```python
import torch

def _softmax(x, axis=-1):
    return torch.softmax(x, dim=axis)
def _gelu(x):
    return torch.nn.functional.gelu(x, approximate="tanh")
def _silu(x):
    return torch.nn.functional.silu(x)
def _sigmoid(x):
    return torch.sigmoid(x)
def _layernorm(x, axis=-1, eps=1e-5):
    m = x.mean(dim=axis, keepdim=True)
    v = x.var(dim=axis, keepdim=True, unbiased=False)
    return (x - m) / torch.sqrt(v + eps)
def _scatter_add(tgt, idx, src, axis=0):
    return tgt.clone().index_add_(axis, idx, src)
def _segment_sum(src, seg, n):
    out = torch.zeros((n,) + src.shape[1:], dtype=src.dtype)
    return out.index_add_(0, seg, src)
def _pad(x, pw):
    flat = tuple(v for pair in reversed(pw) for v in pair)
    return torch.nn.functional.pad(x, flat)

kernel_name = 'standalone__adm_resblock__diffusion'

def setup_inputs():

    _w = (lambda a: (lambda t: t.to(torch.bfloat16) if t.is_floating_point() else t)(torch.as_tensor(a)))
    B, C, HW, E = 2, 320, 64, 1152
    sc = (9.0 * C) ** -0.5
    return {
        "x": _w((lambda *s: torch.randn(*s, dtype=torch.bfloat16) * 0.05)(B, C, HW, HW)),
        "t_emb": _w((lambda *s: torch.randn(*s, dtype=torch.bfloat16) * 0.2)(B, E)),
        "g1": _w(1.0 + 0.1 * (lambda *s: torch.randn(*s, dtype=torch.bfloat16) * 0.2)(C)),
        "be1": _w(0.1 * (lambda *s: torch.randn(*s, dtype=torch.bfloat16) * 0.2)(C)),
        "w1": _w((lambda *s: torch.randn(*s, dtype=torch.bfloat16) * 0.2)(C, C, 3, 3) * sc),
        "w_emb": _w((lambda *s: torch.randn(*s, dtype=torch.bfloat16) * 0.2)(E, C) * (E ** -0.5)),
        "g2": _w(1.0 + 0.1 * (lambda *s: torch.randn(*s, dtype=torch.bfloat16) * 0.2)(C)),
        "be2": _w(0.1 * (lambda *s: torch.randn(*s, dtype=torch.bfloat16) * 0.2)(C)),
        "w2": _w((lambda *s: torch.randn(*s, dtype=torch.bfloat16) * 0.2)(C, C, 3, 3) * sc),
    }

def reference(x, t_emb, g1, be1, w1, w_emb, g2, be2, w2):
    B, C, H, W = x.shape
    G, eps = 4, 1e-5
    def gn(z, gamma, beta):
        zr = z.reshape(B, G, (C // G) * H * W)
        mu = zr.mean(-1).reshape(B, G, 1)
        var = ((zr - mu) ** 2).mean(-1).reshape(B, G, 1)
        zn = ((zr - mu) / torch.sqrt(var + eps)).reshape(B, C, H, W)
        return zn * gamma.reshape(1, C, 1, 1) + beta.reshape(1, C, 1, 1)
    def conv3(z, w):
        zp = _pad(z, ((0, 0), (0, 0), (1, 1), (1, 1)))
        taps = [torch.einsum("bchw,oc->bohw", zp[:, :, i:i+H, j:j+W], w[:, :, i, j]) for i in range(3) for j in range(3)]
        out = taps[0]
        for t in taps[1:]:
            out = out + t
        return out
    h = conv3(_silu(gn(x, g1, be1)), w1)
    emb = _silu(t_emb) @ w_emb
    h = h + emb.reshape(B, C, 1, 1)
    h = conv3(_silu(gn(h, g2, be2)), w2)
    return x + h
```

```asm
; @launch grid=(256,1,1) block=(256,1,1) lds=163840
.amdgcn_target "amdgcn-amd-amdhsa--gfx950"
.text
.globl standalone__adm_resblock__diffusion_kernel
.p2align 8
.type standalone__adm_resblock__diffusion_kernel,@function
standalone__adm_resblock__diffusion_kernel:
    s_cmp_ge_u32 s2, 256
    s_cbranch_scc1 L_end
    s_load_dwordx16 s[4:19], s[0:1], 0
    s_load_dwordx8 s[20:27], s[0:1], 64
    v_lshrrev_b32 v4, 6, v0
    v_and_b32 v1, 63, v0
    v_readfirstlane_b32 s28, v4
    s_and_b32 s33, s2, 7
    s_lshr_b32 s34, s2, 3
    s_getpc_b64 s[94:95]
L_pc:
    s_lshl_b32 s35, s34, 2
    s_add_u32 s35, s35, s28
    s_and_b32 s35, s35, 7
    s_lshl_b32 s35, s35, 13
    v_lshlrev_b32 v5, 7, v1
    v_add_u32 v5, s35, v5
    v_min_u32 v5, L_end-L_pc, v5
    global_load_dword v242, v5, s[94:95]
    s_lshr_b32 s29, s33, 2
    s_and_b32 s30, s33, 1
    s_lshl_b32 s30, s30, 1
    s_and_b32 s35, s34, 1
    s_add_u32 s30, s30, s35
    s_bfe_u32 s32, s34, 0x10001
    s_bfe_u32 s31, s33, 0x10001
    s_lshl_b32 s31, s31, 3
    s_lshr_b32 s35, s34, 2
    s_add_u32 s31, s31, s35
    s_lshl_b32 s31, s31, 2
    s_lshl_b32 s32, s32, 5
    s_mul_i32 s58, s28, 40896
    s_lshl_b32 s59, s29, 2
    s_add_u32 s59, s59, s30
    v_lshlrev_b32 v2, 4, v1
    v_bfe_u32 v4, v1, 2, 2
    v_lshrrev_b32 v5, 4, v1
    v_and_b32 v6, 3, v1
    v_lshlrev_b32 v6, 4, v6
    v_lshl_add_u32 v7, v4, 3, v5
    v_lshl_add_u32 v7, v7, 13, v6
    v_lshl_add_u32 v8, v4, 2, v5
    v_lshl_add_u32 v8, v8, 13, v6
    s_add_u32 s35, s31, s28
    s_lshl_b32 s35, s35, 6
    s_add_u32 s35, s35, s32
    s_lshl_b32 s35, s35, 1
    s_mul_i32 s36, s59, 655360
    s_mov_b32 m0, s58
    s_memrealtime s[92:93]
    v_mov_b32 v240, 163584
    v_mov_b32 v241, 0
    s_lshl_b32 s33, s2, 2
    s_or_b32 s33, s33, s28
    s_waitcnt lgkmcnt(0)
    s_add_u32 s68, s4, s36
    s_addc_u32 s69, s5, 0
    s_mov_b32 s70, 655360
    s_mov_b32 s71, 0x00020000
    s_add_u32 s37, s35, 0
    buffer_load_dwordx4 v7, s[68:71], s37 offen offset:0 lds
    s_add_u32 s37, s35, 31744
    buffer_load_dwordx4 v7, s[68:71], s37 offen offset:1024 lds
    s_add_u32 s37, s35, 260096
    buffer_load_dwordx4 v7, s[68:71], s37 offen offset:2048 lds
    s_add_u32 s37, s35, 291840
    buffer_load_dwordx4 v7, s[68:71], s37 offen offset:3072 lds
    s_add_u32 m0, s58, 4096
    s_add_u32 s37, s35, 524288
    buffer_load_dwordx4 v8, s[68:71], s37 offen offset:0 lds
    s_mov_b32 s72, s8
    s_mov_b32 s73, s9
    s_mov_b32 s74, 640
    s_mov_b32 s75, 0x00020000
    s_mov_b32 s76, s10
    s_mov_b32 s77, s11
    s_mov_b32 s78, 640
    s_mov_b32 s79, 0x00020000
    s_mul_i32 s37, s30, 160
    s_mov_b64 exec, 0x3ff
    s_add_u32 m0, s58, 5120
    s_nop 0
    buffer_load_dwordx4 v2, s[72:75], s37 offen lds
    s_add_u32 m0, s58, 5376
    s_nop 0
    buffer_load_dwordx4 v2, s[76:79], s37 offen lds
    s_mov_b64 exec, -1
    s_mov_b32 s80, s24
    s_mov_b32 s81, s25
    s_mov_b32 s82, 256
    s_mov_b32 s83, 0x00020000
    s_cmp_lg_u32 s33, 1
    s_cbranch_scc1 L_not0
    v_mov_b32 v228, s92
    v_mov_b32 v229, s93
    s_mov_b64 exec, 1
    buffer_store_dwordx2 v[228:229], v241, s[80:83], 0 offen sc1
    s_mov_b64 exec, -1
L_not0:
    s_mov_b32 s96, s92
    s_mul_i32 s94, s93, 0x9e3779b1
    v_mov_b32 v252, s94
    s_add_u32 s94, s94, 0x9e3779b1
    v_mov_b32 v253, s94
    s_mov_b32 s99, 0
    s_cmp_eq_u32 s28, 0
    s_cbranch_scc1 L_r0
    s_cmp_eq_u32 s28, 3
    s_cbranch_scc1 L_r3
    s_cmp_lt_u32 s2, 16
    s_cbranch_scc1 L_r12x
    s_cmp_eq_u32 s28, 2
    s_cselect_b32 s99, 3, 1
    s_cbranch_scc1 L_rdone
    s_sub_u32 s94, s2, 16
    s_and_b32 s95, s94, 15
    s_lshl_b32 s94, s94, 1
    s_sub_u32 s94, s94, s95
    s_sub_u32 s95, s28, 1
    s_lshl_b32 s95, s95, 4
    s_add_u32 s94, s94, s95
    s_mov_b32 s33, 0
    s_cmp_ge_u32 s94, 160
    s_addc_u32 s33, s33, 0
    s_cmp_ge_u32 s94, 320
    s_addc_u32 s33, s33, 0
    s_mul_i32 s38, s33, 160
    s_sub_u32 s38, s94, s38
    s_lshr_b32 s34, s38, 5
    s_bfe_u32 s35, s38, 0x10004
    s_bfe_u32 s36, s38, 0x20002
    s_and_b32 s37, s38, 3
    s_lshl_b32 s38, s34, 4
    s_lshr_b32 s40, s34, 1
    s_lshl_b32 s40, s40, 5
    s_and_b32 s39, s34, 1
    s_lshl_b32 s39, s39, 2
    s_add_u32 s40, s40, s39
    s_cmp_lt_u32 s34, 4
    s_cselect_b32 s39, 1, 0
    s_andn2_b32 s39, s39, s35
    s_cmp_lg_u32 s39, 0
    s_cselect_b32 s38, s40, s38
    s_cselect_b32 s39, 8, 4
    s_mul_i32 s40, s36, 80
    s_add_u32 s38, s38, s40
    s_mul_i32 s38, s38, 5760
    s_mul_i32 s40, s37, 1440
    s_add_u32 s38, s38, s40
    s_mul_i32 s40, s33, 576
    s_add_u32 s38, s38, s40
    s_cmp_eq_u32 s35, 0
    s_cselect_b32 s72, s12, s20
    s_cselect_b32 s73, s13, s21
    s_mov_b32 s74, 1843200
    s_mov_b32 s75, 0x00020000
    s_cmp_eq_u32 s33, 2
    s_cselect_b32 s40, 18, 36
    s_movk_i32 s94, 1821
    s_cselect_b32 s94, 3641, s94
    v_mov_b32 v236, 0x40000000
    v_add_u32 v237, 0, v1
    v_mul_lo_u32 v238, v237, s94
    v_lshrrev_b32 v238, 16, v238
    v_mul_lo_u32 v239, v238, s40
    v_sub_u32 v237, v237, v239
    v_cmp_gt_u32 vcc, 16, v238
    v_lshrrev_b32 v239, 2, v238
    v_mul_lo_u32 v239, v239, s39
    v_and_b32 v238, 3, v238
    v_add_u32 v238, v238, v239
    v_mul_u32_u24 v238, 5760, v238
    v_lshl_add_u32 v238, v237, 4, v238
    v_add_u32 v238, s38, v238
    v_cndmask_b32 v100, v236, v238, vcc
    v_add_u32 v237, 64, v1
    v_mul_lo_u32 v238, v237, s94
    v_lshrrev_b32 v238, 16, v238
    v_mul_lo_u32 v239, v238, s40
    v_sub_u32 v237, v237, v239
    v_cmp_gt_u32 vcc, 16, v238
    v_lshrrev_b32 v239, 2, v238
    v_mul_lo_u32 v239, v239, s39
    v_and_b32 v238, 3, v238
    v_add_u32 v238, v238, v239
    v_mul_u32_u24 v238, 5760, v238
    v_lshl_add_u32 v238, v237, 4, v238
    v_add_u32 v238, s38, v238
    v_cndmask_b32 v101, v236, v238, vcc
    v_add_u32 v237, 128, v1
    v_mul_lo_u32 v238, v237, s94
    v_lshrrev_b32 v238, 16, v238
    v_mul_lo_u32 v239, v238, s40
    v_sub_u32 v237, v237, v239
    v_cmp_gt_u32 vcc, 16, v238
    v_lshrrev_b32 v239, 2, v238
    v_mul_lo_u32 v239, v239, s39
    v_and_b32 v238, 3, v238
    v_add_u32 v238, v238, v239
    v_mul_u32_u24 v238, 5760, v238
    v_lshl_add_u32 v238, v237, 4, v238
    v_add_u32 v238, s38, v238
    v_cndmask_b32 v102, v236, v238, vcc
    v_add_u32 v237, 192, v1
    v_mul_lo_u32 v238, v237, s94
    v_lshrrev_b32 v238, 16, v238
    v_mul_lo_u32 v239, v238, s40
    v_sub_u32 v237, v237, v239
    v_cmp_gt_u32 vcc, 16, v238
    v_lshrrev_b32 v239, 2, v238
    v_mul_lo_u32 v239, v239, s39
    v_and_b32 v238, 3, v238
    v_add_u32 v238, v238, v239
    v_mul_u32_u24 v238, 5760, v238
    v_lshl_add_u32 v238, v237, 4, v238
    v_add_u32 v238, s38, v238
    v_cndmask_b32 v103, v236, v238, vcc
    v_add_u32 v237, 256, v1
    v_mul_lo_u32 v238, v237, s94
    v_lshrrev_b32 v238, 16, v238
    v_mul_lo_u32 v239, v238, s40
    v_sub_u32 v237, v237, v239
    v_cmp_gt_u32 vcc, 16, v238
    v_lshrrev_b32 v239, 2, v238
    v_mul_lo_u32 v239, v239, s39
    v_and_b32 v238, 3, v238
    v_add_u32 v238, v238, v239
    v_mul_u32_u24 v238, 5760, v238
    v_lshl_add_u32 v238, v237, 4, v238
    v_add_u32 v238, s38, v238
    v_cndmask_b32 v104, v236, v238, vcc
    v_add_u32 v237, 320, v1
    v_mul_lo_u32 v238, v237, s94
    v_lshrrev_b32 v238, 16, v238
    v_mul_lo_u32 v239, v238, s40
    v_sub_u32 v237, v237, v239
    v_cmp_gt_u32 vcc, 16, v238
    v_lshrrev_b32 v239, 2, v238
    v_mul_lo_u32 v239, v239, s39
    v_and_b32 v238, 3, v238
    v_add_u32 v238, v238, v239
    v_mul_u32_u24 v238, 5760, v238
    v_lshl_add_u32 v238, v237, 4, v238
    v_add_u32 v238, s38, v238
    v_cndmask_b32 v105, v236, v238, vcc
    v_add_u32 v237, 384, v1
    v_mul_lo_u32 v238, v237, s94
    v_lshrrev_b32 v238, 16, v238
    v_mul_lo_u32 v239, v238, s40
    v_sub_u32 v237, v237, v239
    v_cmp_gt_u32 vcc, 16, v238
    v_lshrrev_b32 v239, 2, v238
    v_mul_lo_u32 v239, v239, s39
    v_and_b32 v238, 3, v238
    v_add_u32 v238, v238, v239
    v_mul_u32_u24 v238, 5760, v238
    v_lshl_add_u32 v238, v237, 4, v238
    v_add_u32 v238, s38, v238
    v_cndmask_b32 v106, v236, v238, vcc
    v_add_u32 v237, 448, v1
    v_mul_lo_u32 v238, v237, s94
    v_lshrrev_b32 v238, 16, v238
    v_mul_lo_u32 v239, v238, s40
    v_sub_u32 v237, v237, v239
    v_cmp_gt_u32 vcc, 16, v238
    v_lshrrev_b32 v239, 2, v238
    v_mul_lo_u32 v239, v239, s39
    v_and_b32 v238, 3, v238
    v_add_u32 v238, v238, v239
    v_mul_u32_u24 v238, 5760, v238
    v_lshl_add_u32 v238, v237, 4, v238
    v_add_u32 v238, s38, v238
    v_cndmask_b32 v107, v236, v238, vcc
    v_add_u32 v237, 512, v1
    v_mul_lo_u32 v238, v237, s94
    v_lshrrev_b32 v238, 16, v238
    v_mul_lo_u32 v239, v238, s40
    v_sub_u32 v237, v237, v239
    v_cmp_gt_u32 vcc, 16, v238
    v_lshrrev_b32 v239, 2, v238
    v_mul_lo_u32 v239, v239, s39
    v_and_b32 v238, 3, v238
    v_add_u32 v238, v238, v239
    v_mul_u32_u24 v238, 5760, v238
    v_lshl_add_u32 v238, v237, 4, v238
    v_add_u32 v238, s38, v238
    v_cndmask_b32 v108, v236, v238, vcc
    s_branch L_rdone
L_r12x:
    s_branch L_rdone
L_r0:
    v_mov_b32 v228, 0
    v_mov_b32 v229, 0
    ds_write_b64 v240, v[228:229] offset:64
    ds_write_b64 v240, v[228:229] offset:40
    buffer_load_dword v230, v241, s[80:83], 0 offen offset:128
    s_add_u32 s84, s26, 14254080
    s_addc_u32 s85, s27, 0
    s_mov_b32 s86, 16384
    s_mov_b32 s87, 0x00020000
    buffer_load_dword v231, v241, s[84:87], 0 offen sc1
    s_branch L_rdone
L_r3:
    s_cmp_ge_u32 s2, 60
    s_cbranch_scc1 L_rdone
    s_mov_b32 s99, 2
    s_mul_i32 s33, s2, 43
    s_lshr_b32 s33, s33, 9
    s_mul_i32 s34, s33, 12
    s_sub_u32 s34, s2, s34
    s_lshl_b32 s35, s33, 7
    s_add_u32 s36, s35, 3840
    s_mov_b32 s76, s14
    s_mov_b32 s77, s15
    s_mov_b32 s78, 737280
    s_mov_b32 s79, 0x00020000
    v_and_b32 v230, 7, v1
    v_lshrrev_b32 v229, 3, v1
    v_mul_u32_u24 v229, 12, v229
    s_mul_i32 s37, s34, 96
    v_add_u32 v229, s37, v229
    v_lshlrev_b32 v228, 1, v229
    v_mul_u32_u24 v229, 640, v229
    v_lshl_add_u32 v229, v230, 4, v229
    s_mov_b32 s72, s6
    s_mov_b32 s73, s7
    s_mov_b32 s74, 4608
    s_mov_b32 s75, 0x00020000
    buffer_load_dwordx4 v[100:103], v228, s[72:75], 0 offen offset:0
    buffer_load_dwordx2 v[104:105], v228, s[72:75], 0 offen offset:16
    buffer_load_dwordx4 v[108:111], v228, s[72:75], 0 offen offset:2304
    buffer_load_dwordx2 v[112:113], v228, s[72:75], 0 offen offset:2320
    buffer_load_dwordx4 v[116:119], v229, s[76:79], s35 offen offset:0
L_rdone:
    s_mov_b32 s90, s35
    s_mov_b32 s91, s36
    v_add_u32 v3, 4096, v2
    s_add_u32 s53, s28, 1
    s_and_b32 s53, s53, 3
    s_mul_i32 s47, s53, 2176
    s_add_u32 s47, s47, s58
    s_add_u32 s47, s47, 6592
    s_add_u32 s36, s53, s31
    s_sub_u32 s36, s36, 1
    s_lshl_b32 s41, s36, 6
    s_add_u32 s41, s41, s32
    s_lshl_b32 s41, s41, 6
    s_cmp_lt_u32 s36, 64
    s_cselect_b32 s41, s41, 0x40000000
    s_add_u32 s54, s28, 2
    s_and_b32 s54, s54, 3
    s_mul_i32 s48, s54, 2176
    s_add_u32 s48, s48, s58
    s_add_u32 s48, s48, 6592
    s_add_u32 s36, s54, s31
    s_sub_u32 s36, s36, 1
    s_lshl_b32 s42, s36, 6
    s_add_u32 s42, s42, s32
    s_lshl_b32 s42, s42, 6
    s_cmp_lt_u32 s36, 64
    s_cselect_b32 s42, s42, 0x40000000
    s_add_u32 s55, s28, 3
    s_and_b32 s55, s55, 3
    s_mul_i32 s49, s55, 2176
    s_add_u32 s49, s49, s58
    s_add_u32 s49, s49, 6592
    s_add_u32 s36, s55, s31
    s_sub_u32 s36, s36, 1
    s_lshl_b32 s43, s36, 6
    s_add_u32 s43, s43, s32
    s_lshl_b32 s43, s43, 6
    s_cmp_lt_u32 s36, 64
    s_cselect_b32 s43, s43, 0x40000000
    s_add_u32 s56, s28, 4
    s_and_b32 s56, s56, 3
    s_mul_i32 s50, s56, 2176
    s_add_u32 s50, s50, s58
    s_add_u32 s50, s50, 6592
    s_add_u32 s36, s56, s31
    s_sub_u32 s36, s36, 1
    s_lshl_b32 s44, s36, 6
    s_add_u32 s44, s44, s32
    s_lshl_b32 s44, s44, 6
    s_cmp_lt_u32 s36, 64
    s_cselect_b32 s44, s44, 0x40000000
    s_add_u32 s51, s58, 15296
    s_add_u32 s36, s31, 3
    s_lshl_b32 s45, s36, 6
    s_add_u32 s45, s45, s32
    s_lshl_b32 s45, s45, 6
    s_cmp_lt_u32 s36, 64
    s_cselect_b32 s45, s45, 0x40000000
    s_add_u32 s52, s58, 17472
    s_add_u32 s36, s31, 4
    s_lshl_b32 s46, s36, 6
    s_add_u32 s46, s46, s32
    s_lshl_b32 s46, s46, 6
    s_cmp_lt_u32 s36, 64
    s_cselect_b32 s46, s46, 0x40000000
    v_lshrrev_b32 v8, 3, v1
    v_subrev_u32 v9, 6, v8
    v_min_u32 v8, v8, v9
    v_bfe_u32 v9, v1, 2, 1
    v_and_b32 v10, 3, v1
    v_and_b32 v237, 1, v1
    v_mul_u32_u24 v11, 33, v9
    v_mul_u32_u24 v246, 2176, v8
    v_lshl_add_u32 v246, v11, 6, v246
    v_lshl_add_u32 v246, v10, 4, v246
    v_add_u32 v246, s58, v246
    v_mul_u32_u24 v247, 1088, v8
    v_lshl_add_u32 v247, v11, 5, v247
    v_lshl_add_u32 v247, v237, 4, v247
    v_add_u32 v247, s58, v247
    v_add_u32 v8, s31, v8
    v_subrev_u32 v8, 1, v8
    v_add_u32 v11, s32, v11
    v_subrev_u32 v11, 1, v11
    v_max_u32 v9, v8, v11
    v_lshl_add_u32 v8, v8, 6, v11
    v_lshlrev_b32 v10, 4, v10
    v_lshl_add_u32 v244, v8, 6, v10
    v_lshlrev_b32 v237, 4, v237
    v_lshl_add_u32 v245, v8, 5, v237
    v_cmp_gt_u32 vcc, 64, v9
    v_mov_b32 v8, 0x40000000
    s_nop 0
    v_cndmask_b32 v244, v8, v244, vcc
    v_cndmask_b32 v245, v8, v245, vcc
    v_and_b32 v8, 15, v1
    v_lshrrev_b32 v9, 4, v1
    v_add_u32 v10, -1, v8
    v_bfe_u32 v11, v10, 2, 1
    v_lshlrev_b32 v11, 1, v11
    v_xor_b32 v11, v11, v9
    v_lshlrev_b32 v11, 4, v11
    v_lshl_add_u32 v237, v10, 6, v11
    v_add_u32 v12, s47, v237
    v_add_u32 v15, s48, v237
    v_add_u32 v18, s49, v237
    v_add_u32 v21, s50, v237
    v_add_u32 v10, 0, v8
    v_bfe_u32 v11, v10, 2, 1
    v_lshlrev_b32 v11, 1, v11
    v_xor_b32 v11, v11, v9
    v_lshlrev_b32 v11, 4, v11
    v_lshl_add_u32 v237, v10, 6, v11
    v_add_u32 v13, s47, v237
    v_add_u32 v16, s48, v237
    v_add_u32 v19, s49, v237
    v_add_u32 v22, s50, v237
    v_add_u32 v10, 1, v8
    v_bfe_u32 v11, v10, 2, 1
    v_lshlrev_b32 v11, 1, v11
    v_xor_b32 v11, v11, v9
    v_lshlrev_b32 v11, 4, v11
    v_lshl_add_u32 v237, v10, 6, v11
    v_add_u32 v14, s47, v237
    v_add_u32 v17, s48, v237
    v_add_u32 v20, s49, v237
    v_add_u32 v23, s50, v237
    v_and_b32 v10, 1, v9
    v_lshlrev_b32 v10, 4, v10
    v_lshl_add_u32 v10, v8, 5, v10
    v_add_u32 v237, s58, v10
    v_lshrrev_b32 v238, 1, v9
    v_mul_u32_u24 v239, 1088, v238
    s_mul_i32 s39, s53, 1088
    v_add_u32 v26, s39, v237
    v_lshl_add_u32 v24, v238, 5, v26
    v_add_u32 v25, v239, v26
    s_mul_i32 s39, s54, 1088
    v_add_u32 v29, s39, v237
    v_lshl_add_u32 v27, v238, 5, v29
    v_add_u32 v28, v239, v29
    s_mul_i32 s39, s55, 1088
    v_add_u32 v32, s39, v237
    v_lshl_add_u32 v30, v238, 5, v32
    v_add_u32 v31, v239, v32
    s_mul_i32 s39, s56, 1088
    v_add_u32 v35, s39, v237
    v_lshl_add_u32 v33, v238, 5, v35
    v_add_u32 v34, v239, v35
    s_and_b32 s39, s28, 1
    v_subrev_u32 v239, s39, v238
    v_mul_i32_i24 v239, 40896, v239
    v_add_u32 v29, v29, v239
    v_add_u32 v35, v35, v239
    v_add_u32 v248, s58, v2
    s_sub_u32 s39, s28, 1
    s_and_b32 s39, s39, 3
    s_mul_i32 s39, s39, 40896
    v_add_u32 v249, s39, v2
    s_sub_u32 s39, s28, 2
    s_and_b32 s39, s39, 3
    s_mul_i32 s39, s39, 40896
    v_add_u32 v250, s39, v2
    s_sub_u32 s39, s28, 3
    s_and_b32 s39, s39, 3
    s_mul_i32 s39, s39, 40896
    v_add_u32 v251, s39, v2
    s_sub_u32 s53, s58, 6528
    v_add_u32 v255, 524288, v2
    s_lshl_b32 s39, s29, 2
    s_add_u32 s39, s39, s28
    s_mul_i32 s39, s39, 655360
    s_add_u32 s60, s26, s39
    s_addc_u32 s61, s27, 0
    s_mov_b32 s62, 655360
    s_mov_b32 s63, 0x00020000
    s_lshl_b32 s39, s30, 2
    s_add_u32 s39, s39, s28
    s_mul_i32 s39, s39, 117760
    s_add_u32 s39, s39, 10485760
    s_add_u32 s64, s26, s39
    s_addc_u32 s65, s27, 0
    s_mov_b32 s66, 117760
    s_mov_b32 s67, 0x00020000
    s_sub_u32 s39, s2, 16
    s_mov_b32 s33, 0
    s_cmp_ge_u32 s39, 80
    s_addc_u32 s33, s33, 0
    s_cmp_ge_u32 s39, 160
    s_addc_u32 s33, s33, 0
    s_mul_i32 s40, s33, 80
    s_sub_u32 s40, s39, s40
    s_lshr_b32 s34, s40, 4
    s_bfe_u32 s37, s40, 0x20002
    s_and_b32 s38, s40, 3
    s_and_b32 s40, s40, 15
    s_lshl_b32 s36, s40, 7
    s_mul_i32 s97, s33, 5
    s_add_u32 s97, s97, s34
    s_lshl_b32 s97, s97, 3
    s_add_u32 s36, s36, s97
    s_add_u32 s100, s36, 2048
    s_mul_i32 s40, s40, 117760
    s_mul_i32 s97, s33, 46080
    s_add_u32 s40, s40, s97
    s_lshl_b32 s97, s34, 10
    s_add_u32 s40, s40, s97
    s_lshl_b32 s97, s28, 8
    s_add_u32 s40, s40, s97
    s_cmp_lt_u32 s39, 240
    s_cselect_b32 s40, s40, 0x40000000
    s_and_b32 s97, s38, 1
    s_lshr_b32 s36, s28, 1
    s_sub_u32 s36, s36, s97
    s_mul_i32 s36, s36, 117760
    s_lshl_b32 s97, s97, 9
    s_add_u32 s36, s36, s97
    s_and_b32 s97, s28, 2
    s_lshl_b32 s97, s97, 8
    s_sub_u32 s36, s36, s97
    s_cmp_eq_u32 s33, 2
    s_cselect_b32 s36, s36, 0
    s_mul_i32 s37, s37, 80
    s_lshl_b32 s97, s34, 4
    s_add_u32 s37, s37, s97
    s_mul_i32 s37, s37, 5760
    s_mul_i32 s38, s38, 1440
    s_add_u32 s37, s37, s38
    s_and_b32 s97, s28, 1
    s_cmp_eq_u32 s33, 2
    s_cselect_b32 s97, s97, s28
    s_lshl_b32 s38, s33, 2
    s_add_u32 s97, s97, s38
    s_mul_i32 s97, s97, 144
    s_add_u32 s37, s37, s97
    s_cmp_lt_u32 s39, 240
    s_cselect_b32 s37, s37, 0x40000000
    v_mov_b32 v236, 0x40000000
    v_add_u32 v237, 0, v1
    v_mul_u32_u24 v238, 7282, v237
    v_lshrrev_b32 v238, 16, v238
    v_mul_u32_u24 v239, 9, v238
    v_sub_u32 v237, v237, v239
    v_cmp_gt_u32 vcc, 16, v238
    v_mul_u32_u24 v238, 5760, v238
    v_lshl_add_u32 v238, v237, 4, v238
    v_add_u32 v238, s37, v238
    v_cndmask_b32 v176, v236, v238, vcc
    v_add_u32 v237, 64, v1
    v_mul_u32_u24 v238, 7282, v237
    v_lshrrev_b32 v238, 16, v238
    v_mul_u32_u24 v239, 9, v238
    v_sub_u32 v237, v237, v239
    v_cmp_gt_u32 vcc, 16, v238
    v_mul_u32_u24 v238, 5760, v238
    v_lshl_add_u32 v238, v237, 4, v238
    v_add_u32 v238, s37, v238
    v_cndmask_b32 v177, v236, v238, vcc
    v_add_u32 v237, 128, v1
    v_mul_u32_u24 v238, 7282, v237
    v_lshrrev_b32 v238, 16, v238
    v_mul_u32_u24 v239, 9, v238
    v_sub_u32 v237, v237, v239
    v_cmp_gt_u32 vcc, 16, v238
    v_mul_u32_u24 v238, 5760, v238
    v_lshl_add_u32 v238, v237, 4, v238
    v_add_u32 v238, s37, v238
    v_cndmask_b32 v178, v236, v238, vcc
    s_mov_b32 s94, 0xfff82630
    s_cmp_ge_u32 s28, 2
    s_cselect_b32 s94, 0xfff85741, s94
    s_cmp_eq_u32 s33, 2
    s_cselect_b32 s94, s94, 0x67534201
    s_cselect_b32 s95, -1, 0xfffffff8
    v_and_b32 v8, 15, v1
    v_lshrrev_b32 v9, 4, v1
    v_mul_u32_u24 v10, 144, v8
    v_add_u32 v10, s58, v10
    v_lshlrev_b32 v8, 4, v8
    v_add_u32 v8, s40, v8
    s_add_u32 s97, s58, 2304
    v_mov_b32 v11, s97
    v_add_u32 v237, 0, v9
    v_lshlrev_b32 v238, 2, v237
    v_lshrrev_b64 v[234:235], v238, s[94:95]
    v_and_b32 v238, 15, v234
    v_lshl_add_u32 v239, v238, 1, v10
    v_cmp_gt_u32 vcc, 14, v238
    s_nop 1
    v_cndmask_b32 v179, v11, v239, vcc
    v_mul_u32_u24 v237, 5120, v237
    v_add_u32 v237, v237, v8
    v_cmp_gt_u32 vcc, 15, v238
    s_nop 1
    v_cndmask_b32 v182, v236, v237, vcc
    v_add_u32 v237, 4, v9
    v_lshlrev_b32 v238, 2, v237
    v_lshrrev_b64 v[234:235], v238, s[94:95]
    v_and_b32 v238, 15, v234
    v_lshl_add_u32 v239, v238, 1, v10
    v_cmp_gt_u32 vcc, 14, v238
    s_nop 1
    v_cndmask_b32 v180, v11, v239, vcc
    v_cmp_eq_u32 vcc, 4, v237
    v_mov_b32 v239, s36
    s_nop 0
    v_cndmask_b32 v239, 0, v239, vcc
    v_mul_u32_u24 v237, 5120, v237
    v_add_u32 v237, v237, v8
    v_add_u32 v237, v237, v239
    v_cmp_gt_u32 vcc, 15, v238
    s_nop 1
    v_cndmask_b32 v183, v236, v237, vcc
    v_add_u32 v237, 8, v9
    v_lshlrev_b32 v238, 2, v237
    v_lshrrev_b64 v[234:235], v238, s[94:95]
    v_and_b32 v238, 15, v234
    v_lshl_add_u32 v239, v238, 1, v10
    v_cmp_gt_u32 vcc, 14, v238
    s_nop 1
    v_cndmask_b32 v181, v11, v239, vcc
    v_mul_u32_u24 v237, 5120, v237
    v_add_u32 v237, v237, v8
    v_cmp_gt_u32 vcc, 15, v238
    s_nop 1
    v_cndmask_b32 v184, v236, v237, vcc
    v_accvgpr_write_b32 a240, v176
    v_accvgpr_write_b32 a241, v177
    v_accvgpr_write_b32 a242, v178
    v_accvgpr_write_b32 a243, v179
    v_accvgpr_write_b32 a244, v180
    v_accvgpr_write_b32 a245, v181
    v_accvgpr_write_b32 a246, v182
    v_accvgpr_write_b32 a247, v183
    v_accvgpr_write_b32 a248, v184
    s_mov_b32 s35, s90
    s_mov_b32 s36, s91
    v_mov_b32 v36, 0
    v_mov_b32 v37, 0
    v_mov_b32 v38, 0
    v_mov_b32 v39, 0
    v_mov_b32 v40, 0
    v_mov_b32 v41, 0
    v_mov_b32 v42, 0
    v_mov_b32 v43, 0
    v_mov_b32 v44, 0
    v_mov_b32 v45, 0
    v_mov_b32 v46, 0
    v_mov_b32 v47, 0
    v_mov_b32 v48, 0
    v_mov_b32 v49, 0
    v_mov_b32 v50, 0
    v_mov_b32 v51, 0
    v_mov_b32 v52, 0
    v_mov_b32 v53, 0
    v_mov_b32 v54, 0
    v_mov_b32 v55, 0
    v_mov_b32 v56, 0
    v_mov_b32 v57, 0
    v_mov_b32 v58, 0
    v_mov_b32 v59, 0
    v_mov_b32 v60, 0
    v_mov_b32 v61, 0
    v_mov_b32 v62, 0
    v_mov_b32 v63, 0
    v_mov_b32 v64, 0
    v_mov_b32 v65, 0
    v_mov_b32 v66, 0
    v_mov_b32 v67, 0
    v_mov_b32 v68, 0
    v_mov_b32 v69, 0
    v_mov_b32 v70, 0
    v_mov_b32 v71, 0
    v_mov_b32 v72, 0
    v_mov_b32 v73, 0
    v_mov_b32 v74, 0
    v_mov_b32 v75, 0
    v_and_b32 v8, 15, v1
    v_lshrrev_b32 v9, 4, v1
    v_lshlrev_b32 v4, 6, v9
    v_lshl_add_u32 v4, v8, 1, v4
    v_add_u32 v4, s58, v4
    v_lshlrev_b32 v5, 4, v9
    v_add_u32 v5, s58, v5
    v_lshlrev_b32 v6, 3, v9
    v_add_u32 v6, s58, v6
    s_cmp_eq_u32 s99, 0
    s_cbranch_scc1 L_xw0
    s_cmp_eq_u32 s99, 3
    s_cbranch_scc1 L_xw0
    s_cmp_eq_u32 s99, 2
    s_cbranch_scc1 L_xw3
    s_waitcnt vmcnt(4)
    s_add_u32 m0, s58, 8192
    s_nop 0
    buffer_load_dwordx4 v100, s[72:75], 0 offen lds
    s_add_u32 m0, s58, 9216
    s_nop 0
    buffer_load_dwordx4 v101, s[72:75], 0 offen lds
    s_add_u32 m0, s58, 10240
    s_nop 0
    buffer_load_dwordx4 v102, s[72:75], 0 offen lds
    s_add_u32 m0, s58, 11264
    s_nop 0
    buffer_load_dwordx4 v103, s[72:75], 0 offen lds
    s_add_u32 m0, s58, 12288
    s_nop 0
    buffer_load_dwordx4 v104, s[72:75], 0 offen lds
    s_add_u32 m0, s58, 13312
    s_nop 0
    buffer_load_dwordx4 v105, s[72:75], 0 offen lds
    s_add_u32 m0, s58, 14336
    s_nop 0
    buffer_load_dwordx4 v106, s[72:75], 0 offen lds
    s_add_u32 m0, s58, 15360
    s_nop 0
    buffer_load_dwordx4 v107, s[72:75], 0 offen lds
    s_add_u32 m0, s58, 16384
    s_nop 0
    buffer_load_dwordx4 v108, s[72:75], 0 offen lds
    s_waitcnt vmcnt(11)
    s_branch L_xw1
L_xw3:
    s_waitcnt vmcnt(9)
    buffer_load_dwordx4 v[120:123], v229, s[76:79], s35 offen offset:640
    buffer_load_dwordx4 v[124:127], v229, s[76:79], s35 offen offset:1280
    buffer_load_dwordx4 v[128:131], v229, s[76:79], s35 offen offset:1920
    buffer_load_dwordx4 v[132:135], v229, s[76:79], s35 offen offset:2560
    buffer_load_dwordx4 v[136:139], v229, s[76:79], s35 offen offset:3200
    buffer_load_dwordx4 v[140:143], v229, s[76:79], s36 offen offset:0
    buffer_load_dwordx4 v[144:147], v229, s[76:79], s36 offen offset:640
    buffer_load_dwordx4 v[148:151], v229, s[76:79], s36 offen offset:1280
    buffer_load_dwordx4 v[152:155], v229, s[76:79], s36 offen offset:1920
    buffer_load_dwordx4 v[156:159], v229, s[76:79], s36 offen offset:2560
    buffer_load_dwordx4 v[160:163], v229, s[76:79], s36 offen offset:3200
    s_waitcnt vmcnt(18)
    s_branch L_xw1
L_xw0:
    s_cmp_eq_u32 s28, 0
    s_cbranch_scc1 L_xw2
    s_waitcnt vmcnt(2) lgkmcnt(0)
    s_branch L_xw1
L_xw2:
    s_waitcnt vmcnt(4) lgkmcnt(0)
L_xw1:
    ds_read_u16_d16_hi v36, v4 offset:0
    ds_read_u16_d16_hi v37, v4 offset:256
    ds_read_u16_d16_hi v38, v4 offset:512
    ds_read_u16_d16_hi v39, v4 offset:768
    ds_read_u16_d16_hi v40, v4 offset:1024
    ds_read_u16_d16_hi v41, v4 offset:1280
    ds_read_u16_d16_hi v42, v4 offset:1536
    ds_read_u16_d16_hi v43, v4 offset:1792
    ds_read_u16_d16_hi v44, v4 offset:2048
    ds_read_u16_d16_hi v45, v4 offset:2304
    ds_read_u16_d16_hi v46, v4 offset:2560
    ds_read_u16_d16_hi v47, v4 offset:2816
    ds_read_u16_d16_hi v48, v4 offset:3072
    ds_read_u16_d16_hi v49, v4 offset:3328
    ds_read_u16_d16_hi v50, v4 offset:3584
    ds_read_u16_d16_hi v51, v4 offset:3840
    ds_read_u16_d16_hi v52, v4 offset:4096
    ds_read_u16_d16_hi v53, v4 offset:4352
    ds_read_u16_d16_hi v54, v4 offset:4608
    ds_read_u16_d16_hi v55, v4 offset:4864
    ds_read_u16_d16_hi v56, v4 offset:32
    ds_read_u16_d16_hi v57, v4 offset:288
    ds_read_u16_d16_hi v58, v4 offset:544
    ds_read_u16_d16_hi v59, v4 offset:800
    ds_read_u16_d16_hi v60, v4 offset:1056
    ds_read_u16_d16_hi v61, v4 offset:1312
    ds_read_u16_d16_hi v62, v4 offset:1568
    ds_read_u16_d16_hi v63, v4 offset:1824
    ds_read_u16_d16_hi v64, v4 offset:2080
    ds_read_u16_d16_hi v65, v4 offset:2336
    ds_read_u16_d16_hi v66, v4 offset:2592
    ds_read_u16_d16_hi v67, v4 offset:2848
    ds_read_u16_d16_hi v68, v4 offset:3104
    ds_read_u16_d16_hi v69, v4 offset:3360
    ds_read_u16_d16_hi v70, v4 offset:3616
    ds_read_u16_d16_hi v71, v4 offset:3872
    ds_read_u16_d16_hi v72, v4 offset:4128
    ds_read_u16_d16_hi v73, v4 offset:4384
    ds_read_u16_d16_hi v74, v4 offset:4640
    ds_read_u16_d16_hi v75, v4 offset:4896
    s_waitcnt lgkmcnt(0)
    v_readfirstlane_b32 s98, v36
    s_nop 1
    v_sub_f32 v76, 0, s98
    v_sub_f32 v77, 0, s98
    v_pk_add_f32 v[36:37], v[36:37], v[76:77]
    v_pk_add_f32 v[38:39], v[38:39], v[76:77]
    v_pk_add_f32 v[40:41], v[40:41], v[76:77]
    v_pk_add_f32 v[42:43], v[42:43], v[76:77]
    v_pk_add_f32 v[44:45], v[44:45], v[76:77]
    v_pk_add_f32 v[46:47], v[46:47], v[76:77]
    v_pk_add_f32 v[48:49], v[48:49], v[76:77]
    v_pk_add_f32 v[50:51], v[50:51], v[76:77]
    v_pk_add_f32 v[52:53], v[52:53], v[76:77]
    v_pk_add_f32 v[54:55], v[54:55], v[76:77]
    v_pk_add_f32 v[56:57], v[56:57], v[76:77]
    v_pk_add_f32 v[58:59], v[58:59], v[76:77]
    v_pk_add_f32 v[60:61], v[60:61], v[76:77]
    v_pk_add_f32 v[62:63], v[62:63], v[76:77]
    v_pk_add_f32 v[64:65], v[64:65], v[76:77]
    v_pk_add_f32 v[66:67], v[66:67], v[76:77]
    v_pk_add_f32 v[68:69], v[68:69], v[76:77]
    v_pk_add_f32 v[70:71], v[70:71], v[76:77]
    v_pk_add_f32 v[72:73], v[72:73], v[76:77]
    v_pk_add_f32 v[74:75], v[74:75], v[76:77]
    v_pk_add_f32 v[78:79], v[36:37], v[40:41]
    v_pk_add_f32 v[80:81], v[38:39], v[42:43]
    v_pk_mul_f32 v[82:83], v[36:37], v[36:37]
    v_pk_mul_f32 v[84:85], v[38:39], v[38:39]
    v_pk_fma_f32 v[82:83], v[40:41], v[40:41], v[82:83]
    v_pk_fma_f32 v[84:85], v[42:43], v[42:43], v[84:85]
    v_pk_add_f32 v[78:79], v[78:79], v[44:45]
    v_pk_fma_f32 v[82:83], v[44:45], v[44:45], v[82:83]
    v_pk_add_f32 v[80:81], v[80:81], v[46:47]
    v_pk_fma_f32 v[84:85], v[46:47], v[46:47], v[84:85]
    v_pk_add_f32 v[78:79], v[78:79], v[48:49]
    v_pk_fma_f32 v[82:83], v[48:49], v[48:49], v[82:83]
    v_pk_add_f32 v[80:81], v[80:81], v[50:51]
    v_pk_fma_f32 v[84:85], v[50:51], v[50:51], v[84:85]
    v_pk_add_f32 v[78:79], v[78:79], v[52:53]
    v_pk_fma_f32 v[82:83], v[52:53], v[52:53], v[82:83]
    v_pk_add_f32 v[80:81], v[80:81], v[54:55]
    v_pk_fma_f32 v[84:85], v[54:55], v[54:55], v[84:85]
    v_pk_add_f32 v[78:79], v[78:79], v[56:57]
    v_pk_fma_f32 v[82:83], v[56:57], v[56:57], v[82:83]
    v_pk_add_f32 v[80:81], v[80:81], v[58:59]
    v_pk_fma_f32 v[84:85], v[58:59], v[58:59], v[84:85]
    v_pk_add_f32 v[78:79], v[78:79], v[60:61]
    v_pk_fma_f32 v[82:83], v[60:61], v[60:61], v[82:83]
    v_pk_add_f32 v[80:81], v[80:81], v[62:63]
    v_pk_fma_f32 v[84:85], v[62:63], v[62:63], v[84:85]
    v_pk_add_f32 v[78:79], v[78:79], v[64:65]
    v_pk_fma_f32 v[82:83], v[64:65], v[64:65], v[82:83]
    v_pk_add_f32 v[80:81], v[80:81], v[66:67]
    v_pk_fma_f32 v[84:85], v[66:67], v[66:67], v[84:85]
    v_pk_add_f32 v[78:79], v[78:79], v[68:69]
    v_pk_fma_f32 v[82:83], v[68:69], v[68:69], v[82:83]
    v_pk_add_f32 v[80:81], v[80:81], v[70:71]
    v_pk_fma_f32 v[84:85], v[70:71], v[70:71], v[84:85]
    v_pk_add_f32 v[78:79], v[78:79], v[72:73]
    v_pk_fma_f32 v[82:83], v[72:73], v[72:73], v[82:83]
    v_pk_add_f32 v[80:81], v[80:81], v[74:75]
    v_pk_fma_f32 v[84:85], v[74:75], v[74:75], v[84:85]
    v_pk_add_f32 v[78:79], v[78:79], v[80:81]
    v_pk_add_f32 v[82:83], v[82:83], v[84:85]
    v_add_f32 v78, v78, v79
    v_add_f32 v79, v82, v83
    s_nop 0
    v_add_f32_dpp v78, v78, v78 quad_perm:[1,0,3,2] row_mask:0xf bank_mask:0xf
    v_add_f32_dpp v79, v79, v79 quad_perm:[1,0,3,2] row_mask:0xf bank_mask:0xf
    s_nop 0
    v_add_f32_dpp v78, v78, v78 quad_perm:[2,3,0,1] row_mask:0xf bank_mask:0xf
    v_add_f32_dpp v79, v79, v79 quad_perm:[2,3,0,1] row_mask:0xf bank_mask:0xf
    s_nop 0
    v_add_f32_dpp v78, v78, v78 row_half_mirror row_mask:0xf bank_mask:0xf
    v_add_f32_dpp v79, v79, v79 row_half_mirror row_mask:0xf bank_mask:0xf
    s_nop 0
    v_add_f32_dpp v78, v78, v78 row_mirror row_mask:0xf bank_mask:0xf
    v_add_f32_dpp v79, v79, v79 row_mirror row_mask:0xf bank_mask:0xf
    v_mov_b32 v82, v78
    v_mov_b32 v83, v79
    s_nop 0
    v_permlane16_swap_b32 v78, v82
    v_permlane16_swap_b32 v79, v83
    v_add_f32 v78, v78, v82
    v_add_f32 v79, v79, v83
    v_mov_b32 v82, v78
    v_mov_b32 v83, v79
    s_nop 0
    v_permlane32_swap_b32 v78, v82
    v_permlane32_swap_b32 v79, v83
    v_add_f32 v78, v78, v82
    v_add_f32 v79, v79, v83
    v_mul_f32 v82, 0x39cccccd, v78
    v_fma_f32 v87, -v82, v78, v79
    v_add_f32 v86, s98, v82
    s_lshl_b32 s40, s28, 3
    v_add_u32 v88, s40, v240
    ds_write_b64 v88, v[86:87]
    s_lshl_b32 s34, s59, 10
    s_add_u32 s34, s34, 14254080
    s_add_u32 s84, s26, s34
    s_addc_u32 s85, s27, 0
    s_mov_b32 s86, 1024
    s_mov_b32 s87, 0x00020000
    s_waitcnt lgkmcnt(0)
    s_barrier
    s_cmp_lg_u32 s28, 0
    s_cbranch_scc1 L_e0_notw0
    ds_read_b128 v[92:95], v240
    ds_read_b128 v[96:99], v240 offset:16
    s_lshl_b32 s35, s31, 3
    s_lshr_b32 s36, s32, 1
    s_add_u32 s35, s35, s36
    s_memrealtime s[92:93]
    s_waitcnt lgkmcnt(0)
    s_mul_i32 s97, s93, 0x9e3779b1
    s_add_u32 s97, s97, s92
    v_add_f32 v86, v92, v94
    v_add_f32 v87, v96, v98
    v_add_f32 v86, v86, v87
    v_mul_f32 v80, 0x3e800000, v86
    v_add_f32 v87, v93, v95
    v_add_f32 v93, v97, v99
    v_add_f32 v87, v87, v93
    v_sub_f32 v92, v92, v80
    v_sub_f32 v94, v94, v80
    v_sub_f32 v96, v96, v80
    v_sub_f32 v98, v98, v80
    v_mul_f32 v93, v92, v92
    v_fmac_f32 v93, v94, v94
    v_fmac_f32 v93, v96, v96
    v_fmac_f32 v93, v98, v98
    v_fmac_f32 v87, 0x45200000, v93
    v_max_f32 v82, 0, v87
    v_mov_b32 v81, s92
    v_mov_b32 v83, s97
    s_mov_b64 exec, 1
    buffer_store_dwordx4 v[80:83], v241, s[84:87], s35 offen sc1
    s_mov_b64 exec, -1
    s_waitcnt vmcnt(1)
    s_branch L_e0_pub_done
L_e0_notw0:
    s_cmp_eq_u32 s99, 2
    s_cbranch_scc1 L_sj_emb
    s_cmp_eq_u32 s99, 0
    s_cbranch_scc1 L_sj_none
    s_cmp_eq_u32 s99, 1
    s_cbranch_scc1 L_sj_rp1
    s_waitcnt vmcnt(0)
    s_branch L_sj_done
L_sj_rp1:
    s_sub_u32 s94, s2, 16
    s_and_b32 s95, s94, 15
    s_lshl_b32 s94, s94, 1
    s_sub_u32 s94, s94, s95
    s_sub_u32 s95, s28, 1
    s_lshl_b32 s95, s95, 4
    s_add_u32 s94, s94, s95
    s_mov_b32 s33, 0
    s_cmp_ge_u32 s94, 160
    s_addc_u32 s33, s33, 0
    s_cmp_ge_u32 s94, 320
    s_addc_u32 s33, s33, 0
    s_mul_i32 s38, s33, 160
    s_sub_u32 s38, s94, s38
    s_lshr_b32 s34, s38, 5
    s_bfe_u32 s35, s38, 0x10004
    s_bfe_u32 s36, s38, 0x20002
    s_and_b32 s37, s38, 3
    s_lshl_b32 s38, s34, 4
    s_lshr_b32 s40, s34, 1
    s_lshl_b32 s40, s40, 5
    s_and_b32 s39, s34, 1
    s_lshl_b32 s39, s39, 2
    s_add_u32 s40, s40, s39
    s_cmp_lt_u32 s34, 4
    s_cselect_b32 s39, 1, 0
    s_andn2_b32 s39, s39, s35
    s_cmp_lg_u32 s39, 0
    s_cselect_b32 s38, s40, s38
    s_cselect_b32 s39, 8, 4
    s_mul_i32 s40, s36, 80
    s_add_u32 s38, s38, s40
    s_lshl_b32 s57, s36, 2
    s_add_u32 s57, s57, s37
    s_lshl_b32 s57, s57, 7
    s_lshl_b32 s38, s35, 11
    s_add_u32 s57, s57, s38
    s_mul_i32 s38, s33, 5
    s_add_u32 s38, s38, s34
    s_lshl_b32 s38, s38, 3
    s_add_u32 s57, s57, s38
    s_waitcnt vmcnt(0)
    s_cmp_eq_u32 s33, 2
    s_movk_i32 s38, 576
    s_cselect_b32 s38, 288, s38
    s_cselect_b64 s[94:95], -1, 0
    v_and_b32 v228, 15, v1
    v_mul_lo_u32 v228, v228, s38
    v_lshrrev_b32 v229, 4, v1
    v_and_b32 v230, 1, v229
    v_cndmask_b32 v229, v229, v230, s[94:95]
    v_mul_u32_u24 v229, 144, v229
    v_add3_u32 v228, v228, v229, s58
    ds_read_b128 v[100:103], v228 offset:8192
    ds_read_b128 v[104:107], v228 offset:8208
    ds_read_b128 v[108:111], v228 offset:8224
    ds_read_b128 v[112:115], v228 offset:8240
    ds_read_b128 v[116:119], v228 offset:8256
    ds_read_b128 v[120:123], v228 offset:8272
    ds_read_b128 v[124:127], v228 offset:8288
    ds_read_b128 v[128:131], v228 offset:8304
    ds_read_b128 v[132:135], v228 offset:8320
    s_lshl_b32 s39, s36, 2
    s_and_b32 s38, s37, 2
    s_add_u32 s39, s39, s38
    s_mul_i32 s39, s39, 117760
    s_mul_i32 s38, s35, 1884160
    s_add_u32 s39, s39, s38
    s_add_u32 s39, s39, 10485760
    s_add_u32 s76, s26, s39
    s_addc_u32 s77, s27, 0
    s_mov_b32 s78, 235520
    s_mov_b32 s79, 0x00020000
    s_mul_i32 s36, s33, 46080
    s_lshl_b32 s38, s34, 10
    s_add_u32 s36, s36, s38
    s_and_b32 s38, s37, 1
    s_mul_i32 s38, s38, 117760
    s_add_u32 s36, s36, s38
    v_lshlrev_b32 v229, 4, v1
    s_waitcnt lgkmcnt(0)
    s_mov_b32 s38, 0x07060100
    s_mov_b32 s39, 0x05040302
    s_cmp_eq_u32 s33, 2
    s_cbranch_scc1 L_rpB
    v_perm_b32 v136, v105, v100, s39
    v_perm_b32 v137, v114, v109, s39
    v_perm_b32 v138, v123, v118, s39
    v_perm_b32 v139, v132, v127, s39
    s_add_u32 s40, s36, 0
    buffer_store_dwordx4 v[136:139], v229, s[76:79], s40 offen sc1
    v_perm_b32 v140, v104, v100, s38
    v_perm_b32 v141, v113, v109, s38
    v_perm_b32 v142, v122, v118, s38
    v_perm_b32 v143, v131, v127, s38
    s_add_u32 s40, s36, 5120
    buffer_store_dwordx4 v[140:143], v229, s[76:79], s40 offen sc1
    v_perm_b32 v144, v105, v101, s38
    v_perm_b32 v145, v114, v110, s38
    v_perm_b32 v146, v123, v119, s38
    v_perm_b32 v147, v132, v128, s38
    s_add_u32 s40, s36, 10240
    buffer_store_dwordx4 v[144:147], v229, s[76:79], s40 offen sc1
    v_perm_b32 v136, v106, v102, s38
    v_perm_b32 v137, v115, v111, s38
    v_perm_b32 v138, v124, v120, s38
    v_perm_b32 v139, v133, v129, s38
    s_add_u32 s40, s36, 15360
    buffer_store_dwordx4 v[136:139], v229, s[76:79], s40 offen sc1
    v_perm_b32 v140, v106, v101, s39
    v_perm_b32 v141, v115, v110, s39
    v_perm_b32 v142, v124, v119, s39
    v_perm_b32 v143, v133, v128, s39
    s_add_u32 s40, s36, 20480
    buffer_store_dwordx4 v[140:143], v229, s[76:79], s40 offen sc1
    v_perm_b32 v144, v107, v102, s39
    v_perm_b32 v145, v116, v111, s39
    v_perm_b32 v146, v125, v120, s39
    v_perm_b32 v147, v134, v129, s39
    s_add_u32 s40, s36, 25600
    buffer_store_dwordx4 v[144:147], v229, s[76:79], s40 offen sc1
    v_perm_b32 v136, v108, v103, s39
    v_perm_b32 v137, v117, v112, s39
    v_perm_b32 v138, v126, v121, s39
    v_perm_b32 v139, v135, v130, s39
    s_add_u32 s40, s36, 30720
    buffer_store_dwordx4 v[136:139], v229, s[76:79], s40 offen sc1
    v_perm_b32 v140, v107, v103, s38
    v_perm_b32 v141, v116, v112, s38
    v_perm_b32 v142, v125, v121, s38
    v_perm_b32 v143, v134, v130, s38
    s_add_u32 s40, s36, 35840
    buffer_store_dwordx4 v[140:143], v229, s[76:79], s40 offen sc1
    v_perm_b32 v144, v108, v104, s38
    v_perm_b32 v145, v117, v113, s38
    v_perm_b32 v146, v126, v122, s38
    v_perm_b32 v147, v135, v131, s38
    s_add_u32 s40, s36, 40960
    buffer_store_dwordx4 v[144:147], v229, s[76:79], s40 offen sc1
    s_branch L_rpE
L_rpB:
    s_mov_b32 s94, 0
    s_mov_b32 s95, -1
    v_perm_b32 v136, v104, v100, s38
    v_perm_b32 v137, v113, v109, s38
    v_perm_b32 v138, v122, v118, s38
    v_perm_b32 v139, v131, v127, s38
    v_perm_b32 v144, v105, v100, s39
    v_perm_b32 v145, v114, v109, s39
    v_perm_b32 v146, v123, v118, s39
    v_perm_b32 v147, v132, v127, s39
    v_cndmask_b32 v136, v136, v144, s[94:95]
    v_cndmask_b32 v137, v137, v145, s[94:95]
    v_cndmask_b32 v138, v138, v146, s[94:95]
    v_cndmask_b32 v139, v139, v147, s[94:95]
    s_add_u32 s40, s36, 0
    buffer_store_dwordx4 v[136:139], v229, s[76:79], s40 offen sc1
    v_perm_b32 v140, v106, v101, s39
    v_perm_b32 v141, v115, v110, s39
    v_perm_b32 v142, v124, v119, s39
    v_perm_b32 v143, v133, v128, s39
    v_perm_b32 v144, v106, v102, s38
    v_perm_b32 v145, v115, v111, s38
    v_perm_b32 v146, v124, v120, s38
    v_perm_b32 v147, v133, v129, s38
    v_cndmask_b32 v140, v140, v144, s[94:95]
    v_cndmask_b32 v141, v141, v145, s[94:95]
    v_cndmask_b32 v142, v142, v146, s[94:95]
    v_cndmask_b32 v143, v143, v147, s[94:95]
    s_add_u32 s40, s36, 5120
    buffer_store_dwordx4 v[140:143], v229, s[76:79], s40 offen sc1
    v_perm_b32 v136, v107, v103, s38
    v_perm_b32 v137, v116, v112, s38
    v_perm_b32 v138, v125, v121, s38
    v_perm_b32 v139, v134, v130, s38
    v_perm_b32 v144, v108, v103, s39
    v_perm_b32 v145, v117, v112, s39
    v_perm_b32 v146, v126, v121, s39
    v_perm_b32 v147, v135, v130, s39
    v_cndmask_b32 v136, v136, v144, s[94:95]
    v_cndmask_b32 v137, v137, v145, s[94:95]
    v_cndmask_b32 v138, v138, v146, s[94:95]
    v_cndmask_b32 v139, v139, v147, s[94:95]
    s_add_u32 s40, s36, 10240
    buffer_store_dwordx4 v[136:139], v229, s[76:79], s40 offen sc1
    v_perm_b32 v140, v105, v101, s38
    v_perm_b32 v141, v114, v110, s38
    v_perm_b32 v142, v123, v119, s38
    v_perm_b32 v143, v132, v128, s38
    v_perm_b32 v144, v107, v102, s39
    v_perm_b32 v145, v116, v111, s39
    v_perm_b32 v146, v125, v120, s39
    v_perm_b32 v147, v134, v129, s39
    v_cndmask_b32 v140, v140, v144, s[94:95]
    v_cndmask_b32 v141, v141, v145, s[94:95]
    v_cndmask_b32 v142, v142, v146, s[94:95]
    v_cndmask_b32 v143, v143, v147, s[94:95]
    s_add_u32 s40, s36, 15360
    buffer_store_dwordx4 v[140:143], v229, s[76:79], s40 offen sc1
    v_perm_b32 v136, v108, v104, s38
    v_perm_b32 v137, v117, v113, s38
    v_perm_b32 v138, v126, v122, s38
    v_perm_b32 v139, v135, v131, s38
    v_lshrrev_b32 v230, 5, v1
    v_mul_u32_u24 v230, 117760, v230
    v_and_b32 v229, 31, v1
    v_lshl_add_u32 v230, v229, 4, v230
    s_and_b32 s40, s37, 1
    s_lshl_b32 s40, s40, 9
    s_lshl_b32 s38, s34, 10
    s_add_u32 s40, s40, s38
    s_add_u32 s40, s40, 112640
    buffer_store_dwordx4 v[136:139], v230, s[76:79], s40 offen sc1
L_rpE:
    s_branch L_sj_done
L_sj_emb:
    s_mul_i32 s33, s2, 43
    s_lshr_b32 s33, s33, 9
    s_mul_i32 s34, s33, 12
    s_sub_u32 s34, s2, s34
    s_lshl_b32 s35, s33, 7
    s_add_u32 s36, s35, 3840
    s_mov_b32 s76, s14
    s_mov_b32 s77, s15
    s_mov_b32 s78, 737280
    s_mov_b32 s79, 0x00020000
    s_add_u32 s72, s26, 14286848
    s_addc_u32 s73, s27, 0
    s_mov_b32 s74, 30720
    s_mov_b32 s75, 0x00020000
    s_waitcnt vmcnt(12)
    v_lshlrev_b32 v164, 16, v100
    v_lshlrev_b32 v165, 16, v108
    v_and_b32 v166, 0xffff0000, v100
    v_and_b32 v167, 0xffff0000, v108
    v_lshlrev_b32 v168, 16, v101
    v_lshlrev_b32 v169, 16, v109
    v_and_b32 v170, 0xffff0000, v101
    v_and_b32 v171, 0xffff0000, v109
    v_lshlrev_b32 v172, 16, v102
    v_lshlrev_b32 v173, 16, v110
    v_and_b32 v174, 0xffff0000, v102
    v_and_b32 v175, 0xffff0000, v110
    v_lshlrev_b32 v176, 16, v103
    v_lshlrev_b32 v177, 16, v111
    v_and_b32 v178, 0xffff0000, v103
    v_and_b32 v179, 0xffff0000, v111
    v_lshlrev_b32 v180, 16, v104
    v_lshlrev_b32 v181, 16, v112
    v_and_b32 v182, 0xffff0000, v104
    v_and_b32 v183, 0xffff0000, v112
    v_lshlrev_b32 v184, 16, v105
    v_lshlrev_b32 v185, 16, v113
    v_and_b32 v186, 0xffff0000, v105
    v_and_b32 v187, 0xffff0000, v113
    v_mul_f32 v188, 0xbfb8aa3b, v164
    v_mul_f32 v189, 0xbfb8aa3b, v165
    v_mul_f32 v190, 0xbfb8aa3b, v166
    v_mul_f32 v191, 0xbfb8aa3b, v167
    v_mul_f32 v192, 0xbfb8aa3b, v168
    v_mul_f32 v193, 0xbfb8aa3b, v169
    v_mul_f32 v194, 0xbfb8aa3b, v170
    v_mul_f32 v195, 0xbfb8aa3b, v171
    v_mul_f32 v196, 0xbfb8aa3b, v172
    v_mul_f32 v197, 0xbfb8aa3b, v173
    v_mul_f32 v198, 0xbfb8aa3b, v174
    v_mul_f32 v199, 0xbfb8aa3b, v175
    v_exp_f32 v188, v188
    v_exp_f32 v189, v189
    v_exp_f32 v190, v190
    v_exp_f32 v191, v191
    v_exp_f32 v192, v192
    v_exp_f32 v193, v193
    v_exp_f32 v194, v194
    v_exp_f32 v195, v195
    v_exp_f32 v196, v196
    v_exp_f32 v197, v197
    v_exp_f32 v198, v198
    v_exp_f32 v199, v199
    v_add_f32 v188, 1.0, v188
    v_add_f32 v189, 1.0, v189
    v_add_f32 v190, 1.0, v190
    v_add_f32 v191, 1.0, v191
    v_add_f32 v192, 1.0, v192
    v_add_f32 v193, 1.0, v193
    v_add_f32 v194, 1.0, v194
    v_add_f32 v195, 1.0, v195
    v_add_f32 v196, 1.0, v196
    v_add_f32 v197, 1.0, v197
    v_add_f32 v198, 1.0, v198
    v_add_f32 v199, 1.0, v199
    v_rcp_f32 v188, v188
    v_rcp_f32 v189, v189
    v_rcp_f32 v190, v190
    v_rcp_f32 v191, v191
    v_rcp_f32 v192, v192
    v_rcp_f32 v193, v193
    v_rcp_f32 v194, v194
    v_rcp_f32 v195, v195
    v_rcp_f32 v196, v196
    v_rcp_f32 v197, v197
    v_rcp_f32 v198, v198
    v_rcp_f32 v199, v199
    v_mul_f32 v164, v164, v188
    v_mul_f32 v165, v165, v189
    v_mul_f32 v166, v166, v190
    v_mul_f32 v167, v167, v191
    v_mul_f32 v168, v168, v192
    v_mul_f32 v169, v169, v193
    v_mul_f32 v170, v170, v194
    v_mul_f32 v171, v171, v195
    v_mul_f32 v172, v172, v196
    v_mul_f32 v173, v173, v197
    v_mul_f32 v174, v174, v198
    v_mul_f32 v175, v175, v199
    v_mul_f32 v188, 0xbfb8aa3b, v176
    v_mul_f32 v189, 0xbfb8aa3b, v177
    v_mul_f32 v190, 0xbfb8aa3b, v178
    v_mul_f32 v191, 0xbfb8aa3b, v179
    v_mul_f32 v192, 0xbfb8aa3b, v180
    v_mul_f32 v193, 0xbfb8aa3b, v181
    v_mul_f32 v194, 0xbfb8aa3b, v182
    v_mul_f32 v195, 0xbfb8aa3b, v183
    v_mul_f32 v196, 0xbfb8aa3b, v184
    v_mul_f32 v197, 0xbfb8aa3b, v185
    v_mul_f32 v198, 0xbfb8aa3b, v186
    v_mul_f32 v199, 0xbfb8aa3b, v187
    v_exp_f32 v188, v188
    v_exp_f32 v189, v189
    v_exp_f32 v190, v190
    v_exp_f32 v191, v191
    v_exp_f32 v192, v192
    v_exp_f32 v193, v193
    v_exp_f32 v194, v194
    v_exp_f32 v195, v195
    v_exp_f32 v196, v196
    v_exp_f32 v197, v197
    v_exp_f32 v198, v198
    v_exp_f32 v199, v199
    v_add_f32 v188, 1.0, v188
    v_add_f32 v189, 1.0, v189
    v_add_f32 v190, 1.0, v190
    v_add_f32 v191, 1.0, v191
    v_add_f32 v192, 1.0, v192
    v_add_f32 v193, 1.0, v193
    v_add_f32 v194, 1.0, v194
    v_add_f32 v195, 1.0, v195
    v_add_f32 v196, 1.0, v196
    v_add_f32 v197, 1.0, v197
    v_add_f32 v198, 1.0, v198
    v_add_f32 v199, 1.0, v199
    v_rcp_f32 v188, v188
    v_rcp_f32 v189, v189
    v_rcp_f32 v190, v190
    v_rcp_f32 v191, v191
    v_rcp_f32 v192, v192
    v_rcp_f32 v193, v193
    v_rcp_f32 v194, v194
    v_rcp_f32 v195, v195
    v_rcp_f32 v196, v196
    v_rcp_f32 v197, v197
    v_rcp_f32 v198, v198
    v_rcp_f32 v199, v199
    v_mul_f32 v176, v176, v188
    v_mul_f32 v177, v177, v189
    v_mul_f32 v178, v178, v190
    v_mul_f32 v179, v179, v191
    v_mul_f32 v180, v180, v192
    v_mul_f32 v181, v181, v193
    v_mul_f32 v182, v182, v194
    v_mul_f32 v183, v183, v195
    v_mul_f32 v184, v184, v196
    v_mul_f32 v185, v185, v197
    v_mul_f32 v186, v186, v198
    v_mul_f32 v187, v187, v199
    v_mov_b32 v100, 0
    v_mov_b32 v101, 0
    v_mov_b32 v102, 0
    v_mov_b32 v103, 0
    v_mov_b32 v104, 0
    v_mov_b32 v105, 0
    v_mov_b32 v106, 0
    v_mov_b32 v107, 0
    v_mov_b32 v108, 0
    v_mov_b32 v109, 0
    v_mov_b32 v110, 0
    v_mov_b32 v111, 0
    v_mov_b32 v112, 0
    v_mov_b32 v113, 0
    v_mov_b32 v114, 0
    v_mov_b32 v115, 0
    s_waitcnt vmcnt(11)
    v_lshlrev_b32 v188, 16, v116
    v_and_b32 v189, 0xffff0000, v116
    v_pk_fma_f32 v[100:101], v[188:189], v[164:165], v[100:101] op_sel:[0,0,0] op_sel_hi:[1,0,1]
    v_pk_fma_f32 v[108:109], v[188:189], v[164:165], v[108:109] op_sel:[0,1,0] op_sel_hi:[1,1,1]
    v_lshlrev_b32 v190, 16, v117
    v_and_b32 v191, 0xffff0000, v117
    v_pk_fma_f32 v[102:103], v[190:191], v[164:165], v[102:103] op_sel:[0,0,0] op_sel_hi:[1,0,1]
    v_pk_fma_f32 v[110:111], v[190:191], v[164:165], v[110:111] op_sel:[0,1,0] op_sel_hi:[1,1,1]
    v_lshlrev_b32 v188, 16, v118
    v_and_b32 v189, 0xffff0000, v118
    v_pk_fma_f32 v[104:105], v[188:189], v[164:165], v[104:105] op_sel:[0,0,0] op_sel_hi:[1,0,1]
    v_pk_fma_f32 v[112:113], v[188:189], v[164:165], v[112:113] op_sel:[0,1,0] op_sel_hi:[1,1,1]
    v_lshlrev_b32 v190, 16, v119
    v_and_b32 v191, 0xffff0000, v119
    v_pk_fma_f32 v[106:107], v[190:191], v[164:165], v[106:107] op_sel:[0,0,0] op_sel_hi:[1,0,1]
    v_pk_fma_f32 v[114:115], v[190:191], v[164:165], v[114:115] op_sel:[0,1,0] op_sel_hi:[1,1,1]
    s_waitcnt vmcnt(10)
    v_lshlrev_b32 v188, 16, v120
    v_and_b32 v189, 0xffff0000, v120
    v_pk_fma_f32 v[100:101], v[188:189], v[166:167], v[100:101] op_sel:[0,0,0] op_sel_hi:[1,0,1]
    v_pk_fma_f32 v[108:109], v[188:189], v[166:167], v[108:109] op_sel:[0,1,0] op_sel_hi:[1,1,1]
    v_lshlrev_b32 v190, 16, v121
    v_and_b32 v191, 0xffff0000, v121
    v_pk_fma_f32 v[102:103], v[190:191], v[166:167], v[102:103] op_sel:[0,0,0] op_sel_hi:[1,0,1]
    v_pk_fma_f32 v[110:111], v[190:191], v[166:167], v[110:111] op_sel:[0,1,0] op_sel_hi:[1,1,1]
    v_lshlrev_b32 v188, 16, v122
    v_and_b32 v189, 0xffff0000, v122
    v_pk_fma_f32 v[104:105], v[188:189], v[166:167], v[104:105] op_sel:[0,0,0] op_sel_hi:[1,0,1]
    v_pk_fma_f32 v[112:113], v[188:189], v[166:167], v[112:113] op_sel:[0,1,0] op_sel_hi:[1,1,1]
    v_lshlrev_b32 v190, 16, v123
    v_and_b32 v191, 0xffff0000, v123
    v_pk_fma_f32 v[106:107], v[190:191], v[166:167], v[106:107] op_sel:[0,0,0] op_sel_hi:[1,0,1]
    v_pk_fma_f32 v[114:115], v[190:191], v[166:167], v[114:115] op_sel:[0,1,0] op_sel_hi:[1,1,1]
    s_waitcnt vmcnt(9)
    v_lshlrev_b32 v188, 16, v124
    v_and_b32 v189, 0xffff0000, v124
    v_pk_fma_f32 v[100:101], v[188:189], v[168:169], v[100:101] op_sel:[0,0,0] op_sel_hi:[1,0,1]
    v_pk_fma_f32 v[108:109], v[188:189], v[168:169], v[108:109] op_sel:[0,1,0] op_sel_hi:[1,1,1]
    v_lshlrev_b32 v190, 16, v125
    v_and_b32 v191, 0xffff0000, v125
    v_pk_fma_f32 v[102:103], v[190:191], v[168:169], v[102:103] op_sel:[0,0,0] op_sel_hi:[1,0,1]
    v_pk_fma_f32 v[110:111], v[190:191], v[168:169], v[110:111] op_sel:[0,1,0] op_sel_hi:[1,1,1]
    v_lshlrev_b32 v188, 16, v126
    v_and_b32 v189, 0xffff0000, v126
    v_pk_fma_f32 v[104:105], v[188:189], v[168:169], v[104:105] op_sel:[0,0,0] op_sel_hi:[1,0,1]
    v_pk_fma_f32 v[112:113], v[188:189], v[168:169], v[112:113] op_sel:[0,1,0] op_sel_hi:[1,1,1]
    v_lshlrev_b32 v190, 16, v127
    v_and_b32 v191, 0xffff0000, v127
    v_pk_fma_f32 v[106:107], v[190:191], v[168:169], v[106:107] op_sel:[0,0,0] op_sel_hi:[1,0,1]
    v_pk_fma_f32 v[114:115], v[190:191], v[168:169], v[114:115] op_sel:[0,1,0] op_sel_hi:[1,1,1]
    s_waitcnt vmcnt(8)
    v_lshlrev_b32 v188, 16, v128
    v_and_b32 v189, 0xffff0000, v128
    v_pk_fma_f32 v[100:101], v[188:189], v[170:171], v[100:101] op_sel:[0,0,0] op_sel_hi:[1,0,1]
    v_pk_fma_f32 v[108:109], v[188:189], v[170:171], v[108:109] op_sel:[0,1,0] op_sel_hi:[1,1,1]
    v_lshlrev_b32 v190, 16, v129
    v_and_b32 v191, 0xffff0000, v129
    v_pk_fma_f32 v[102:103], v[190:191], v[170:171], v[102:103] op_sel:[0,0,0] op_sel_hi:[1,0,1]
    v_pk_fma_f32 v[110:111], v[190:191], v[170:171], v[110:111] op_sel:[0,1,0] op_sel_hi:[1,1,1]
    v_lshlrev_b32 v188, 16, v130
    v_and_b32 v189, 0xffff0000, v130
    v_pk_fma_f32 v[104:105], v[188:189], v[170:171], v[104:105] op_sel:[0,0,0] op_sel_hi:[1,0,1]
    v_pk_fma_f32 v[112:113], v[188:189], v[170:171], v[112:113] op_sel:[0,1,0] op_sel_hi:[1,1,1]
    v_lshlrev_b32 v190, 16, v131
    v_and_b32 v191, 0xffff0000, v131
    v_pk_fma_f32 v[106:107], v[190:191], v[170:171], v[106:107] op_sel:[0,0,0] op_sel_hi:[1,0,1]
    v_pk_fma_f32 v[114:115], v[190:191], v[170:171], v[114:115] op_sel:[0,1,0] op_sel_hi:[1,1,1]
    s_waitcnt vmcnt(7)
    v_lshlrev_b32 v188, 16, v132
    v_and_b32 v189, 0xffff0000, v132
    v_pk_fma_f32 v[100:101], v[188:189], v[172:173], v[100:101] op_sel:[0,0,0] op_sel_hi:[1,0,1]
    v_pk_fma_f32 v[108:109], v[188:189], v[172:173], v[108:109] op_sel:[0,1,0] op_sel_hi:[1,1,1]
    v_lshlrev_b32 v190, 16, v133
    v_and_b32 v191, 0xffff0000, v133
    v_pk_fma_f32 v[102:103], v[190:191], v[172:173], v[102:103] op_sel:[0,0,0] op_sel_hi:[1,0,1]
    v_pk_fma_f32 v[110:111], v[190:191], v[172:173], v[110:111] op_sel:[0,1,0] op_sel_hi:[1,1,1]
    v_lshlrev_b32 v188, 16, v134
    v_and_b32 v189, 0xffff0000, v134
    v_pk_fma_f32 v[104:105], v[188:189], v[172:173], v[104:105] op_sel:[0,0,0] op_sel_hi:[1,0,1]
    v_pk_fma_f32 v[112:113], v[188:189], v[172:173], v[112:113] op_sel:[0,1,0] op_sel_hi:[1,1,1]
    v_lshlrev_b32 v190, 16, v135
    v_and_b32 v191, 0xffff0000, v135
    v_pk_fma_f32 v[106:107], v[190:191], v[172:173], v[106:107] op_sel:[0,0,0] op_sel_hi:[1,0,1]
    v_pk_fma_f32 v[114:115], v[190:191], v[172:173], v[114:115] op_sel:[0,1,0] op_sel_hi:[1,1,1]
    s_waitcnt vmcnt(6)
    v_lshlrev_b32 v188, 16, v136
    v_and_b32 v189, 0xffff0000, v136
    v_pk_fma_f32 v[100:101], v[188:189], v[174:175], v[100:101] op_sel:[0,0,0] op_sel_hi:[1,0,1]
    v_pk_fma_f32 v[108:109], v[188:189], v[174:175], v[108:109] op_sel:[0,1,0] op_sel_hi:[1,1,1]
    v_lshlrev_b32 v190, 16, v137
    v_and_b32 v191, 0xffff0000, v137
    v_pk_fma_f32 v[102:103], v[190:191], v[174:175], v[102:103] op_sel:[0,0,0] op_sel_hi:[1,0,1]
    v_pk_fma_f32 v[110:111], v[190:191], v[174:175], v[110:111] op_sel:[0,1,0] op_sel_hi:[1,1,1]
    v_lshlrev_b32 v188, 16, v138
    v_and_b32 v189, 0xffff0000, v138
    v_pk_fma_f32 v[104:105], v[188:189], v[174:175], v[104:105] op_sel:[0,0,0] op_sel_hi:[1,0,1]
    v_pk_fma_f32 v[112:113], v[188:189], v[174:175], v[112:113] op_sel:[0,1,0] op_sel_hi:[1,1,1]
    v_lshlrev_b32 v190, 16, v139
    v_and_b32 v191, 0xffff0000, v139
    v_pk_fma_f32 v[106:107], v[190:191], v[174:175], v[106:107] op_sel:[0,0,0] op_sel_hi:[1,0,1]
    v_pk_fma_f32 v[114:115], v[190:191], v[174:175], v[114:115] op_sel:[0,1,0] op_sel_hi:[1,1,1]
    s_waitcnt vmcnt(5)
    v_lshlrev_b32 v188, 16, v140
    v_and_b32 v189, 0xffff0000, v140
    v_pk_fma_f32 v[100:101], v[188:189], v[176:177], v[100:101] op_sel:[0,0,0] op_sel_hi:[1,0,1]
    v_pk_fma_f32 v[108:109], v[188:189], v[176:177], v[108:109] op_sel:[0,1,0] op_sel_hi:[1,1,1]
    v_lshlrev_b32 v190, 16, v141
    v_and_b32 v191, 0xffff0000, v141
    v_pk_fma_f32 v[102:103], v[190:191], v[176:177], v[102:103] op_sel:[0,0,0] op_sel_hi:[1,0,1]
    v_pk_fma_f32 v[110:111], v[190:191], v[176:177], v[110:111] op_sel:[0,1,0] op_sel_hi:[1,1,1]
    v_lshlrev_b32 v188, 16, v142
    v_and_b32 v189, 0xffff0000, v142
    v_pk_fma_f32 v[104:105], v[188:189], v[176:177], v[104:105] op_sel:[0,0,0] op_sel_hi:[1,0,1]
    v_pk_fma_f32 v[112:113], v[188:189], v[176:177], v[112:113] op_sel:[0,1,0] op_sel_hi:[1,1,1]
    v_lshlrev_b32 v190, 16, v143
    v_and_b32 v191, 0xffff0000, v143
    v_pk_fma_f32 v[106:107], v[190:191], v[176:177], v[106:107] op_sel:[0,0,0] op_sel_hi:[1,0,1]
    v_pk_fma_f32 v[114:115], v[190:191], v[176:177], v[114:115] op_sel:[0,1,0] op_sel_hi:[1,1,1]
    s_waitcnt vmcnt(4)
    v_lshlrev_b32 v188, 16, v144
    v_and_b32 v189, 0xffff0000, v144
    v_pk_fma_f32 v[100:101], v[188:189], v[178:179], v[100:101] op_sel:[0,0,0] op_sel_hi:[1,0,1]
    v_pk_fma_f32 v[108:109], v[188:189], v[178:179], v[108:109] op_sel:[0,1,0] op_sel_hi:[1,1,1]
    v_lshlrev_b32 v190, 16, v145
    v_and_b32 v191, 0xffff0000, v145
    v_pk_fma_f32 v[102:103], v[190:191], v[178:179], v[102:103] op_sel:[0,0,0] op_sel_hi:[1,0,1]
    v_pk_fma_f32 v[110:111], v[190:191], v[178:179], v[110:111] op_sel:[0,1,0] op_sel_hi:[1,1,1]
    v_lshlrev_b32 v188, 16, v146
    v_and_b32 v189, 0xffff0000, v146
    v_pk_fma_f32 v[104:105], v[188:189], v[178:179], v[104:105] op_sel:[0,0,0] op_sel_hi:[1,0,1]
    v_pk_fma_f32 v[112:113], v[188:189], v[178:179], v[112:113] op_sel:[0,1,0] op_sel_hi:[1,1,1]
    v_lshlrev_b32 v190, 16, v147
    v_and_b32 v191, 0xffff0000, v147
    v_pk_fma_f32 v[106:107], v[190:191], v[178:179], v[106:107] op_sel:[0,0,0] op_sel_hi:[1,0,1]
    v_pk_fma_f32 v[114:115], v[190:191], v[178:179], v[114:115] op_sel:[0,1,0] op_sel_hi:[1,1,1]
    s_waitcnt vmcnt(3)
    v_lshlrev_b32 v188, 16, v148
    v_and_b32 v189, 0xffff0000, v148
    v_pk_fma_f32 v[100:101], v[188:189], v[180:181], v[100:101] op_sel:[0,0,0] op_sel_hi:[1,0,1]
    v_pk_fma_f32 v[108:109], v[188:189], v[180:181], v[108:109] op_sel:[0,1,0] op_sel_hi:[1,1,1]
    v_lshlrev_b32 v190, 16, v149
    v_and_b32 v191, 0xffff0000, v149
    v_pk_fma_f32 v[102:103], v[190:191], v[180:181], v[102:103] op_sel:[0,0,0] op_sel_hi:[1,0,1]
    v_pk_fma_f32 v[110:111], v[190:191], v[180:181], v[110:111] op_sel:[0,1,0] op_sel_hi:[1,1,1]
    v_lshlrev_b32 v188, 16, v150
    v_and_b32 v189, 0xffff0000, v150
    v_pk_fma_f32 v[104:105], v[188:189], v[180:181], v[104:105] op_sel:[0,0,0] op_sel_hi:[1,0,1]
    v_pk_fma_f32 v[112:113], v[188:189], v[180:181], v[112:113] op_sel:[0,1,0] op_sel_hi:[1,1,1]
    v_lshlrev_b32 v190, 16, v151
    v_and_b32 v191, 0xffff0000, v151
    v_pk_fma_f32 v[106:107], v[190:191], v[180:181], v[106:107] op_sel:[0,0,0] op_sel_hi:[1,0,1]
    v_pk_fma_f32 v[114:115], v[190:191], v[180:181], v[114:115] op_sel:[0,1,0] op_sel_hi:[1,1,1]
    s_waitcnt vmcnt(2)
    v_lshlrev_b32 v188, 16, v152
    v_and_b32 v189, 0xffff0000, v152
    v_pk_fma_f32 v[100:101], v[188:189], v[182:183], v[100:101] op_sel:[0,0,0] op_sel_hi:[1,0,1]
    v_pk_fma_f32 v[108:109], v[188:189], v[182:183], v[108:109] op_sel:[0,1,0] op_sel_hi:[1,1,1]
    v_lshlrev_b32 v190, 16, v153
    v_and_b32 v191, 0xffff0000, v153
    v_pk_fma_f32 v[102:103], v[190:191], v[182:183], v[102:103] op_sel:[0,0,0] op_sel_hi:[1,0,1]
    v_pk_fma_f32 v[110:111], v[190:191], v[182:183], v[110:111] op_sel:[0,1,0] op_sel_hi:[1,1,1]
    v_lshlrev_b32 v188, 16, v154
    v_and_b32 v189, 0xffff0000, v154
    v_pk_fma_f32 v[104:105], v[188:189], v[182:183], v[104:105] op_sel:[0,0,0] op_sel_hi:[1,0,1]
    v_pk_fma_f32 v[112:113], v[188:189], v[182:183], v[112:113] op_sel:[0,1,0] op_sel_hi:[1,1,1]
    v_lshlrev_b32 v190, 16, v155
    v_and_b32 v191, 0xffff0000, v155
    v_pk_fma_f32 v[106:107], v[190:191], v[182:183], v[106:107] op_sel:[0,0,0] op_sel_hi:[1,0,1]
    v_pk_fma_f32 v[114:115], v[190:191], v[182:183], v[114:115] op_sel:[0,1,0] op_sel_hi:[1,1,1]
    s_waitcnt vmcnt(1)
    v_lshlrev_b32 v188, 16, v156
    v_and_b32 v189, 0xffff0000, v156
    v_pk_fma_f32 v[100:101], v[188:189], v[184:185], v[100:101] op_sel:[0,0,0] op_sel_hi:[1,0,1]
    v_pk_fma_f32 v[108:109], v[188:189], v[184:185], v[108:109] op_sel:[0,1,0] op_sel_hi:[1,1,1]
    v_lshlrev_b32 v190, 16, v157
    v_and_b32 v191, 0xffff0000, v157
    v_pk_fma_f32 v[102:103], v[190:191], v[184:185], v[102:103] op_sel:[0,0,0] op_sel_hi:[1,0,1]
    v_pk_fma_f32 v[110:111], v[190:191], v[184:185], v[110:111] op_sel:[0,1,0] op_sel_hi:[1,1,1]
    v_lshlrev_b32 v188, 16, v158
    v_and_b32 v189, 0xffff0000, v158
    v_pk_fma_f32 v[104:105], v[188:189], v[184:185], v[104:105] op_sel:[0,0,0] op_sel_hi:[1,0,1]
    v_pk_fma_f32 v[112:113], v[188:189], v[184:185], v[112:113] op_sel:[0,1,0] op_sel_hi:[1,1,1]
    v_lshlrev_b32 v190, 16, v159
    v_and_b32 v191, 0xffff0000, v159
    v_pk_fma_f32 v[106:107], v[190:191], v[184:185], v[106:107] op_sel:[0,0,0] op_sel_hi:[1,0,1]
    v_pk_fma_f32 v[114:115], v[190:191], v[184:185], v[114:115] op_sel:[0,1,0] op_sel_hi:[1,1,1]
    s_waitcnt vmcnt(0)
    v_lshlrev_b32 v188, 16, v160
    v_and_b32 v189, 0xffff0000, v160
    v_pk_fma_f32 v[100:101], v[188:189], v[186:187], v[100:101] op_sel:[0,0,0] op_sel_hi:[1,0,1]
    v_pk_fma_f32 v[108:109], v[188:189], v[186:187], v[108:109] op_sel:[0,1,0] op_sel_hi:[1,1,1]
    v_lshlrev_b32 v190, 16, v161
    v_and_b32 v191, 0xffff0000, v161
    v_pk_fma_f32 v[102:103], v[190:191], v[186:187], v[102:103] op_sel:[0,0,0] op_sel_hi:[1,0,1]
    v_pk_fma_f32 v[110:111], v[190:191], v[186:187], v[110:111] op_sel:[0,1,0] op_sel_hi:[1,1,1]
    v_lshlrev_b32 v188, 16, v162
    v_and_b32 v189, 0xffff0000, v162
    v_pk_fma_f32 v[104:105], v[188:189], v[186:187], v[104:105] op_sel:[0,0,0] op_sel_hi:[1,0,1]
    v_pk_fma_f32 v[112:113], v[188:189], v[186:187], v[112:113] op_sel:[0,1,0] op_sel_hi:[1,1,1]
    v_lshlrev_b32 v190, 16, v163
    v_and_b32 v191, 0xffff0000, v163
    v_pk_fma_f32 v[106:107], v[190:191], v[186:187], v[106:107] op_sel:[0,0,0] op_sel_hi:[1,0,1]
    v_pk_fma_f32 v[114:115], v[190:191], v[186:187], v[114:115] op_sel:[0,1,0] op_sel_hi:[1,1,1]
    v_permlane32_swap_b32 v100, v108
    v_permlane32_swap_b32 v101, v109
    v_permlane32_swap_b32 v102, v110
    v_permlane32_swap_b32 v103, v111
    v_permlane32_swap_b32 v104, v112
    v_permlane32_swap_b32 v105, v113
    v_permlane32_swap_b32 v106, v114
    v_permlane32_swap_b32 v107, v115
    v_add_f32 v100, v100, v108
    v_add_f32 v101, v101, v109
    v_add_f32 v102, v102, v110
    v_add_f32 v103, v103, v111
    v_add_f32 v104, v104, v112
    v_add_f32 v105, v105, v113
    v_add_f32 v106, v106, v114
    v_add_f32 v107, v107, v115
    v_permlane16_swap_b32 v100, v104
    v_permlane16_swap_b32 v101, v105
    v_permlane16_swap_b32 v102, v106
    v_permlane16_swap_b32 v103, v107
    v_add_f32 v100, v100, v104
    v_add_f32 v101, v101, v105
    v_add_f32 v102, v102, v106
    v_add_f32 v103, v103, v107
    v_add_f32_dpp v100, v100, v100 row_ror:8 row_mask:0xf bank_mask:0xf
    v_add_f32_dpp v101, v101, v101 row_ror:8 row_mask:0xf bank_mask:0xf
    v_add_f32_dpp v102, v102, v102 row_ror:8 row_mask:0xf bank_mask:0xf
    v_add_f32_dpp v103, v103, v103 row_ror:8 row_mask:0xf bank_mask:0xf
    v_lshrrev_b32 v228, 5, v1
    v_mul_u32_u24 v228, 1280, v228
    v_bfe_u32 v229, v1, 4, 1
    v_lshl_add_u32 v228, v229, 4, v228
    v_lshl_add_u32 v228, v230, 5, v228
    s_mul_i32 s35, s34, 2560
    s_lshl_b32 s36, s33, 8
    s_add_u32 s35, s35, s36
    s_mov_b32 exec_lo, 0x00ff00ff
    s_mov_b32 exec_hi, 0x00ff00ff
    buffer_store_dwordx4 v[100:103], v228, s[72:75], s35 offen sc1
    s_mov_b64 exec, -1
    s_lshl_b32 s40, s33, 7
    s_lshl_b32 s36, s34, 3
    s_add_u32 s40, s40, s36
    s_add_u32 s40, s40, 4096
    s_mov_b32 s57, s40
    s_branch L_sj_done
L_sj_none:
    s_cmp_eq_u32 s2, 0
    s_cbranch_scc1 L_sj_n0
    s_waitcnt vmcnt(0)
L_sj_n0:
    s_cmp_lg_u32 s28, 1
    s_cbranch_scc1 L_sj_n1
    s_waitcnt vmcnt(1)
    s_branch L_sj_done
L_sj_n1:
    s_waitcnt vmcnt(0)
L_sj_done:
L_e0_pub_done:
    ds_read_b128 v[208:211], v5 offset:5120
    ds_read_b128 v[212:215], v5 offset:5184
    ds_read_b64 v[216:217], v6 offset:5248
    ds_read_b128 v[218:221], v5 offset:5376
    ds_read_b128 v[222:225], v5 offset:5440
    ds_read_b64 v[226:227], v6 offset:5504
    s_waitcnt lgkmcnt(0)
    v_mov_b32 v90, 0xbfb8aa3b
    v_mov_b32 v91, 0xbfb8aa3b
    v_lshlrev_b32 v100, 16, v208
    v_and_b32 v101, 0xffff0000, v208
    v_lshlrev_b32 v102, 16, v209
    v_and_b32 v103, 0xffff0000, v209
    v_lshlrev_b32 v104, 16, v210
    v_and_b32 v105, 0xffff0000, v210
    v_lshlrev_b32 v106, 16, v211
    v_and_b32 v107, 0xffff0000, v211
    v_lshlrev_b32 v108, 16, v212
    v_and_b32 v109, 0xffff0000, v212
    v_lshlrev_b32 v110, 16, v213
    v_and_b32 v111, 0xffff0000, v213
    v_lshlrev_b32 v112, 16, v214
    v_and_b32 v113, 0xffff0000, v214
    v_lshlrev_b32 v114, 16, v215
    v_and_b32 v115, 0xffff0000, v215
    v_lshlrev_b32 v116, 16, v216
    v_and_b32 v117, 0xffff0000, v216
    v_lshlrev_b32 v118, 16, v217
    v_and_b32 v119, 0xffff0000, v217
    v_lshlrev_b32 v120, 16, v218
    v_and_b32 v121, 0xffff0000, v218
    v_lshlrev_b32 v122, 16, v219
    v_and_b32 v123, 0xffff0000, v219
    v_lshlrev_b32 v124, 16, v220
    v_and_b32 v125, 0xffff0000, v220
    v_lshlrev_b32 v126, 16, v221
    v_and_b32 v127, 0xffff0000, v221
    v_lshlrev_b32 v128, 16, v222
    v_and_b32 v129, 0xffff0000, v222
    v_lshlrev_b32 v130, 16, v223
    v_and_b32 v131, 0xffff0000, v223
    v_lshlrev_b32 v132, 16, v224
    v_and_b32 v133, 0xffff0000, v224
    v_lshlrev_b32 v134, 16, v225
    v_and_b32 v135, 0xffff0000, v225
    v_lshlrev_b32 v136, 16, v226
    v_and_b32 v137, 0xffff0000, v226
    v_lshlrev_b32 v138, 16, v227
    v_and_b32 v139, 0xffff0000, v227
    v_pk_mul_f32 v[100:101], v[100:101], v[90:91]
    v_pk_mul_f32 v[102:103], v[102:103], v[90:91]
    v_pk_mul_f32 v[104:105], v[104:105], v[90:91]
    v_pk_mul_f32 v[106:107], v[106:107], v[90:91]
    v_pk_mul_f32 v[108:109], v[108:109], v[90:91]
    v_pk_mul_f32 v[110:111], v[110:111], v[90:91]
    v_pk_mul_f32 v[112:113], v[112:113], v[90:91]
    v_pk_mul_f32 v[114:115], v[114:115], v[90:91]
    v_pk_mul_f32 v[116:117], v[116:117], v[90:91]
    v_pk_mul_f32 v[118:119], v[118:119], v[90:91]
    v_pk_mul_f32 v[120:121], v[120:121], v[90:91]
    v_pk_mul_f32 v[122:123], v[122:123], v[90:91]
    v_pk_mul_f32 v[124:125], v[124:125], v[90:91]
    v_pk_mul_f32 v[126:127], v[126:127], v[90:91]
    v_pk_mul_f32 v[128:129], v[128:129], v[90:91]
    v_pk_mul_f32 v[130:131], v[130:131], v[90:91]
    v_pk_mul_f32 v[132:133], v[132:133], v[90:91]
    v_pk_mul_f32 v[134:135], v[134:135], v[90:91]
    v_pk_mul_f32 v[136:137], v[136:137], v[90:91]
    v_pk_mul_f32 v[138:139], v[138:139], v[90:91]
    v_pk_mul_f32 v[36:37], v[36:37], v[100:101]
    v_pk_mul_f32 v[38:39], v[38:39], v[102:103]
    v_pk_mul_f32 v[40:41], v[40:41], v[104:105]
    v_pk_mul_f32 v[42:43], v[42:43], v[106:107]
    v_pk_mul_f32 v[44:45], v[44:45], v[108:109]
    v_pk_mul_f32 v[46:47], v[46:47], v[110:111]
    v_pk_mul_f32 v[48:49], v[48:49], v[112:113]
    v_pk_mul_f32 v[50:51], v[50:51], v[114:115]
    v_pk_mul_f32 v[52:53], v[52:53], v[116:117]
    v_pk_mul_f32 v[54:55], v[54:55], v[118:119]
    v_pk_mul_f32 v[56:57], v[56:57], v[100:101]
    v_pk_mul_f32 v[58:59], v[58:59], v[102:103]
    v_pk_mul_f32 v[60:61], v[60:61], v[104:105]
    v_pk_mul_f32 v[62:63], v[62:63], v[106:107]
    v_pk_mul_f32 v[64:65], v[64:65], v[108:109]
    v_pk_mul_f32 v[66:67], v[66:67], v[110:111]
    v_pk_mul_f32 v[68:69], v[68:69], v[112:113]
    v_pk_mul_f32 v[70:71], v[70:71], v[114:115]
    v_pk_mul_f32 v[72:73], v[72:73], v[116:117]
    v_pk_mul_f32 v[74:75], v[74:75], v[118:119]
    s_mul_i32 s33, s59, 655360
    s_add_u32 s76, s26, s33
    s_addc_u32 s77, s27, 0
    s_mov_b32 s78, 655360
    s_mov_b32 s79, 0x00020000
    s_add_u32 s37, s31, s28
    s_lshl_b32 s37, s37, 6
    s_add_u32 s37, s37, s32
    v_and_b32 v4, 15, v1
    v_add_u32 v4, s37, v4
    v_lshrrev_b32 v5, 4, v1
    v_bfe_u32 v6, v1, 2, 1
    v_lshlrev_b32 v6, 1, v6
    v_xor_b32 v6, v6, v5
    v_lshlrev_b32 v6, 4, v6
    v_lshl_add_u32 v6, v4, 6, v6
    v_lshlrev_b32 v7, 3, v5
    v_lshl_add_u32 v7, v4, 5, v7
    s_mov_b32 s36, 262144
    s_mov_b32 s37, 524288
    s_cmp_eq_u32 s28, 0
    s_cbranch_scc1 L_e0_nose
    s_cmp_eq_u32 s99, 0
    s_cbranch_scc1 L_sp_skip
    s_cmp_eq_u32 s99, 3
    s_cbranch_scc1 L_sp_skip
    s_waitcnt vmcnt(0)
    s_memrealtime s[92:93]
    s_waitcnt lgkmcnt(0)
    s_mul_i32 s97, s93, 0x9e3779b1
    s_add_u32 s97, s97, s92
    s_add_u32 s72, s26, 14278656
    s_addc_u32 s73, s27, 0
    s_mov_b32 s74, 4736
    s_mov_b32 s75, 0x00020000
    s_mov_b32 s3, s92
    v_mov_b32 v228, s92
    v_mov_b32 v229, s97
    s_mov_b64 exec, 1
    buffer_store_dwordx2 v[228:229], v241, s[72:75], s57 offen sc1
    s_mov_b64 exec, -1
L_sp_skip:
    s_cmp_lg_u32 s28, 2
    s_cbranch_scc1 L_sp_skip2
    buffer_load_dwordx2 v[232:233], v241, s[80:83], 0 offen
L_sp_skip2:
L_e0_nose:
    s_mov_b32 s37, 524288
    s_cmp_eq_u32 s28, 0
    s_cbranch_scc1 L_e0_isw0
    s_branch L_e0_wait
L_e0_isw0:
    v_and_b32 v8, 31, v1
    v_lshlrev_b32 v8, 4, v8
    s_sleep 13
    s_mov_b32 s38, 0
    buffer_load_dwordx4 v[140:143], v8, s[84:87], 0 offen sc1
L_e0_poll_loop:
    s_waitcnt vmcnt(0)
    v_cmp_gt_u32 vcc, s96, v141
    v_sub_u32 v143, v143, v141
    v_subrev_u32 v141, s96, v141
    v_cndmask_b32 v9, v252, v253, vcc
    v_cmp_eq_u32 s[94:95], v9, v143
    v_cmp_gt_u32 vcc, 0x10000000, v141
    s_nop 0
    s_and_b64 vcc, vcc, s[94:95]
    s_cmp_eq_u64 vcc, -1
    s_cbranch_scc1 L_e0_poll_ok0
    s_sleep 8
    s_cbranch_scc1 L_e0_poll_ok0
    buffer_load_dwordx4 v[140:143], v8, s[84:87], 0 offen sc1
    s_add_u32 s38, s38, 1
    s_cmp_lt_u32 s38, 2097152
    s_cbranch_scc1 L_e0_poll_loop
    s_waitcnt vmcnt(0)
L_e0_poll_ok0:
    v_mov_b32 v92, v140
    v_mov_b32 v94, v140
    v_mov_b32 v93, v142
L_e0_poll_done:
    s_nop 0
    v_add_f32_dpp v94, v94, v94 quad_perm:[1,0,3,2] row_mask:0xf bank_mask:0xf
    s_nop 1
    v_add_f32_dpp v94, v94, v94 quad_perm:[2,3,0,1] row_mask:0xf bank_mask:0xf
    s_nop 1
    v_add_f32_dpp v94, v94, v94 row_half_mirror row_mask:0xf bank_mask:0xf
    s_nop 1
    v_add_f32_dpp v94, v94, v94 row_mirror row_mask:0xf bank_mask:0xf
    v_mov_b32 v95, v94
    s_nop 1
    v_permlane16_swap_b32 v94, v95
    v_add_f32 v94, v94, v95
    v_mul_f32 v94, 0x3d000000, v94
    v_sub_f32 v92, v92, v94
    v_mul_f32 v92, v92, v92
    v_fmac_f32 v93, 0x46200000, v92
    s_nop 1
    v_add_f32_dpp v93, v93, v93 quad_perm:[1,0,3,2] row_mask:0xf bank_mask:0xf
    s_nop 1
    v_add_f32_dpp v93, v93, v93 quad_perm:[2,3,0,1] row_mask:0xf bank_mask:0xf
    s_nop 1
    v_add_f32_dpp v93, v93, v93 row_half_mirror row_mask:0xf bank_mask:0xf
    s_nop 1
    v_add_f32_dpp v93, v93, v93 row_mirror row_mask:0xf bank_mask:0xf
    v_mov_b32 v95, v93
    s_nop 1
    v_permlane16_swap_b32 v93, v95
    v_add_f32 v93, v93, v95
    v_mov_b32 v95, 0x3727c5ac
    v_fmac_f32 v95, 0x364ccccd, v93
    v_rsq_f32 v95, v95
    v_mov_b32 v96, 1
    ds_write_b96 v240, v[94:96] offset:32
    s_waitcnt lgkmcnt(0)
L_e0_wait:
    s_barrier
    ds_read_b64 v[94:95], v240 offset:32
    s_waitcnt lgkmcnt(0)
    v_sub_f32 v94, s98, v94
    v_mul_f32 v94, v94, v95
    v_pk_fma_f32 v[120:121], v[100:101], v[94:95], v[120:121] op_sel_hi:[1,0,1]
    v_pk_fma_f32 v[122:123], v[102:103], v[94:95], v[122:123] op_sel_hi:[1,0,1]
    v_pk_fma_f32 v[124:125], v[104:105], v[94:95], v[124:125] op_sel_hi:[1,0,1]
    v_pk_fma_f32 v[126:127], v[106:107], v[94:95], v[126:127] op_sel_hi:[1,0,1]
    v_pk_fma_f32 v[128:129], v[108:109], v[94:95], v[128:129] op_sel_hi:[1,0,1]
    v_pk_fma_f32 v[130:131], v[110:111], v[94:95], v[130:131] op_sel_hi:[1,0,1]
    v_pk_fma_f32 v[132:133], v[112:113], v[94:95], v[132:133] op_sel_hi:[1,0,1]
    v_pk_fma_f32 v[134:135], v[114:115], v[94:95], v[134:135] op_sel_hi:[1,0,1]
    v_pk_fma_f32 v[136:137], v[116:117], v[94:95], v[136:137] op_sel_hi:[1,0,1]
    v_pk_fma_f32 v[138:139], v[118:119], v[94:95], v[138:139] op_sel_hi:[1,0,1]
    v_pk_fma_f32 v[36:37], v[36:37], v[94:95], v[120:121] op_sel:[0,1,0] op_sel_hi:[1,1,1]
    v_pk_fma_f32 v[38:39], v[38:39], v[94:95], v[122:123] op_sel:[0,1,0] op_sel_hi:[1,1,1]
    v_pk_fma_f32 v[40:41], v[40:41], v[94:95], v[124:125] op_sel:[0,1,0] op_sel_hi:[1,1,1]
    v_pk_fma_f32 v[42:43], v[42:43], v[94:95], v[126:127] op_sel:[0,1,0] op_sel_hi:[1,1,1]
    v_pk_fma_f32 v[44:45], v[44:45], v[94:95], v[128:129] op_sel:[0,1,0] op_sel_hi:[1,1,1]
    v_pk_fma_f32 v[46:47], v[46:47], v[94:95], v[130:131] op_sel:[0,1,0] op_sel_hi:[1,1,1]
    v_pk_fma_f32 v[48:49], v[48:49], v[94:95], v[132:133] op_sel:[0,1,0] op_sel_hi:[1,1,1]
    v_pk_fma_f32 v[50:51], v[50:51], v[94:95], v[134:135] op_sel:[0,1,0] op_sel_hi:[1,1,1]
    v_pk_fma_f32 v[52:53], v[52:53], v[94:95], v[136:137] op_sel:[0,1,0] op_sel_hi:[1,1,1]
    v_pk_fma_f32 v[54:55], v[54:55], v[94:95], v[138:139] op_sel:[0,1,0] op_sel_hi:[1,1,1]
    v_pk_fma_f32 v[56:57], v[56:57], v[94:95], v[120:121] op_sel:[0,1,0] op_sel_hi:[1,1,1]
    v_pk_fma_f32 v[58:59], v[58:59], v[94:95], v[122:123] op_sel:[0,1,0] op_sel_hi:[1,1,1]
    v_pk_fma_f32 v[60:61], v[60:61], v[94:95], v[124:125] op_sel:[0,1,0] op_sel_hi:[1,1,1]
    v_pk_fma_f32 v[62:63], v[62:63], v[94:95], v[126:127] op_sel:[0,1,0] op_sel_hi:[1,1,1]
    v_pk_fma_f32 v[64:65], v[64:65], v[94:95], v[128:129] op_sel:[0,1,0] op_sel_hi:[1,1,1]
    v_pk_fma_f32 v[66:67], v[66:67], v[94:95], v[130:131] op_sel:[0,1,0] op_sel_hi:[1,1,1]
    v_pk_fma_f32 v[68:69], v[68:69], v[94:95], v[132:133] op_sel:[0,1,0] op_sel_hi:[1,1,1]
    v_pk_fma_f32 v[70:71], v[70:71], v[94:95], v[134:135] op_sel:[0,1,0] op_sel_hi:[1,1,1]
    v_pk_fma_f32 v[72:73], v[72:73], v[94:95], v[136:137] op_sel:[0,1,0] op_sel_hi:[1,1,1]
    v_pk_fma_f32 v[74:75], v[74:75], v[94:95], v[138:139] op_sel:[0,1,0] op_sel_hi:[1,1,1]
    v_exp_f32 v156, v36
    v_exp_f32 v157, v37
    v_exp_f32 v158, v38
    v_exp_f32 v159, v39
    v_exp_f32 v160, v40
    v_exp_f32 v161, v41
    v_exp_f32 v162, v42
    v_exp_f32 v163, v43
    v_pk_fma_f32 v[156:157], v[156:157], v[90:91], v[90:91]
    v_pk_fma_f32 v[158:159], v[158:159], v[90:91], v[90:91]
    v_pk_fma_f32 v[160:161], v[160:161], v[90:91], v[90:91]
    v_pk_fma_f32 v[162:163], v[162:163], v[90:91], v[90:91]
    v_rcp_f32 v156, v156
    v_rcp_f32 v157, v157
    v_rcp_f32 v158, v158
    v_rcp_f32 v159, v159
    v_rcp_f32 v160, v160
    v_rcp_f32 v161, v161
    v_rcp_f32 v162, v162
    v_rcp_f32 v163, v163
    v_pk_mul_f32 v[156:157], v[156:157], v[36:37]
    v_pk_mul_f32 v[158:159], v[158:159], v[38:39]
    v_pk_mul_f32 v[160:161], v[160:161], v[40:41]
    v_pk_mul_f32 v[162:163], v[162:163], v[42:43]
    v_cvt_pk_bf16_f32 v188, v156, v157
    v_cvt_pk_bf16_f32 v189, v158, v159
    v_cvt_pk_bf16_f32 v190, v160, v161
    v_cvt_pk_bf16_f32 v191, v162, v163
    buffer_store_dwordx4 v[188:191], v6, s[76:79], 0 offen offset:0 sc1
    v_exp_f32 v164, v44
    v_exp_f32 v165, v45
    v_exp_f32 v166, v46
    v_exp_f32 v167, v47
    v_exp_f32 v168, v48
    v_exp_f32 v169, v49
    v_exp_f32 v170, v50
    v_exp_f32 v171, v51
    v_exp_f32 v172, v52
    v_exp_f32 v173, v53
    v_exp_f32 v174, v54
    v_exp_f32 v175, v55
    v_pk_fma_f32 v[164:165], v[164:165], v[90:91], v[90:91]
    v_pk_fma_f32 v[166:167], v[166:167], v[90:91], v[90:91]
    v_pk_fma_f32 v[168:169], v[168:169], v[90:91], v[90:91]
    v_pk_fma_f32 v[170:171], v[170:171], v[90:91], v[90:91]
    v_pk_fma_f32 v[172:173], v[172:173], v[90:91], v[90:91]
    v_pk_fma_f32 v[174:175], v[174:175], v[90:91], v[90:91]
    v_rcp_f32 v164, v164
    v_rcp_f32 v165, v165
    v_rcp_f32 v166, v166
    v_rcp_f32 v167, v167
    v_rcp_f32 v168, v168
    v_rcp_f32 v169, v169
    v_rcp_f32 v170, v170
    v_rcp_f32 v171, v171
    v_rcp_f32 v172, v172
    v_rcp_f32 v173, v173
    v_rcp_f32 v174, v174
    v_rcp_f32 v175, v175
    v_pk_mul_f32 v[164:165], v[164:165], v[44:45]
    v_pk_mul_f32 v[166:167], v[166:167], v[46:47]
    v_pk_mul_f32 v[168:169], v[168:169], v[48:49]
    v_pk_mul_f32 v[170:171], v[170:171], v[50:51]
    v_pk_mul_f32 v[172:173], v[172:173], v[52:53]
    v_pk_mul_f32 v[174:175], v[174:175], v[54:55]
    v_cvt_pk_bf16_f32 v192, v164, v165
    v_cvt_pk_bf16_f32 v193, v166, v167
    v_cvt_pk_bf16_f32 v194, v168, v169
    v_cvt_pk_bf16_f32 v195, v170, v171
    v_cvt_pk_bf16_f32 v196, v172, v173
    v_cvt_pk_bf16_f32 v197, v174, v175
    buffer_store_dwordx4 v[192:195], v6, s[76:79], s36 offen offset:0 sc1
    buffer_store_dwordx2 v[196:197], v7, s[76:79], s37 offen offset:0 sc1
    v_exp_f32 v156, v56
    v_exp_f32 v157, v57
    v_exp_f32 v158, v58
    v_exp_f32 v159, v59
    v_exp_f32 v160, v60
    v_exp_f32 v161, v61
    v_exp_f32 v162, v62
    v_exp_f32 v163, v63
    v_pk_fma_f32 v[156:157], v[156:157], v[90:91], v[90:91]
    v_pk_fma_f32 v[158:159], v[158:159], v[90:91], v[90:91]
    v_pk_fma_f32 v[160:161], v[160:161], v[90:91], v[90:91]
    v_pk_fma_f32 v[162:163], v[162:163], v[90:91], v[90:91]
    v_rcp_f32 v156, v156
    v_rcp_f32 v157, v157
    v_rcp_f32 v158, v158
    v_rcp_f32 v159, v159
    v_rcp_f32 v160, v160
    v_rcp_f32 v161, v161
    v_rcp_f32 v162, v162
    v_rcp_f32 v163, v163
    v_pk_mul_f32 v[156:157], v[156:157], v[56:57]
    v_pk_mul_f32 v[158:159], v[158:159], v[58:59]
    v_pk_mul_f32 v[160:161], v[160:161], v[60:61]
    v_pk_mul_f32 v[162:163], v[162:163], v[62:63]
    v_cvt_pk_bf16_f32 v200, v156, v157
    v_cvt_pk_bf16_f32 v201, v158, v159
    v_cvt_pk_bf16_f32 v202, v160, v161
    v_cvt_pk_bf16_f32 v203, v162, v163
    buffer_store_dwordx4 v[200:203], v6, s[76:79], 0 offen offset:1024 sc1
    v_exp_f32 v164, v64
    v_exp_f32 v165, v65
    v_exp_f32 v166, v66
    v_exp_f32 v167, v67
    v_exp_f32 v168, v68
    v_exp_f32 v169, v69
    v_exp_f32 v170, v70
    v_exp_f32 v171, v71
    v_exp_f32 v172, v72
    v_exp_f32 v173, v73
    v_exp_f32 v174, v74
    v_exp_f32 v175, v75
    v_pk_fma_f32 v[164:165], v[164:165], v[90:91], v[90:91]
    v_pk_fma_f32 v[166:167], v[166:167], v[90:91], v[90:91]
    v_pk_fma_f32 v[168:169], v[168:169], v[90:91], v[90:91]
    v_pk_fma_f32 v[170:171], v[170:171], v[90:91], v[90:91]
    v_pk_fma_f32 v[172:173], v[172:173], v[90:91], v[90:91]
    v_pk_fma_f32 v[174:175], v[174:175], v[90:91], v[90:91]
    v_rcp_f32 v164, v164
    v_rcp_f32 v165, v165
    v_rcp_f32 v166, v166
    v_rcp_f32 v167, v167
    v_rcp_f32 v168, v168
    v_rcp_f32 v169, v169
    v_rcp_f32 v170, v170
    v_rcp_f32 v171, v171
    v_rcp_f32 v172, v172
    v_rcp_f32 v173, v173
    v_rcp_f32 v174, v174
    v_rcp_f32 v175, v175
    v_pk_mul_f32 v[164:165], v[164:165], v[64:65]
    v_pk_mul_f32 v[166:167], v[166:167], v[66:67]
    v_pk_mul_f32 v[168:169], v[168:169], v[68:69]
    v_pk_mul_f32 v[170:171], v[170:171], v[70:71]
    v_pk_mul_f32 v[172:173], v[172:173], v[72:73]
    v_pk_mul_f32 v[174:175], v[174:175], v[74:75]
    v_cvt_pk_bf16_f32 v204, v164, v165
    v_cvt_pk_bf16_f32 v205, v166, v167
    v_cvt_pk_bf16_f32 v206, v168, v169
    v_cvt_pk_bf16_f32 v207, v170, v171
    v_cvt_pk_bf16_f32 v208, v172, v173
    v_cvt_pk_bf16_f32 v209, v174, v175
    buffer_store_dwordx4 v[204:207], v6, s[76:79], s36 offen offset:1024 sc1
    buffer_store_dwordx2 v[208:209], v7, s[76:79], s37 offen offset:512 sc1
    s_cmp_lg_u32 s28, 0
    s_cbranch_scc1 L_e0_norep
    s_memrealtime s[92:93]
    s_waitcnt lgkmcnt(0)
    s_mul_i32 s97, s93, 0x9e3779b1
    s_add_u32 s97, s97, s92
    v_mov_b32 v81, s92
    v_mov_b32 v83, s97
    s_mov_b64 exec, 1
    buffer_store_dwordx4 v[80:83], v241, s[84:87], s35 offen sc1
    s_mov_b64 exec, -1
L_e0_norep:
    s_cmp_lg_u32 s28, 2
    s_cbranch_scc1 L_e0_not0
    s_mov_b32 s38, 0
    s_waitcnt vmcnt(6)
    s_branch L_e0_nchk
L_e0_npoll:
    s_waitcnt vmcnt(0)
L_e0_nchk:
    v_or_b32 v8, v232, v233
    s_nop 0
    v_readfirstlane_b32 s94, v8
    s_nop 0
    s_cmp_lg_u32 s94, 0
    s_cbranch_scc1 L_e0_ngot
    buffer_load_dwordx2 v[232:233], v241, s[80:83], 0 offen sc1
    s_add_u32 s38, s38, 1
    s_cmp_lt_u32 s38, 2097152
    s_cbranch_scc1 L_e0_npoll
    v_mov_b32 v232, 1
L_e0_ngot:
    ds_write_b64 v240, v[232:233] offset:64
L_e0_not0:
L_e0_t0w:
    ds_read_b64 v[10:11], v240 offset:64
    s_waitcnt lgkmcnt(0)
    v_or_b32 v8, v10, v11
    s_nop 0
    v_readfirstlane_b32 s94, v8
    s_nop 0
    s_cmp_lg_u32 s94, 0
    s_cbranch_scc1 L_e0_t0w_ok
    s_sleep 2
    s_branch L_e0_t0w
L_e0_t0w_ok:
    v_readfirstlane_b32 s96, v10
    v_readfirstlane_b32 s94, v11
    s_nop 0
    s_mul_i32 s94, s94, 0x9e3779b1
    v_mov_b32 v252, s94
    s_add_u32 s94, s94, 0x9e3779b1
    v_mov_b32 v253, s94
    s_sub_u32 s38, s99, 1
    s_cmp_gt_u32 s38, 1
    s_cbranch_scc1 L_e0_nofix
    s_sub_u32 s38, s3, s96
    s_cmp_lt_u32 s38, 0x10000000
    s_cbranch_scc1 L_e0_nofix
    s_memrealtime s[92:93]
    s_waitcnt lgkmcnt(0)
    s_mul_i32 s97, s93, 0x9e3779b1
    s_add_u32 s97, s97, s92
    s_add_u32 s72, s26, 14278656
    s_addc_u32 s73, s27, 0
    s_mov_b32 s74, 4736
    s_mov_b32 s75, 0x00020000
    s_mov_b32 s3, s92
    v_mov_b32 v228, s92
    v_mov_b32 v229, s97
    s_mov_b64 exec, 1
    buffer_store_dwordx2 v[228:229], v241, s[72:75], s57 offen sc1
    s_mov_b64 exec, -1
L_e0_nofix:
    s_lshl_b32 s33, s29, 11
    s_add_u32 s33, s33, 14270464
    s_add_u32 s84, s26, s33
    s_addc_u32 s85, s27, 0
    s_mov_b32 s86, 2048
    s_mov_b32 s87, 0x00020000
    s_lshr_b32 s34, s31, 2
    s_lshl_b32 s35, s34, 7
    s_add_u32 s35, s35, s32
    s_lshl_b32 s38, s30, 3
    s_add_u32 s35, s35, s38
    v_lshrrev_b32 v4, 3, v1
    v_add_u32 v4, s34, v4
    v_subrev_u32 v4, 1, v4
    v_cmp_lt_u32 s[90:91], 15, v4
    v_and_b32 v5, 7, v1
    v_lshlrev_b32 v5, 3, v5
    v_lshl_add_u32 v4, v4, 7, v5
    s_or_b32 s90, s90, 0xff000000
    s_lshl_b32 s38, 0x111111, s28
    s_orn2_b32 s90, s90, s38
    s_mov_b32 s91, -1
    v_mov_b32 v5, 0x40000000
    v_cndmask_b32 v4, v4, v5, s[90:91]
    s_cmp_lg_u32 s28, 3
    s_cbranch_scc1 L_e0_nofw
    s_add_u32 s72, s26, 14278656
    s_addc_u32 s73, s27, 0
    s_mov_b32 s74, 4736
    s_mov_b32 s75, 0x00020000
    v_lshlrev_b32 v8, 3, v1
    s_lshl_b32 s39, s30, 9
    s_lshl_b32 s40, s30, 7
    s_add_u32 s40, s40, 4096
    s_mov_b32 s38, 0
    buffer_load_dwordx2 v[140:141], v8, s[72:75], s39 offen offset:0 sc1
L_e0_fw_loop:
    s_waitcnt vmcnt(0)
    v_cmp_gt_u32 vcc, s96, v140
    v_sub_u32 v141, v141, v140
    v_subrev_u32 v140, s96, v140
    v_cndmask_b32 v9, v252, v253, vcc
    v_cmp_eq_u32 s[94:95], v9, v141
    v_cmp_gt_u32 vcc, 0x10000000, v140
    s_nop 0
    s_and_b64 vcc, vcc, s[94:95]
    s_or_b32 vcc_lo, vcc_lo, 0x80008000
    s_or_b32 vcc_hi, vcc_hi, 0x80008000
    s_cmp_eq_u64 vcc, -1
    s_cbranch_scc1 L_e0_fw_ok0
    s_sleep 4
    s_cbranch_scc1 L_e0_fw_ok0
    buffer_load_dwordx2 v[140:141], v8, s[72:75], s39 offen offset:0 sc1
    s_add_u32 s38, s38, 1
    s_cmp_lt_u32 s38, 2097152
    s_cbranch_scc1 L_e0_fw_loop
    s_waitcnt vmcnt(0)
L_e0_fw_ok0:
L_e0_fw_done:
L_e0_nofw:
    s_cmp_lg_u32 s28, 0
    s_cbranch_scc1 L_e0_nofw2
    s_add_u32 s72, s26, 14278656
    s_addc_u32 s73, s27, 0
    s_mov_b32 s74, 4736
    s_mov_b32 s75, 0x00020000
    v_lshlrev_b32 v8, 3, v1
    s_lshl_b32 s39, s30, 9
    s_lshl_b32 s40, s30, 7
    s_add_u32 s40, s40, 4096
    s_mov_b32 s38, 0
    buffer_load_dwordx2 v[144:145], v8, s[72:75], s40 offen sc1
L_e0_fx_loop:
    s_waitcnt vmcnt(0)
    v_cmp_gt_u32 vcc, s96, v144
    v_sub_u32 v145, v145, v144
    v_subrev_u32 v144, s96, v144
    v_cndmask_b32 v9, v252, v253, vcc
    v_cmp_eq_u32 s[94:95], v9, v145
    v_cmp_gt_u32 vcc, 0x10000000, v144
    s_nop 0
    s_and_b64 vcc, vcc, s[94:95]
    s_or_b32 vcc_lo, vcc_lo, 0xf000f000
    s_mov_b32 vcc_hi, -1
    s_cmp_eq_u64 vcc, -1
    s_cbranch_scc1 L_e0_fx_ok0
    s_sleep 4
    s_cbranch_scc1 L_e0_fx_ok0
    buffer_load_dwordx2 v[144:145], v8, s[72:75], s40 offen sc1
    s_add_u32 s38, s38, 1
    s_cmp_lt_u32 s38, 2097152
    s_cbranch_scc1 L_e0_fx_loop
    s_waitcnt vmcnt(0)
L_e0_fx_ok0:
L_e0_fx_done:
L_e0_nofw2:
    s_waitcnt vmcnt(0)
    s_barrier
    s_cmp_lg_u32 s28, 1
    s_cbranch_scc1 L_e0_nofl
    s_memrealtime s[92:93]
    s_waitcnt lgkmcnt(0)
    s_mul_i32 s97, s93, 0x9e3779b1
    s_add_u32 s97, s97, s92
    v_mov_b32 v228, s92
    v_mov_b32 v229, s97
    s_mov_b64 exec, 1
    buffer_store_dwordx2 v[228:229], v241, s[84:87], s35 offen sc1
    s_mov_b64 exec, -1
L_e0_nofl:
    s_mov_b32 s57, 0
    buffer_load_dwordx4 a[120:123], v2, s[64:67], s57 offen offset:0 sc1
    buffer_load_dwordx4 a[124:127], v2, s[64:67], s57 offen offset:1024 sc1
    buffer_load_dwordx4 a[128:131], v2, s[64:67], s57 offen offset:2048 sc1
    buffer_load_dwordx4 a[132:135], v2, s[64:67], s57 offen offset:3072 sc1
    buffer_load_dwordx4 a[136:139], v3, s[64:67], s57 offen sc1
    s_mov_b32 s57, 5120
    buffer_load_dwordx4 a[140:143], v2, s[64:67], s57 offen offset:0 sc1
    buffer_load_dwordx4 a[144:147], v2, s[64:67], s57 offen offset:1024 sc1
    buffer_load_dwordx4 a[148:151], v2, s[64:67], s57 offen offset:2048 sc1
    buffer_load_dwordx4 a[152:155], v2, s[64:67], s57 offen offset:3072 sc1
    buffer_load_dwordx4 a[156:159], v3, s[64:67], s57 offen sc1
    s_mov_b32 s57, 10240
    buffer_load_dwordx4 a[160:163], v2, s[64:67], s57 offen offset:0 sc1
    buffer_load_dwordx4 a[164:167], v2, s[64:67], s57 offen offset:1024 sc1
    buffer_load_dwordx4 a[168:171], v2, s[64:67], s57 offen offset:2048 sc1
    buffer_load_dwordx4 a[172:175], v2, s[64:67], s57 offen offset:3072 sc1
    buffer_load_dwordx4 a[176:179], v3, s[64:67], s57 offen sc1
    s_mov_b32 s57, 15360
    buffer_load_dwordx4 a[180:183], v2, s[64:67], s57 offen offset:0 sc1
    buffer_load_dwordx4 a[184:187], v2, s[64:67], s57 offen offset:1024 sc1
    buffer_load_dwordx4 a[188:191], v2, s[64:67], s57 offen offset:2048 sc1
    buffer_load_dwordx4 a[192:195], v2, s[64:67], s57 offen offset:3072 sc1
    buffer_load_dwordx4 a[196:199], v3, s[64:67], s57 offen sc1
L_e0_pre_done:
    s_mov_b32 s38, 0
    buffer_load_dwordx2 v[230:231], v4, s[84:87], 0 offen sc1
L_e0_fa_loop:
    s_waitcnt vmcnt(0)
    v_cmp_gt_u32 vcc, s96, v230
    v_sub_u32 v231, v231, v230
    v_subrev_u32 v230, s96, v230
    v_cndmask_b32 v9, v252, v253, vcc
    v_cmp_eq_u32 s[94:95], v9, v231
    v_cmp_gt_u32 vcc, 0x10000000, v230
    s_nop 0
    s_and_b64 vcc, vcc, s[94:95]
    s_or_b64 vcc, vcc, s[90:91]
    s_cmp_eq_u64 vcc, -1
    s_cbranch_scc1 L_e0_fa_ok0
    s_sleep 2
    s_cbranch_scc1 L_e0_fa_ok0
    buffer_load_dwordx2 v[230:231], v4, s[84:87], 0 offen sc1
    s_add_u32 s38, s38, 1
    s_cmp_lt_u32 s38, 2097152
    s_cbranch_scc1 L_e0_fa_loop
    s_waitcnt vmcnt(0)
L_e0_fa_ok0:
L_e0_fa_done:
L_e0_go2:
    buffer_load_dwordx4 v[188:191], v244, s[60:63], 0 offen sc1
    s_add_u32 m0, s47, 0
    s_add_u32 s35, s41, 0
    buffer_load_dwordx4 v2, s[60:63], s35 offen sc1 lds
    buffer_load_dwordx4 v2, s[60:63], s35 offen offset:1024 sc1 lds
    s_add_u32 m0, s48, 0
    s_add_u32 s35, s42, 0
    buffer_load_dwordx4 v2, s[60:63], s35 offen sc1 lds
    buffer_load_dwordx4 v2, s[60:63], s35 offen offset:1024 sc1 lds
    s_add_u32 m0, s49, 0
    s_add_u32 s35, s43, 0
    buffer_load_dwordx4 v2, s[60:63], s35 offen sc1 lds
    buffer_load_dwordx4 v2, s[60:63], s35 offen offset:1024 sc1 lds
    s_add_u32 m0, s50, 0
    s_add_u32 s35, s44, 0
    buffer_load_dwordx4 v2, s[60:63], s35 offen sc1 lds
    buffer_load_dwordx4 v2, s[60:63], s35 offen offset:1024 sc1 lds
    s_add_u32 m0, s51, 0
    s_add_u32 s35, s45, 0
    buffer_load_dwordx4 v2, s[60:63], s35 offen sc1 lds
    buffer_load_dwordx4 v2, s[60:63], s35 offen offset:1024 sc1 lds
    s_mov_b32 s36, 262144
    buffer_load_dwordx4 v[192:195], v244, s[60:63], s36 offen sc1
    s_waitcnt vmcnt(10)
    ds_read_b128 v[156:159], v13 offset:0
    s_waitcnt lgkmcnt(0)
    v_mfma_f32_16x16x32_bf16 a[0:3], a[120:123], v[156:159], 0
    s_waitcnt vmcnt(9)
    ds_write_b128 v246, v[188:191] offset:6528
    ds_read_b128 v[160:163], v12 offset:0
    s_waitcnt lgkmcnt(0)
    v_mfma_f32_16x16x32_bf16 a[0:3], a[140:143], v[160:163], a[0:3]
    s_mov_b32 s36, 524288
    buffer_load_dwordx4 v[196:199], v245, s[60:63], s36 offen sc1
    v_mfma_f32_16x16x32_bf16 a[4:7], a[124:127], v[156:159], 0
    ds_read_b128 v[164:167], v13 offset:1024
    v_mfma_f32_16x16x32_bf16 a[4:7], a[144:147], v[160:163], a[4:7]
    s_mov_b32 s57, 20480
    v_mfma_f32_16x16x32_bf16 a[8:11], a[128:131], v[156:159], 0
    buffer_load_dwordx4 a[200:203], v2, s[64:67], s57 offen offset:0 sc1
    v_mfma_f32_16x16x32_bf16 a[8:11], a[148:151], v[160:163], a[8:11]
    ds_read_b128 v[168:171], v12 offset:1024
    v_mfma_f32_16x16x32_bf16 a[12:15], a[132:135], v[156:159], 0
    v_mfma_f32_16x16x32_bf16 a[12:15], a[152:155], v[160:163], a[12:15]
    s_waitcnt vmcnt(10)
    ds_read_b128 v[172:175], v16 offset:0
    v_mfma_f32_16x16x32_bf16 a[16:19], a[136:139], v[156:159], 0
    s_waitcnt lgkmcnt(1)
    v_mfma_f32_16x16x32_bf16 a[16:19], a[156:159], v[160:163], a[16:19]
    buffer_load_dwordx4 a[204:207], v2, s[64:67], s57 offen offset:1024 sc1
    v_mfma_f32_16x16x32_bf16 a[20:23], a[120:123], v[164:167], 0
    s_waitcnt vmcnt(10)
    ds_read_b128 v[176:179], v15 offset:0
    v_mfma_f32_16x16x32_bf16 a[20:23], a[140:143], v[168:171], a[20:23]
    v_mfma_f32_16x16x32_bf16 a[24:27], a[124:127], v[164:167], 0
    ds_read_b128 v[180:183], v16 offset:1024
    v_mfma_f32_16x16x32_bf16 a[24:27], a[144:147], v[168:171], a[24:27]
    v_mfma_f32_16x16x32_bf16 a[28:31], a[128:131], v[164:167], 0
    buffer_load_dwordx4 a[208:211], v2, s[64:67], s57 offen offset:2048 sc1
    v_mfma_f32_16x16x32_bf16 a[28:31], a[148:151], v[168:171], a[28:31]
    ds_read_b128 v[184:187], v15 offset:1024
    v_mfma_f32_16x16x32_bf16 a[32:35], a[132:135], v[164:167], 0
    v_mfma_f32_16x16x32_bf16 a[32:35], a[152:155], v[168:171], a[32:35]
    s_waitcnt vmcnt(10)
    ds_read_b128 v[156:159], v19 offset:0
    v_mfma_f32_16x16x32_bf16 a[36:39], a[136:139], v[164:167], 0
    s_waitcnt lgkmcnt(3)
    v_mfma_f32_16x16x32_bf16 a[36:39], a[156:159], v[168:171], a[36:39]
    buffer_load_dwordx4 a[212:215], v2, s[64:67], s57 offen offset:3072 sc1
    v_mfma_f32_16x16x32_bf16 a[40:43], a[120:123], v[172:175], 0
    s_waitcnt vmcnt(10)
    ds_read_b128 v[160:163], v18 offset:0
    v_mfma_f32_16x16x32_bf16 a[40:43], a[140:143], v[176:179], a[40:43]
    v_mfma_f32_16x16x32_bf16 a[44:47], a[124:127], v[172:175], 0
    ds_read_b128 v[164:167], v19 offset:1024
    v_mfma_f32_16x16x32_bf16 a[44:47], a[144:147], v[176:179], a[44:47]
    v_mfma_f32_16x16x32_bf16 a[48:51], a[128:131], v[172:175], 0
    buffer_load_dwordx4 a[216:219], v3, s[64:67], s57 offen sc1
    v_mfma_f32_16x16x32_bf16 a[48:51], a[148:151], v[176:179], a[48:51]
    ds_read_b128 v[168:171], v18 offset:1024
    v_mfma_f32_16x16x32_bf16 a[52:55], a[132:135], v[172:175], 0
    v_mfma_f32_16x16x32_bf16 a[52:55], a[152:155], v[176:179], a[52:55]
    s_mov_b32 s57, 25600
    v_mfma_f32_16x16x32_bf16 a[56:59], a[136:139], v[172:175], 0
    s_waitcnt lgkmcnt(4)
    v_mfma_f32_16x16x32_bf16 a[56:59], a[156:159], v[176:179], a[56:59]
    buffer_load_dwordx4 a[220:223], v2, s[64:67], s57 offen offset:0 sc1
    v_mfma_f32_16x16x32_bf16 a[60:63], a[120:123], v[180:183], 0
    s_waitcnt vmcnt(11)
    ds_read_b128 v[172:175], v22 offset:0
    v_mfma_f32_16x16x32_bf16 a[60:63], a[140:143], v[184:187], a[60:63]
    v_mfma_f32_16x16x32_bf16 a[64:67], a[124:127], v[180:183], 0
    s_waitcnt vmcnt(10)
    ds_read_b128 v[176:179], v21 offset:0
    v_mfma_f32_16x16x32_bf16 a[64:67], a[144:147], v[184:187], a[64:67]
    v_mfma_f32_16x16x32_bf16 a[68:71], a[128:131], v[180:183], 0
    buffer_load_dwordx4 a[224:227], v2, s[64:67], s57 offen offset:1024 sc1
    v_mfma_f32_16x16x32_bf16 a[68:71], a[148:151], v[184:187], a[68:71]
    v_mfma_f32_16x16x32_bf16 a[72:75], a[132:135], v[180:183], 0
    v_mfma_f32_16x16x32_bf16 a[72:75], a[152:155], v[184:187], a[72:75]
    v_mfma_f32_16x16x32_bf16 a[76:79], a[136:139], v[180:183], 0
    s_waitcnt lgkmcnt(4)
    v_mfma_f32_16x16x32_bf16 a[76:79], a[156:159], v[184:187], a[76:79]
    buffer_load_dwordx4 a[228:231], v2, s[64:67], s57 offen offset:2048 sc1
    v_mfma_f32_16x16x32_bf16 a[80:83], a[120:123], v[156:159], 0
    ds_read_b128 v[180:183], v22 offset:1024
    v_mfma_f32_16x16x32_bf16 a[80:83], a[140:143], v[160:163], a[80:83]
    s_mov_b32 s80, s20
    s_mov_b32 s81, s21
    v_mfma_f32_16x16x32_bf16 a[84:87], a[124:127], v[156:159], 0
    ds_read_b128 v[184:187], v21 offset:1024
    v_mfma_f32_16x16x32_bf16 a[84:87], a[144:147], v[160:163], a[84:87]
    v_mfma_f32_16x16x32_bf16 a[88:91], a[128:131], v[156:159], 0
    buffer_load_dwordx4 a[232:235], v2, s[64:67], s57 offen offset:3072 sc1
    v_mfma_f32_16x16x32_bf16 a[88:91], a[148:151], v[160:163], a[88:91]
    s_mov_b32 s82, 1843200
    s_mov_b32 s83, 0x00020000
    v_mfma_f32_16x16x32_bf16 a[92:95], a[132:135], v[156:159], 0
    s_add_u32 s84, s26, 12369920
    s_addc_u32 s85, s27, 0
    v_mfma_f32_16x16x32_bf16 a[92:95], a[152:155], v[160:163], a[92:95]
    s_mov_b32 s86, 1884160
    s_mov_b32 s87, 0x00020000
    v_mfma_f32_16x16x32_bf16 a[96:99], a[136:139], v[156:159], 0
    s_waitcnt lgkmcnt(4)
    v_mfma_f32_16x16x32_bf16 a[96:99], a[156:159], v[160:163], a[96:99]
    v_mfma_f32_16x16x32_bf16 a[100:103], a[120:123], v[164:167], 0
    ds_read_b128 v[156:159], v14 offset:0
    v_mfma_f32_16x16x32_bf16 a[100:103], a[140:143], v[168:171], a[100:103]
    s_mov_b32 s40, 0xffff0000
    v_mfma_f32_16x16x32_bf16 a[104:107], a[124:127], v[164:167], 0
    s_waitcnt vmcnt(12)
    ds_read_b128 v[160:163], v13 offset:2176
    v_mfma_f32_16x16x32_bf16 a[104:107], a[144:147], v[168:171], a[104:107]
    v_mfma_f32_16x16x32_bf16 a[108:111], a[128:131], v[164:167], 0
    buffer_load_dwordx4 a[236:239], v3, s[64:67], s57 offen sc1
    v_mfma_f32_16x16x32_bf16 a[108:111], a[148:151], v[168:171], a[108:111]
    s_add_u32 m0, s52, 0
    s_add_u32 s35, s46, 0
    v_mfma_f32_16x16x32_bf16 a[112:115], a[132:135], v[164:167], 0
    v_mfma_f32_16x16x32_bf16 a[112:115], a[152:155], v[168:171], a[112:115]
    v_mfma_f32_16x16x32_bf16 a[116:119], a[136:139], v[164:167], 0
    s_waitcnt lgkmcnt(4)
    v_mfma_f32_16x16x32_bf16 a[116:119], a[156:159], v[168:171], a[116:119]
    buffer_load_dwordx4 v2, s[60:63], s35 offen sc1 lds
    v_mfma_f32_16x16x32_bf16 v[36:39], a[120:123], v[172:175], 0
    ds_read_b128 v[164:167], v14 offset:1024
    v_mfma_f32_16x16x32_bf16 v[36:39], a[140:143], v[176:179], v[36:39]
    v_mfma_f32_16x16x32_bf16 v[40:43], a[124:127], v[172:175], 0
    s_waitcnt vmcnt(13)
    ds_read_b128 v[168:171], v13 offset:3200
    v_mfma_f32_16x16x32_bf16 v[40:43], a[144:147], v[176:179], v[40:43]
    v_mfma_f32_16x16x32_bf16 v[44:47], a[128:131], v[172:175], 0
    buffer_load_dwordx4 v2, s[60:63], s35 offen offset:1024 sc1 lds
    v_mfma_f32_16x16x32_bf16 v[44:47], a[148:151], v[176:179], v[44:47]
    s_mov_b32 s57, 30720
    v_mfma_f32_16x16x32_bf16 v[48:51], a[132:135], v[172:175], 0
    v_mfma_f32_16x16x32_bf16 v[48:51], a[152:155], v[176:179], v[48:51]
    s_add_u32 m0, s47, 13056
    s_add_u32 s35, s41, 262144
    v_mfma_f32_16x16x32_bf16 v[52:55], a[136:139], v[172:175], 0
    s_waitcnt lgkmcnt(4)
    v_mfma_f32_16x16x32_bf16 v[52:55], a[156:159], v[176:179], v[52:55]
    buffer_load_dwordx4 v2, s[60:63], s35 offen sc1 lds
    v_mfma_f32_16x16x32_bf16 v[56:59], a[120:123], v[180:183], 0
    ds_read_b128 v[172:175], v17 offset:0
    v_mfma_f32_16x16x32_bf16 v[56:59], a[140:143], v[184:187], v[56:59]
    v_mfma_f32_16x16x32_bf16 v[60:63], a[124:127], v[180:183], 0
    ds_read_b128 v[176:179], v16 offset:2176
    v_mfma_f32_16x16x32_bf16 v[60:63], a[144:147], v[184:187], v[60:63]
    v_mfma_f32_16x16x32_bf16 v[64:67], a[128:131], v[180:183], 0
    buffer_load_dwordx4 v[76:79], v2, s[64:67], s57 offen offset:0 sc1
    v_mfma_f32_16x16x32_bf16 v[64:67], a[148:151], v[184:187], v[64:67]
    v_mfma_f32_16x16x32_bf16 v[68:71], a[132:135], v[180:183], 0
    v_mfma_f32_16x16x32_bf16 v[68:71], a[152:155], v[184:187], v[68:71]
    v_mfma_f32_16x16x32_bf16 v[72:75], a[136:139], v[180:183], 0
    s_waitcnt lgkmcnt(4)
    v_mfma_f32_16x16x32_bf16 v[72:75], a[156:159], v[184:187], v[72:75]
    buffer_load_dwordx4 v[80:83], v2, s[64:67], s57 offen offset:1024 sc1
    v_mfma_f32_16x16x32_bf16 a[0:3], a[160:163], v[156:159], a[0:3]
    ds_read_b128 v[180:183], v17 offset:1024
    v_mfma_f32_16x16x32_bf16 a[0:3], a[180:183], v[160:163], a[0:3]
    v_mfma_f32_16x16x32_bf16 a[4:7], a[164:167], v[156:159], a[4:7]
    ds_read_b128 v[184:187], v16 offset:3200
    v_mfma_f32_16x16x32_bf16 a[4:7], a[184:187], v[160:163], a[4:7]
    v_mfma_f32_16x16x32_bf16 a[8:11], a[168:171], v[156:159], a[8:11]
    buffer_load_dwordx4 v[84:87], v2, s[64:67], s57 offen offset:2048 sc1
    v_mfma_f32_16x16x32_bf16 a[8:11], a[188:191], v[160:163], a[8:11]
    v_mfma_f32_16x16x32_bf16 a[12:15], a[172:175], v[156:159], a[12:15]
    v_mfma_f32_16x16x32_bf16 a[12:15], a[192:195], v[160:163], a[12:15]
    v_mfma_f32_16x16x32_bf16 a[16:19], a[176:179], v[156:159], a[16:19]
    s_waitcnt lgkmcnt(4)
    v_mfma_f32_16x16x32_bf16 a[16:19], a[196:199], v[160:163], a[16:19]
    buffer_load_dwordx4 v2, s[60:63], s35 offen offset:1024 sc1 lds
    v_mfma_f32_16x16x32_bf16 a[20:23], a[160:163], v[164:167], a[20:23]
    ds_read_b128 v[156:159], v20 offset:0
    v_mfma_f32_16x16x32_bf16 a[20:23], a[180:183], v[168:171], a[20:23]
    v_mfma_f32_16x16x32_bf16 a[24:27], a[164:167], v[164:167], a[24:27]
    ds_read_b128 v[160:163], v19 offset:2176
    v_mfma_f32_16x16x32_bf16 a[24:27], a[184:187], v[168:171], a[24:27]
    v_mfma_f32_16x16x32_bf16 a[28:31], a[168:171], v[164:167], a[28:31]
    buffer_load_dwordx4 v[88:91], v2, s[64:67], s57 offen offset:3072 sc1
    v_mfma_f32_16x16x32_bf16 a[28:31], a[188:191], v[168:171], a[28:31]
    v_mfma_f32_16x16x32_bf16 a[32:35], a[172:175], v[164:167], a[32:35]
    v_mfma_f32_16x16x32_bf16 a[32:35], a[192:195], v[168:171], a[32:35]
    v_mfma_f32_16x16x32_bf16 a[36:39], a[176:179], v[164:167], a[36:39]
    s_waitcnt lgkmcnt(4)
    v_mfma_f32_16x16x32_bf16 a[36:39], a[196:199], v[168:171], a[36:39]
    buffer_load_dwordx4 v[92:95], v3, s[64:67], s57 offen sc1
    v_mfma_f32_16x16x32_bf16 a[40:43], a[160:163], v[172:175], a[40:43]
    ds_read_b128 v[164:167], v20 offset:1024
    v_mfma_f32_16x16x32_bf16 a[40:43], a[180:183], v[176:179], a[40:43]
    v_mfma_f32_16x16x32_bf16 a[44:47], a[164:167], v[172:175], a[44:47]
    ds_read_b128 v[168:171], v19 offset:3200
    v_mfma_f32_16x16x32_bf16 a[44:47], a[184:187], v[176:179], a[44:47]
    s_add_u32 m0, s48, 13056
    s_add_u32 s35, s42, 262144
    v_mfma_f32_16x16x32_bf16 a[48:51], a[168:171], v[172:175], a[48:51]
    v_mfma_f32_16x16x32_bf16 a[48:51], a[188:191], v[176:179], a[48:51]
    v_mfma_f32_16x16x32_bf16 a[52:55], a[172:175], v[172:175], a[52:55]
    buffer_load_dwordx4 v2, s[60:63], s35 offen sc1 lds
    v_mfma_f32_16x16x32_bf16 a[52:55], a[192:195], v[176:179], a[52:55]
    s_mov_b32 s57, 35840
    v_mfma_f32_16x16x32_bf16 a[56:59], a[176:179], v[172:175], a[56:59]
    s_waitcnt lgkmcnt(4)
    v_mfma_f32_16x16x32_bf16 a[56:59], a[196:199], v[176:179], a[56:59]
    v_mfma_f32_16x16x32_bf16 a[60:63], a[160:163], v[180:183], a[60:63]
    ds_read_b128 v[172:175], v23 offset:0
    v_mfma_f32_16x16x32_bf16 a[60:63], a[180:183], v[184:187], a[60:63]
    buffer_load_dwordx4 v[96:99], v2, s[64:67], s57 offen offset:0 sc1
    v_mfma_f32_16x16x32_bf16 a[64:67], a[164:167], v[180:183], a[64:67]
    ds_read_b128 v[176:179], v22 offset:2176
    v_mfma_f32_16x16x32_bf16 a[64:67], a[184:187], v[184:187], a[64:67]
    v_mfma_f32_16x16x32_bf16 a[68:71], a[168:171], v[180:183], a[68:71]
    v_mfma_f32_16x16x32_bf16 a[68:71], a[188:191], v[184:187], a[68:71]
    v_mfma_f32_16x16x32_bf16 a[72:75], a[172:175], v[180:183], a[72:75]
    buffer_load_dwordx4 v[100:103], v2, s[64:67], s57 offen offset:1024 sc1
    v_mfma_f32_16x16x32_bf16 a[72:75], a[192:195], v[184:187], a[72:75]
    v_mfma_f32_16x16x32_bf16 a[76:79], a[176:179], v[180:183], a[76:79]
    s_waitcnt lgkmcnt(4)
    v_mfma_f32_16x16x32_bf16 a[76:79], a[196:199], v[184:187], a[76:79]
    v_mfma_f32_16x16x32_bf16 a[80:83], a[160:163], v[156:159], a[80:83]
    ds_read_b128 v[180:183], v23 offset:1024
    v_mfma_f32_16x16x32_bf16 a[80:83], a[180:183], v[160:163], a[80:83]
    buffer_load_dwordx4 v[104:107], v2, s[64:67], s57 offen offset:2048 sc1
    v_mfma_f32_16x16x32_bf16 a[84:87], a[164:167], v[156:159], a[84:87]
    ds_read_b128 v[184:187], v22 offset:3200
    v_mfma_f32_16x16x32_bf16 a[84:87], a[184:187], v[160:163], a[84:87]
    v_mfma_f32_16x16x32_bf16 a[88:91], a[168:171], v[156:159], a[88:91]
    v_mfma_f32_16x16x32_bf16 a[88:91], a[188:191], v[160:163], a[88:91]
    v_mfma_f32_16x16x32_bf16 a[92:95], a[172:175], v[156:159], a[92:95]
    buffer_load_dwordx4 v2, s[60:63], s35 offen offset:1024 sc1 lds
    v_mfma_f32_16x16x32_bf16 a[92:95], a[192:195], v[160:163], a[92:95]
    v_mfma_f32_16x16x32_bf16 a[96:99], a[176:179], v[156:159], a[96:99]
    s_waitcnt lgkmcnt(4)
    v_mfma_f32_16x16x32_bf16 a[96:99], a[196:199], v[160:163], a[96:99]
    v_mfma_f32_16x16x32_bf16 a[100:103], a[160:163], v[164:167], a[100:103]
    ds_read_b128 v[156:159], v12 offset:2176
    v_mfma_f32_16x16x32_bf16 a[100:103], a[180:183], v[168:171], a[100:103]
    buffer_load_dwordx4 v[108:111], v2, s[64:67], s57 offen offset:3072 sc1
    v_mfma_f32_16x16x32_bf16 a[104:107], a[164:167], v[164:167], a[104:107]
    ds_read_b128 v[160:163], v14 offset:2176
    v_mfma_f32_16x16x32_bf16 a[104:107], a[184:187], v[168:171], a[104:107]
    v_mfma_f32_16x16x32_bf16 a[108:111], a[168:171], v[164:167], a[108:111]
    v_mfma_f32_16x16x32_bf16 a[108:111], a[188:191], v[168:171], a[108:111]
    v_mfma_f32_16x16x32_bf16 a[112:115], a[172:175], v[164:167], a[112:115]
    buffer_load_dwordx4 v[112:115], v3, s[64:67], s57 offen sc1
    v_mfma_f32_16x16x32_bf16 a[112:115], a[192:195], v[168:171], a[112:115]
    s_mov_b32 s57, 40960
    v_mfma_f32_16x16x32_bf16 a[116:119], a[176:179], v[164:167], a[116:119]
    s_waitcnt lgkmcnt(4)
    v_mfma_f32_16x16x32_bf16 a[116:119], a[196:199], v[168:171], a[116:119]
    v_mfma_f32_16x16x32_bf16 v[36:39], a[160:163], v[172:175], v[36:39]
    ds_read_b128 v[164:167], v12 offset:3200
    v_mfma_f32_16x16x32_bf16 v[36:39], a[180:183], v[176:179], v[36:39]
    s_add_u32 m0, s49, 13056
    s_add_u32 s35, s43, 262144
    buffer_load_dwordx4 v2, s[60:63], s35 offen sc1 lds
    v_mfma_f32_16x16x32_bf16 v[40:43], a[164:167], v[172:175], v[40:43]
    ds_read_b128 v[168:171], v14 offset:3200
    v_mfma_f32_16x16x32_bf16 v[40:43], a[184:187], v[176:179], v[40:43]
    v_mfma_f32_16x16x32_bf16 v[44:47], a[168:171], v[172:175], v[44:47]
    v_mfma_f32_16x16x32_bf16 v[44:47], a[188:191], v[176:179], v[44:47]
    v_mfma_f32_16x16x32_bf16 v[48:51], a[172:175], v[172:175], v[48:51]
    buffer_load_dwordx4 v[116:119], v2, s[64:67], s57 offen offset:0 sc1
    v_mfma_f32_16x16x32_bf16 v[48:51], a[192:195], v[176:179], v[48:51]
    v_mfma_f32_16x16x32_bf16 v[52:55], a[176:179], v[172:175], v[52:55]
    s_waitcnt lgkmcnt(4)
    v_mfma_f32_16x16x32_bf16 v[52:55], a[196:199], v[176:179], v[52:55]
    v_mfma_f32_16x16x32_bf16 v[56:59], a[160:163], v[180:183], v[56:59]
    ds_read_b128 v[172:175], v15 offset:2176
    v_mfma_f32_16x16x32_bf16 v[56:59], a[180:183], v[184:187], v[56:59]
    buffer_load_dwordx4 v[120:123], v2, s[64:67], s57 offen offset:1024 sc1
    v_mfma_f32_16x16x32_bf16 v[60:63], a[164:167], v[180:183], v[60:63]
    ds_read_b128 v[176:179], v17 offset:2176
    v_mfma_f32_16x16x32_bf16 v[60:63], a[184:187], v[184:187], v[60:63]
    v_mfma_f32_16x16x32_bf16 v[64:67], a[168:171], v[180:183], v[64:67]
    v_mfma_f32_16x16x32_bf16 v[64:67], a[188:191], v[184:187], v[64:67]
    v_mfma_f32_16x16x32_bf16 v[68:71], a[172:175], v[180:183], v[68:71]
    v_mfma_f32_16x16x32_bf16 v[68:71], a[192:195], v[184:187], v[68:71]
    v_mfma_f32_16x16x32_bf16 v[72:75], a[176:179], v[180:183], v[72:75]
    s_waitcnt lgkmcnt(4)
    s_waitcnt vmcnt(22)
    v_mfma_f32_16x16x32_bf16 v[72:75], a[196:199], v[184:187], v[72:75]
    buffer_load_dwordx4 v2, s[60:63], s35 offen offset:1024 sc1 lds
    v_mfma_f32_16x16x32_bf16 a[0:3], a[200:203], v[156:159], a[0:3]
    ds_read_b128 v[180:183], v15 offset:3200
    v_mfma_f32_16x16x32_bf16 a[0:3], a[220:223], v[160:163], a[0:3]
    v_mfma_f32_16x16x32_bf16 a[4:7], a[204:207], v[156:159], a[4:7]
    ds_read_b128 v[184:187], v17 offset:3200
    v_mfma_f32_16x16x32_bf16 a[4:7], a[224:227], v[160:163], a[4:7]
    s_waitcnt vmcnt(20)
    v_mfma_f32_16x16x32_bf16 a[8:11], a[208:211], v[156:159], a[8:11]
    buffer_load_dwordx4 v[124:127], v2, s[64:67], s57 offen offset:2048 sc1
    v_mfma_f32_16x16x32_bf16 a[8:11], a[228:231], v[160:163], a[8:11]
    v_mfma_f32_16x16x32_bf16 a[12:15], a[212:215], v[156:159], a[12:15]
    v_mfma_f32_16x16x32_bf16 a[12:15], a[232:235], v[160:163], a[12:15]
    v_mfma_f32_16x16x32_bf16 a[16:19], a[216:219], v[156:159], a[16:19]
    s_waitcnt lgkmcnt(4)
    v_mfma_f32_16x16x32_bf16 a[16:19], a[236:239], v[160:163], a[16:19]
    buffer_load_dwordx4 v[128:131], v2, s[64:67], s57 offen offset:3072 sc1
    v_mfma_f32_16x16x32_bf16 a[20:23], a[200:203], v[164:167], a[20:23]
    ds_read_b128 v[156:159], v18 offset:2176
    v_mfma_f32_16x16x32_bf16 a[20:23], a[220:223], v[168:171], a[20:23]
    v_mfma_f32_16x16x32_bf16 a[24:27], a[204:207], v[164:167], a[24:27]
    ds_read_b128 v[160:163], v20 offset:2176
    v_mfma_f32_16x16x32_bf16 a[24:27], a[224:227], v[168:171], a[24:27]
    v_mfma_f32_16x16x32_bf16 a[28:31], a[208:211], v[164:167], a[28:31]
    buffer_load_dwordx4 v[132:135], v3, s[64:67], s57 offen sc1
    v_mfma_f32_16x16x32_bf16 a[28:31], a[228:231], v[168:171], a[28:31]
    s_add_u32 m0, s50, 13056
    s_add_u32 s35, s44, 262144
    v_mfma_f32_16x16x32_bf16 a[32:35], a[212:215], v[164:167], a[32:35]
    v_mfma_f32_16x16x32_bf16 a[32:35], a[232:235], v[168:171], a[32:35]
    v_mfma_f32_16x16x32_bf16 a[36:39], a[216:219], v[164:167], a[36:39]
    s_waitcnt lgkmcnt(4)
    v_mfma_f32_16x16x32_bf16 a[36:39], a[236:239], v[168:171], a[36:39]
    buffer_load_dwordx4 v2, s[60:63], s35 offen sc1 lds
    v_mfma_f32_16x16x32_bf16 a[40:43], a[200:203], v[172:175], a[40:43]
    ds_read_b128 v[164:167], v18 offset:3200
    v_mfma_f32_16x16x32_bf16 a[40:43], a[220:223], v[176:179], a[40:43]
    v_mfma_f32_16x16x32_bf16 a[44:47], a[204:207], v[172:175], a[44:47]
    ds_read_b128 v[168:171], v20 offset:3200
    v_mfma_f32_16x16x32_bf16 a[44:47], a[224:227], v[176:179], a[44:47]
    s_mov_b32 s57, 46080
    v_mfma_f32_16x16x32_bf16 a[48:51], a[208:211], v[172:175], a[48:51]
    buffer_load_dwordx4 v[136:139], v2, s[64:67], s57 offen offset:0 sc1
    v_mfma_f32_16x16x32_bf16 a[48:51], a[228:231], v[176:179], a[48:51]
    v_mfma_f32_16x16x32_bf16 a[52:55], a[212:215], v[172:175], a[52:55]
    v_mfma_f32_16x16x32_bf16 a[52:55], a[232:235], v[176:179], a[52:55]
    v_mfma_f32_16x16x32_bf16 a[56:59], a[216:219], v[172:175], a[56:59]
    s_waitcnt lgkmcnt(4)
    v_mfma_f32_16x16x32_bf16 a[56:59], a[236:239], v[176:179], a[56:59]
    buffer_load_dwordx4 v[140:143], v2, s[64:67], s57 offen offset:1024 sc1
    v_mfma_f32_16x16x32_bf16 a[60:63], a[200:203], v[180:183], a[60:63]
    ds_read_b128 v[172:175], v21 offset:2176
    v_mfma_f32_16x16x32_bf16 a[60:63], a[220:223], v[184:187], a[60:63]
    v_mfma_f32_16x16x32_bf16 a[64:67], a[204:207], v[180:183], a[64:67]
    ds_read_b128 v[176:179], v23 offset:2176
    v_mfma_f32_16x16x32_bf16 a[64:67], a[224:227], v[184:187], a[64:67]
    v_mfma_f32_16x16x32_bf16 a[68:71], a[208:211], v[180:183], a[68:71]
    buffer_load_dwordx4 v[144:147], v2, s[64:67], s57 offen offset:2048 sc1
    v_mfma_f32_16x16x32_bf16 a[68:71], a[228:231], v[184:187], a[68:71]
    v_mfma_f32_16x16x32_bf16 a[72:75], a[212:215], v[180:183], a[72:75]
    v_mfma_f32_16x16x32_bf16 a[72:75], a[232:235], v[184:187], a[72:75]
    v_mfma_f32_16x16x32_bf16 a[76:79], a[216:219], v[180:183], a[76:79]
    s_waitcnt lgkmcnt(4)
    v_mfma_f32_16x16x32_bf16 a[76:79], a[236:239], v[184:187], a[76:79]
    buffer_load_dwordx4 v2, s[60:63], s35 offen offset:1024 sc1 lds
    v_mfma_f32_16x16x32_bf16 a[80:83], a[200:203], v[156:159], a[80:83]
    ds_read_b128 v[180:183], v21 offset:3200
    v_mfma_f32_16x16x32_bf16 a[80:83], a[220:223], v[160:163], a[80:83]
    v_mfma_f32_16x16x32_bf16 a[84:87], a[204:207], v[156:159], a[84:87]
    ds_read_b128 v[184:187], v23 offset:3200
    v_mfma_f32_16x16x32_bf16 a[84:87], a[224:227], v[160:163], a[84:87]
    v_mfma_f32_16x16x32_bf16 a[88:91], a[208:211], v[156:159], a[88:91]
    buffer_load_dwordx4 v[148:151], v2, s[64:67], s57 offen offset:3072 sc1
    v_mfma_f32_16x16x32_bf16 a[88:91], a[228:231], v[160:163], a[88:91]
    v_mfma_f32_16x16x32_bf16 a[92:95], a[212:215], v[156:159], a[92:95]
    v_mfma_f32_16x16x32_bf16 a[92:95], a[232:235], v[160:163], a[92:95]
    v_mfma_f32_16x16x32_bf16 a[96:99], a[216:219], v[156:159], a[96:99]
    s_waitcnt lgkmcnt(4)
    v_mfma_f32_16x16x32_bf16 a[96:99], a[236:239], v[160:163], a[96:99]
    v_mfma_f32_16x16x32_bf16 a[100:103], a[200:203], v[164:167], a[100:103]
    s_waitcnt vmcnt(28)
    ds_read_b128 v[156:159], v13 offset:4352
    v_mfma_f32_16x16x32_bf16 a[100:103], a[220:223], v[168:171], a[100:103]
    buffer_load_dwordx4 v[152:155], v3, s[64:67], s57 offen sc1
    v_mfma_f32_16x16x32_bf16 a[104:107], a[204:207], v[164:167], a[104:107]
    s_waitcnt vmcnt(28)
    ds_read_b128 v[160:163], v12 offset:4352
    v_mfma_f32_16x16x32_bf16 a[104:107], a[224:227], v[168:171], a[104:107]
    s_add_u32 m0, s51, 13056
    s_add_u32 s35, s45, 262144
    v_mfma_f32_16x16x32_bf16 a[108:111], a[208:211], v[164:167], a[108:111]
    v_mfma_f32_16x16x32_bf16 a[108:111], a[228:231], v[168:171], a[108:111]
    v_mfma_f32_16x16x32_bf16 a[112:115], a[212:215], v[164:167], a[112:115]
    buffer_load_dwordx4 v2, s[60:63], s35 offen sc1 lds
    v_mfma_f32_16x16x32_bf16 a[112:115], a[232:235], v[168:171], a[112:115]
    s_mov_b32 s57, 51200
    v_mfma_f32_16x16x32_bf16 a[116:119], a[216:219], v[164:167], a[116:119]
    s_waitcnt lgkmcnt(4)
    v_mfma_f32_16x16x32_bf16 a[116:119], a[236:239], v[168:171], a[116:119]
    v_mfma_f32_16x16x32_bf16 v[36:39], a[200:203], v[172:175], v[36:39]
    ds_read_b128 v[164:167], v13 offset:5376
    v_mfma_f32_16x16x32_bf16 v[36:39], a[220:223], v[176:179], v[36:39]
    buffer_load_dwordx4 a[120:123], v2, s[64:67], s57 offen offset:0 sc1
    v_mfma_f32_16x16x32_bf16 v[40:43], a[204:207], v[172:175], v[40:43]
    ds_read_b128 v[168:171], v12 offset:5376
    v_mfma_f32_16x16x32_bf16 v[40:43], a[224:227], v[176:179], v[40:43]
    v_mfma_f32_16x16x32_bf16 v[44:47], a[208:211], v[172:175], v[44:47]
    ds_write_b128 v246, v[192:195] offset:19584
    v_mfma_f32_16x16x32_bf16 v[44:47], a[228:231], v[176:179], v[44:47]
    ds_write_b128 v247, v[196:199] offset:0
    v_mfma_f32_16x16x32_bf16 v[48:51], a[212:215], v[172:175], v[48:51]
    buffer_load_dwordx4 a[124:127], v2, s[64:67], s57 offen offset:1024 sc1
    v_mfma_f32_16x16x32_bf16 v[48:51], a[232:235], v[176:179], v[48:51]
    v_mfma_f32_16x16x32_bf16 v[52:55], a[216:219], v[172:175], v[52:55]
    s_waitcnt lgkmcnt(6)
    v_mfma_f32_16x16x32_bf16 v[52:55], a[236:239], v[176:179], v[52:55]
    v_mfma_f32_16x16x32_bf16 v[56:59], a[200:203], v[180:183], v[56:59]
    ds_read_b128 v[172:175], v16 offset:4352
    v_mfma_f32_16x16x32_bf16 v[56:59], a[220:223], v[184:187], v[56:59]
    buffer_load_dwordx4 v2, s[60:63], s35 offen offset:1024 sc1 lds
    v_mfma_f32_16x16x32_bf16 v[60:63], a[204:207], v[180:183], v[60:63]
    ds_read_b128 v[176:179], v15 offset:4352
    v_mfma_f32_16x16x32_bf16 v[60:63], a[224:227], v[184:187], v[60:63]
    v_mfma_f32_16x16x32_bf16 v[64:67], a[208:211], v[180:183], v[64:67]
    v_mfma_f32_16x16x32_bf16 v[64:67], a[228:231], v[184:187], v[64:67]
    v_mfma_f32_16x16x32_bf16 v[68:71], a[212:215], v[180:183], v[68:71]
    buffer_load_dwordx4 a[128:131], v2, s[64:67], s57 offen offset:2048 sc1
    v_mfma_f32_16x16x32_bf16 v[68:71], a[232:235], v[184:187], v[68:71]
    v_mfma_f32_16x16x32_bf16 v[72:75], a[216:219], v[180:183], v[72:75]
    s_waitcnt lgkmcnt(6)
    s_waitcnt vmcnt(23)
    v_mfma_f32_16x16x32_bf16 v[72:75], a[236:239], v[184:187], v[72:75]
    v_mfma_f32_16x16x32_bf16 a[0:3], v[76:79], v[156:159], a[0:3]
    ds_read_b128 v[180:183], v16 offset:5376
    v_mfma_f32_16x16x32_bf16 a[0:3], v[96:99], v[160:163], a[0:3]
    buffer_load_dwordx4 a[132:135], v2, s[64:67], s57 offen offset:3072 sc1
    v_mfma_f32_16x16x32_bf16 a[4:7], v[80:83], v[156:159], a[4:7]
    ds_read_b128 v[184:187], v15 offset:5376
    v_mfma_f32_16x16x32_bf16 a[4:7], v[100:103], v[160:163], a[4:7]
    s_waitcnt vmcnt(20)
    v_mfma_f32_16x16x32_bf16 a[8:11], v[84:87], v[156:159], a[8:11]
    v_lshrrev_b32 v5, 4, v1
    v_and_b32 v4, 15, v1
    v_mfma_f32_16x16x32_bf16 a[8:11], v[104:107], v[160:163], a[8:11]
    v_mul_u32_u24 v4, 2560, v4
    v_lshl_add_u32 v8, v5, 4, v4
    v_mfma_f32_16x16x32_bf16 a[12:15], v[88:91], v[156:159], a[12:15]
    buffer_load_dwordx4 a[136:139], v3, s[64:67], s57 offen sc1
    v_mfma_f32_16x16x32_bf16 a[12:15], v[108:111], v[160:163], a[12:15]
    v_lshl_add_u32 v4, v5, 5, v4
    v_lshlrev_b32 v9, 3, v5
    v_mfma_f32_16x16x32_bf16 a[16:19], v[92:95], v[156:159], a[16:19]
    s_waitcnt lgkmcnt(6)
    s_add_u32 m0, s52, 13056
    s_add_u32 s35, s46, 262144
    v_mfma_f32_16x16x32_bf16 a[16:19], v[112:115], v[160:163], a[16:19]
    v_lshlrev_b32 v5, 4, v5
    v_mfma_f32_16x16x32_bf16 a[20:23], v[76:79], v[164:167], a[20:23]
    ds_read_b128 v[156:159], v19 offset:4352
    v_mfma_f32_16x16x32_bf16 a[20:23], v[96:99], v[168:171], a[20:23]
    buffer_load_dwordx4 v2, s[60:63], s35 offen sc1 lds
    v_mfma_f32_16x16x32_bf16 a[24:27], v[80:83], v[164:167], a[24:27]
    ds_read_b128 v[160:163], v18 offset:4352
    v_mfma_f32_16x16x32_bf16 a[24:27], v[100:103], v[168:171], a[24:27]
    s_mov_b32 s57, 56320
    v_mfma_f32_16x16x32_bf16 a[28:31], v[84:87], v[164:167], a[28:31]
    s_mul_i32 s37, s29, 1280
    s_mul_i32 s38, s30, 320
    v_mfma_f32_16x16x32_bf16 a[28:31], v[104:107], v[168:171], a[28:31]
    s_add_u32 s37, s37, s38
    s_mul_i32 s38, s30, 160
    v_mfma_f32_16x16x32_bf16 a[32:35], v[88:91], v[164:167], a[32:35]
    buffer_load_dwordx4 a[140:143], v2, s[64:67], s57 offen offset:0 sc1
    v_mfma_f32_16x16x32_bf16 a[32:35], v[108:111], v[168:171], a[32:35]
    s_add_u32 s68, s26, 14286848
    s_addc_u32 s69, s27, 0
    v_mfma_f32_16x16x32_bf16 a[36:39], v[92:95], v[164:167], a[36:39]
    s_waitcnt lgkmcnt(4)
    v_mfma_f32_16x16x32_bf16 a[36:39], v[112:115], v[168:171], a[36:39]
    s_mov_b32 s70, 30720
    s_mov_b32 s71, 0x00020000
    v_mfma_f32_16x16x32_bf16 a[40:43], v[76:79], v[172:175], a[40:43]
    ds_read_b128 v[164:167], v19 offset:5376
    v_mfma_f32_16x16x32_bf16 a[40:43], v[96:99], v[176:179], a[40:43]
    s_mov_b32 s72, s16
    s_mov_b32 s73, s17
    v_mfma_f32_16x16x32_bf16 a[44:47], v[80:83], v[172:175], a[44:47]
    ds_read_b128 v[168:171], v18 offset:5376
    v_mfma_f32_16x16x32_bf16 a[44:47], v[100:103], v[176:179], a[44:47]
    v_mfma_f32_16x16x32_bf16 a[48:51], v[84:87], v[172:175], a[48:51]
    buffer_load_dwordx4 a[144:147], v2, s[64:67], s57 offen offset:1024 sc1
    v_mfma_f32_16x16x32_bf16 a[48:51], v[104:107], v[176:179], a[48:51]
    s_mov_b32 s74, 640
    s_mov_b32 s75, 0x00020000
    v_mfma_f32_16x16x32_bf16 a[52:55], v[88:91], v[172:175], a[52:55]
    s_mov_b32 s76, s18
    s_mov_b32 s77, s19
    v_mfma_f32_16x16x32_bf16 a[52:55], v[108:111], v[176:179], a[52:55]
    s_mov_b32 s78, 640
    s_mov_b32 s79, 0x00020000
    v_mfma_f32_16x16x32_bf16 a[56:59], v[92:95], v[172:175], a[56:59]
    s_waitcnt lgkmcnt(4)
    v_mfma_f32_16x16x32_bf16 a[56:59], v[112:115], v[176:179], a[56:59]
    buffer_load_dwordx4 v2, s[60:63], s35 offen offset:1024 sc1 lds
    v_mfma_f32_16x16x32_bf16 a[60:63], v[76:79], v[180:183], a[60:63]
    ds_read_b128 v[172:175], v22 offset:4352
    v_mfma_f32_16x16x32_bf16 a[60:63], v[96:99], v[184:187], a[60:63]
    v_mfma_f32_16x16x32_bf16 a[64:67], v[80:83], v[180:183], a[64:67]
    ds_read_b128 v[176:179], v21 offset:4352
    v_mfma_f32_16x16x32_bf16 a[64:67], v[100:103], v[184:187], a[64:67]
    v_mfma_f32_16x16x32_bf16 a[68:71], v[84:87], v[180:183], a[68:71]
    buffer_load_dwordx4 a[148:151], v2, s[64:67], s57 offen offset:2048 sc1
    v_mfma_f32_16x16x32_bf16 a[68:71], v[104:107], v[184:187], a[68:71]
    v_mfma_f32_16x16x32_bf16 a[72:75], v[88:91], v[180:183], a[72:75]
    v_mfma_f32_16x16x32_bf16 a[72:75], v[108:111], v[184:187], a[72:75]
    v_mfma_f32_16x16x32_bf16 a[76:79], v[92:95], v[180:183], a[76:79]
    s_waitcnt lgkmcnt(4)
    v_mfma_f32_16x16x32_bf16 a[76:79], v[112:115], v[184:187], a[76:79]
    buffer_load_dwordx4 a[152:155], v2, s[64:67], s57 offen offset:3072 sc1
    v_mfma_f32_16x16x32_bf16 a[80:83], v[76:79], v[156:159], a[80:83]
    ds_read_b128 v[180:183], v22 offset:5376
    v_mfma_f32_16x16x32_bf16 a[80:83], v[96:99], v[160:163], a[80:83]
    v_mfma_f32_16x16x32_bf16 a[84:87], v[80:83], v[156:159], a[84:87]
    ds_read_b128 v[184:187], v21 offset:5376
    v_mfma_f32_16x16x32_bf16 a[84:87], v[100:103], v[160:163], a[84:87]
    v_mfma_f32_16x16x32_bf16 a[88:91], v[84:87], v[156:159], a[88:91]
    buffer_load_dwordx4 a[156:159], v3, s[64:67], s57 offen sc1
    v_mfma_f32_16x16x32_bf16 a[88:91], v[104:107], v[160:163], a[88:91]
    s_mov_b32 s57, 61440
    v_mfma_f32_16x16x32_bf16 a[92:95], v[88:91], v[156:159], a[92:95]
    v_mfma_f32_16x16x32_bf16 a[92:95], v[108:111], v[160:163], a[92:95]
    v_mfma_f32_16x16x32_bf16 a[96:99], v[92:95], v[156:159], a[96:99]
    s_waitcnt lgkmcnt(4)
    v_mfma_f32_16x16x32_bf16 a[96:99], v[112:115], v[160:163], a[96:99]
    buffer_load_dwordx4 a[160:163], v2, s[64:67], s57 offen offset:0 sc1
    v_mfma_f32_16x16x32_bf16 a[100:103], v[76:79], v[164:167], a[100:103]
    ds_read_b128 v[156:159], v14 offset:4352
    v_mfma_f32_16x16x32_bf16 a[100:103], v[96:99], v[168:171], a[100:103]
    v_mfma_f32_16x16x32_bf16 a[104:107], v[80:83], v[164:167], a[104:107]
    ds_read_b128 v[160:163], v13 offset:13056
    v_mfma_f32_16x16x32_bf16 a[104:107], v[100:103], v[168:171], a[104:107]
    v_mfma_f32_16x16x32_bf16 a[108:111], v[84:87], v[164:167], a[108:111]
    buffer_load_dwordx4 a[164:167], v2, s[64:67], s57 offen offset:1024 sc1
    v_mfma_f32_16x16x32_bf16 a[108:111], v[104:107], v[168:171], a[108:111]
    v_mfma_f32_16x16x32_bf16 a[112:115], v[88:91], v[164:167], a[112:115]
    v_mfma_f32_16x16x32_bf16 a[112:115], v[108:111], v[168:171], a[112:115]
    v_mfma_f32_16x16x32_bf16 a[116:119], v[92:95], v[164:167], a[116:119]
    s_waitcnt lgkmcnt(4)
    v_mfma_f32_16x16x32_bf16 a[116:119], v[112:115], v[168:171], a[116:119]
    buffer_load_dwordx4 v[188:191], v4, s[68:71], s37 offen offset:0
    v_mfma_f32_16x16x32_bf16 v[36:39], v[76:79], v[172:175], v[36:39]
    ds_read_b128 v[164:167], v14 offset:5376
    v_mfma_f32_16x16x32_bf16 v[36:39], v[96:99], v[176:179], v[36:39]
    v_mfma_f32_16x16x32_bf16 v[40:43], v[80:83], v[172:175], v[40:43]
    ds_read_b128 v[168:171], v13 offset:14080
    v_mfma_f32_16x16x32_bf16 v[40:43], v[100:103], v[176:179], v[40:43]
    v_mfma_f32_16x16x32_bf16 v[44:47], v[84:87], v[172:175], v[44:47]
    buffer_load_dwordx4 v[192:195], v4, s[68:71], s37 offen offset:16
    v_mfma_f32_16x16x32_bf16 v[44:47], v[104:107], v[176:179], v[44:47]
    v_mfma_f32_16x16x32_bf16 v[48:51], v[88:91], v[172:175], v[48:51]
    v_mfma_f32_16x16x32_bf16 v[48:51], v[108:111], v[176:179], v[48:51]
    v_mfma_f32_16x16x32_bf16 v[52:55], v[92:95], v[172:175], v[52:55]
    s_waitcnt lgkmcnt(4)
    v_mfma_f32_16x16x32_bf16 v[52:55], v[112:115], v[176:179], v[52:55]
    buffer_load_dwordx4 v[196:199], v4, s[68:71], s37 offen offset:128
    v_mfma_f32_16x16x32_bf16 v[56:59], v[76:79], v[180:183], v[56:59]
    ds_read_b128 v[172:175], v17 offset:4352
    v_mfma_f32_16x16x32_bf16 v[56:59], v[96:99], v[184:187], v[56:59]
    v_mfma_f32_16x16x32_bf16 v[60:63], v[80:83], v[180:183], v[60:63]
    ds_read_b128 v[176:179], v16 offset:13056
    v_mfma_f32_16x16x32_bf16 v[60:63], v[100:103], v[184:187], v[60:63]
    v_mfma_f32_16x16x32_bf16 v[64:67], v[84:87], v[180:183], v[64:67]
    v_mfma_f32_16x16x32_bf16 v[64:67], v[104:107], v[184:187], v[64:67]
    v_mfma_f32_16x16x32_bf16 v[68:71], v[88:91], v[180:183], v[68:71]
    buffer_load_dwordx4 v[200:203], v4, s[68:71], s37 offen offset:144
    v_mfma_f32_16x16x32_bf16 v[68:71], v[108:111], v[184:187], v[68:71]
    v_mfma_f32_16x16x32_bf16 v[72:75], v[92:95], v[180:183], v[72:75]
    s_waitcnt lgkmcnt(4)
    s_waitcnt vmcnt(24)
    v_mfma_f32_16x16x32_bf16 v[72:75], v[112:115], v[184:187], v[72:75]
    v_mfma_f32_16x16x32_bf16 a[0:3], v[116:119], v[156:159], a[0:3]
    ds_read_b128 v[180:183], v17 offset:5376
    v_mfma_f32_16x16x32_bf16 a[0:3], v[136:139], v[160:163], a[0:3]
    buffer_load_dwordx4 v[204:207], v8, s[68:71], s37 offen offset:256
    v_mfma_f32_16x16x32_bf16 a[4:7], v[120:123], v[156:159], a[4:7]
    ds_read_b128 v[184:187], v16 offset:14080
    v_mfma_f32_16x16x32_bf16 a[4:7], v[140:143], v[160:163], a[4:7]
    s_waitcnt vmcnt(21)
    v_mfma_f32_16x16x32_bf16 a[8:11], v[124:127], v[156:159], a[8:11]
    v_mfma_f32_16x16x32_bf16 a[8:11], v[144:147], v[160:163], a[8:11]
    v_mfma_f32_16x16x32_bf16 a[12:15], v[128:131], v[156:159], a[12:15]
    buffer_load_dwordx4 a[168:171], v2, s[64:67], s57 offen offset:2048 sc1
    v_mfma_f32_16x16x32_bf16 a[12:15], v[148:151], v[160:163], a[12:15]
    s_add_u32 s35, s47, s53
    s_lshr_b32 m0, s35, 1
    s_lshr_b32 s35, s41, 1
    v_mfma_f32_16x16x32_bf16 a[16:19], v[132:135], v[156:159], a[16:19]
    s_waitcnt lgkmcnt(4)
    v_mfma_f32_16x16x32_bf16 a[16:19], v[152:155], v[160:163], a[16:19]
    v_mfma_f32_16x16x32_bf16 a[20:23], v[116:119], v[164:167], a[20:23]
    ds_read_b128 v[156:159], v20 offset:4352
    v_mfma_f32_16x16x32_bf16 a[20:23], v[136:139], v[168:171], a[20:23]
    buffer_load_dwordx4 v255, s[60:63], s35 offen sc1 lds
    v_mfma_f32_16x16x32_bf16 a[24:27], v[120:123], v[164:167], a[24:27]
    ds_read_b128 v[160:163], v19 offset:13056
    v_mfma_f32_16x16x32_bf16 a[24:27], v[140:143], v[168:171], a[24:27]
    v_mfma_f32_16x16x32_bf16 a[28:31], v[124:127], v[164:167], a[28:31]
    v_mfma_f32_16x16x32_bf16 a[28:31], v[144:147], v[168:171], a[28:31]
    v_mfma_f32_16x16x32_bf16 a[32:35], v[128:131], v[164:167], a[32:35]
    buffer_load_dwordx4 a[172:175], v2, s[64:67], s57 offen offset:3072 sc1
    v_mfma_f32_16x16x32_bf16 a[32:35], v[148:151], v[168:171], a[32:35]
    v_mfma_f32_16x16x32_bf16 a[36:39], v[132:135], v[164:167], a[36:39]
    s_waitcnt lgkmcnt(4)
    v_mfma_f32_16x16x32_bf16 a[36:39], v[152:155], v[168:171], a[36:39]
    v_mfma_f32_16x16x32_bf16 a[40:43], v[116:119], v[172:175], a[40:43]
    ds_read_b128 v[164:167], v20 offset:5376
    v_mfma_f32_16x16x32_bf16 a[40:43], v[136:139], v[176:179], a[40:43]
    buffer_load_dwordx4 a[176:179], v3, s[64:67], s57 offen sc1
    v_mfma_f32_16x16x32_bf16 a[44:47], v[120:123], v[172:175], a[44:47]
    ds_read_b128 v[168:171], v19 offset:14080
    v_mfma_f32_16x16x32_bf16 a[44:47], v[140:143], v[176:179], a[44:47]
    s_mov_b32 s57, 66560
    v_mfma_f32_16x16x32_bf16 a[48:51], v[124:127], v[172:175], a[48:51]
    v_mfma_f32_16x16x32_bf16 a[48:51], v[144:147], v[176:179], a[48:51]
    v_mfma_f32_16x16x32_bf16 a[52:55], v[128:131], v[172:175], a[52:55]
    buffer_load_dwordx4 a[180:183], v2, s[64:67], s57 offen offset:0 sc1
    v_mfma_f32_16x16x32_bf16 a[52:55], v[148:151], v[176:179], a[52:55]
    v_mfma_f32_16x16x32_bf16 a[56:59], v[132:135], v[172:175], a[56:59]
    s_waitcnt lgkmcnt(4)
    v_mfma_f32_16x16x32_bf16 a[56:59], v[152:155], v[176:179], a[56:59]
    v_mfma_f32_16x16x32_bf16 a[60:63], v[116:119], v[180:183], a[60:63]
    ds_read_b128 v[172:175], v23 offset:4352
    v_mfma_f32_16x16x32_bf16 a[60:63], v[136:139], v[184:187], a[60:63]
    v_mfma_f32_16x16x32_bf16 a[64:67], v[120:123], v[180:183], a[64:67]
    ds_read_b128 v[176:179], v22 offset:13056
    v_mfma_f32_16x16x32_bf16 a[64:67], v[140:143], v[184:187], a[64:67]
    v_mfma_f32_16x16x32_bf16 a[68:71], v[124:127], v[180:183], a[68:71]
    v_mfma_f32_16x16x32_bf16 a[68:71], v[144:147], v[184:187], a[68:71]
    v_mfma_f32_16x16x32_bf16 a[72:75], v[128:131], v[180:183], a[72:75]
    v_mfma_f32_16x16x32_bf16 a[72:75], v[148:151], v[184:187], a[72:75]
    v_mfma_f32_16x16x32_bf16 a[76:79], v[132:135], v[180:183], a[76:79]
    s_waitcnt lgkmcnt(4)
    v_mfma_f32_16x16x32_bf16 a[76:79], v[152:155], v[184:187], a[76:79]
    buffer_load_dwordx4 a[184:187], v2, s[64:67], s57 offen offset:1024 sc1
    v_mfma_f32_16x16x32_bf16 a[80:83], v[116:119], v[156:159], a[80:83]
    ds_read_b128 v[180:183], v23 offset:5376
    v_mfma_f32_16x16x32_bf16 a[80:83], v[136:139], v[160:163], a[80:83]
    v_mfma_f32_16x16x32_bf16 a[84:87], v[120:123], v[156:159], a[84:87]
    ds_read_b128 v[184:187], v22 offset:14080
    v_mfma_f32_16x16x32_bf16 a[84:87], v[140:143], v[160:163], a[84:87]
    v_mfma_f32_16x16x32_bf16 a[88:91], v[124:127], v[156:159], a[88:91]
    buffer_load_dwordx4 a[188:191], v2, s[64:67], s57 offen offset:2048 sc1
    v_mfma_f32_16x16x32_bf16 a[88:91], v[144:147], v[160:163], a[88:91]
    v_mfma_f32_16x16x32_bf16 a[92:95], v[128:131], v[156:159], a[92:95]
    v_mfma_f32_16x16x32_bf16 a[92:95], v[148:151], v[160:163], a[92:95]
    s_add_u32 s35, s48, s53
    s_lshr_b32 m0, s35, 1
    s_lshr_b32 s35, s42, 1
    v_mfma_f32_16x16x32_bf16 a[96:99], v[132:135], v[156:159], a[96:99]
    s_waitcnt lgkmcnt(4)
    v_mfma_f32_16x16x32_bf16 a[96:99], v[152:155], v[160:163], a[96:99]
    buffer_load_dwordx4 v255, s[60:63], s35 offen sc1 lds
    v_mfma_f32_16x16x32_bf16 a[100:103], v[116:119], v[164:167], a[100:103]
    ds_read_b128 v[156:159], v12 offset:13056
    v_mfma_f32_16x16x32_bf16 a[100:103], v[136:139], v[168:171], a[100:103]
    v_mfma_f32_16x16x32_bf16 a[104:107], v[120:123], v[164:167], a[104:107]
    ds_read_b128 v[160:163], v14 offset:13056
    v_mfma_f32_16x16x32_bf16 a[104:107], v[140:143], v[168:171], a[104:107]
    v_mfma_f32_16x16x32_bf16 a[108:111], v[124:127], v[164:167], a[108:111]
    buffer_load_dwordx4 a[192:195], v2, s[64:67], s57 offen offset:3072 sc1
    v_mfma_f32_16x16x32_bf16 a[108:111], v[144:147], v[168:171], a[108:111]
    v_mfma_f32_16x16x32_bf16 a[112:115], v[128:131], v[164:167], a[112:115]
    v_mfma_f32_16x16x32_bf16 a[112:115], v[148:151], v[168:171], a[112:115]
    v_mfma_f32_16x16x32_bf16 a[116:119], v[132:135], v[164:167], a[116:119]
    s_waitcnt lgkmcnt(4)
    v_mfma_f32_16x16x32_bf16 a[116:119], v[152:155], v[168:171], a[116:119]
    buffer_load_dwordx4 a[196:199], v3, s[64:67], s57 offen sc1
    v_mfma_f32_16x16x32_bf16 v[36:39], v[116:119], v[172:175], v[36:39]
    ds_read_b128 v[164:167], v12 offset:14080
    v_mfma_f32_16x16x32_bf16 v[36:39], v[136:139], v[176:179], v[36:39]
    v_mfma_f32_16x16x32_bf16 v[40:43], v[120:123], v[172:175], v[40:43]
    ds_read_b128 v[168:171], v14 offset:14080
    v_mfma_f32_16x16x32_bf16 v[40:43], v[140:143], v[176:179], v[40:43]
    s_mov_b32 s57, 71680
    v_mfma_f32_16x16x32_bf16 v[44:47], v[124:127], v[172:175], v[44:47]
    buffer_load_dwordx4 v[76:79], v2, s[64:67], s57 offen offset:0 sc1
    v_mfma_f32_16x16x32_bf16 v[44:47], v[144:147], v[176:179], v[44:47]
    v_mfma_f32_16x16x32_bf16 v[48:51], v[128:131], v[172:175], v[48:51]
    v_mfma_f32_16x16x32_bf16 v[48:51], v[148:151], v[176:179], v[48:51]
    v_mfma_f32_16x16x32_bf16 v[52:55], v[132:135], v[172:175], v[52:55]
    s_waitcnt lgkmcnt(4)
    v_mfma_f32_16x16x32_bf16 v[52:55], v[152:155], v[176:179], v[52:55]
    buffer_load_dwordx4 v[80:83], v2, s[64:67], s57 offen offset:1024 sc1
    v_mfma_f32_16x16x32_bf16 v[56:59], v[116:119], v[180:183], v[56:59]
    ds_read_b128 v[172:175], v15 offset:13056
    v_mfma_f32_16x16x32_bf16 v[56:59], v[136:139], v[184:187], v[56:59]
    v_mfma_f32_16x16x32_bf16 v[60:63], v[120:123], v[180:183], v[60:63]
    ds_read_b128 v[176:179], v17 offset:13056
    v_mfma_f32_16x16x32_bf16 v[60:63], v[140:143], v[184:187], v[60:63]
    v_mfma_f32_16x16x32_bf16 v[64:67], v[124:127], v[180:183], v[64:67]
    buffer_load_dwordx4 v[84:87], v2, s[64:67], s57 offen offset:2048 sc1
    v_mfma_f32_16x16x32_bf16 v[64:67], v[144:147], v[184:187], v[64:67]
    v_mfma_f32_16x16x32_bf16 v[68:71], v[128:131], v[180:183], v[68:71]
    v_mfma_f32_16x16x32_bf16 v[68:71], v[148:151], v[184:187], v[68:71]
    v_mfma_f32_16x16x32_bf16 v[72:75], v[132:135], v[180:183], v[72:75]
    s_waitcnt lgkmcnt(4)
    s_waitcnt vmcnt(24)
    v_mfma_f32_16x16x32_bf16 v[72:75], v[152:155], v[184:187], v[72:75]
    buffer_load_dwordx4 v[88:91], v2, s[64:67], s57 offen offset:3072 sc1
    v_mfma_f32_16x16x32_bf16 a[0:3], a[120:123], v[156:159], a[0:3]
    ds_read_b128 v[180:183], v15 offset:14080
    v_mfma_f32_16x16x32_bf16 a[0:3], a[140:143], v[160:163], a[0:3]
    v_mfma_f32_16x16x32_bf16 a[4:7], a[124:127], v[156:159], a[4:7]
    ds_read_b128 v[184:187], v17 offset:14080
    v_mfma_f32_16x16x32_bf16 a[4:7], a[144:147], v[160:163], a[4:7]
    s_waitcnt vmcnt(21)
    v_mfma_f32_16x16x32_bf16 a[8:11], a[128:131], v[156:159], a[8:11]
    buffer_load_dwordx4 v[92:95], v3, s[64:67], s57 offen sc1
    v_mfma_f32_16x16x32_bf16 a[8:11], a[148:151], v[160:163], a[8:11]
    s_mov_b32 s57, 76800
    v_mfma_f32_16x16x32_bf16 a[12:15], a[132:135], v[156:159], a[12:15]
    v_mfma_f32_16x16x32_bf16 a[12:15], a[152:155], v[160:163], a[12:15]
    s_add_u32 s35, s49, s53
    s_lshr_b32 m0, s35, 1
    s_lshr_b32 s35, s43, 1
    v_mfma_f32_16x16x32_bf16 a[16:19], a[136:139], v[156:159], a[16:19]
    s_waitcnt lgkmcnt(4)
    v_mfma_f32_16x16x32_bf16 a[16:19], a[156:159], v[160:163], a[16:19]
    v_mfma_f32_16x16x32_bf16 a[20:23], a[120:123], v[164:167], a[20:23]
    ds_read_b128 v[156:159], v18 offset:13056
    v_mfma_f32_16x16x32_bf16 a[20:23], a[140:143], v[168:171], a[20:23]
    buffer_load_dwordx4 v255, s[60:63], s35 offen sc1 lds
    v_mfma_f32_16x16x32_bf16 a[24:27], a[124:127], v[164:167], a[24:27]
    ds_read_b128 v[160:163], v20 offset:13056
    v_mfma_f32_16x16x32_bf16 a[24:27], a[144:147], v[168:171], a[24:27]
    v_mfma_f32_16x16x32_bf16 a[28:31], a[128:131], v[164:167], a[28:31]
    v_mfma_f32_16x16x32_bf16 a[28:31], a[148:151], v[168:171], a[28:31]
    v_mfma_f32_16x16x32_bf16 a[32:35], a[132:135], v[164:167], a[32:35]
    buffer_load_dwordx4 v[96:99], v2, s[64:67], s57 offen offset:0 sc1
    v_mfma_f32_16x16x32_bf16 a[32:35], a[152:155], v[168:171], a[32:35]
    v_mfma_f32_16x16x32_bf16 a[36:39], a[136:139], v[164:167], a[36:39]
    s_waitcnt lgkmcnt(4)
    v_mfma_f32_16x16x32_bf16 a[36:39], a[156:159], v[168:171], a[36:39]
    v_mfma_f32_16x16x32_bf16 a[40:43], a[120:123], v[172:175], a[40:43]
    ds_read_b128 v[164:167], v18 offset:14080
    v_mfma_f32_16x16x32_bf16 a[40:43], a[140:143], v[176:179], a[40:43]
    buffer_load_dwordx4 v[100:103], v2, s[64:67], s57 offen offset:1024 sc1
    v_mfma_f32_16x16x32_bf16 a[44:47], a[124:127], v[172:175], a[44:47]
    ds_read_b128 v[168:171], v20 offset:14080
    v_mfma_f32_16x16x32_bf16 a[44:47], a[144:147], v[176:179], a[44:47]
    v_mfma_f32_16x16x32_bf16 a[48:51], a[128:131], v[172:175], a[48:51]
    v_mfma_f32_16x16x32_bf16 a[48:51], a[148:151], v[176:179], a[48:51]
    v_mfma_f32_16x16x32_bf16 a[52:55], a[132:135], v[172:175], a[52:55]
    buffer_load_dwordx4 v[104:107], v2, s[64:67], s57 offen offset:2048 sc1
    v_mfma_f32_16x16x32_bf16 a[52:55], a[152:155], v[176:179], a[52:55]
    v_mfma_f32_16x16x32_bf16 a[56:59], a[136:139], v[172:175], a[56:59]
    s_waitcnt lgkmcnt(4)
    v_mfma_f32_16x16x32_bf16 a[56:59], a[156:159], v[176:179], a[56:59]
    v_mfma_f32_16x16x32_bf16 a[60:63], a[120:123], v[180:183], a[60:63]
    ds_read_b128 v[172:175], v21 offset:13056
    v_mfma_f32_16x16x32_bf16 a[60:63], a[140:143], v[184:187], a[60:63]
    buffer_load_dwordx4 v[108:111], v2, s[64:67], s57 offen offset:3072 sc1
    v_mfma_f32_16x16x32_bf16 a[64:67], a[124:127], v[180:183], a[64:67]
    ds_read_b128 v[176:179], v23 offset:13056
    v_mfma_f32_16x16x32_bf16 a[64:67], a[144:147], v[184:187], a[64:67]
    v_mfma_f32_16x16x32_bf16 a[68:71], a[128:131], v[180:183], a[68:71]
    v_mfma_f32_16x16x32_bf16 a[68:71], a[148:151], v[184:187], a[68:71]
    v_mfma_f32_16x16x32_bf16 a[72:75], a[132:135], v[180:183], a[72:75]
    buffer_load_dwordx4 v[112:115], v3, s[64:67], s57 offen sc1
    v_mfma_f32_16x16x32_bf16 a[72:75], a[152:155], v[184:187], a[72:75]
    s_mov_b32 s57, 81920
    v_mfma_f32_16x16x32_bf16 a[76:79], a[136:139], v[180:183], a[76:79]
    s_waitcnt lgkmcnt(4)
    v_mfma_f32_16x16x32_bf16 a[76:79], a[156:159], v[184:187], a[76:79]
    v_mfma_f32_16x16x32_bf16 a[80:83], a[120:123], v[156:159], a[80:83]
    ds_read_b128 v[180:183], v21 offset:14080
    v_mfma_f32_16x16x32_bf16 a[80:83], a[140:143], v[160:163], a[80:83]
    buffer_load_dwordx4 v[116:119], v2, s[64:67], s57 offen offset:0 sc1
    v_mfma_f32_16x16x32_bf16 a[84:87], a[124:127], v[156:159], a[84:87]
    ds_read_b128 v[184:187], v23 offset:14080
    v_mfma_f32_16x16x32_bf16 a[84:87], a[144:147], v[160:163], a[84:87]
    v_mfma_f32_16x16x32_bf16 a[88:91], a[128:131], v[156:159], a[88:91]
    v_mfma_f32_16x16x32_bf16 a[88:91], a[148:151], v[160:163], a[88:91]
    v_mfma_f32_16x16x32_bf16 a[92:95], a[132:135], v[156:159], a[92:95]
    buffer_load_dwordx4 v[120:123], v2, s[64:67], s57 offen offset:1024 sc1
    v_mfma_f32_16x16x32_bf16 a[92:95], a[152:155], v[160:163], a[92:95]
    s_add_u32 s35, s50, s53
    s_lshr_b32 m0, s35, 1
    s_lshr_b32 s35, s44, 1
    v_mfma_f32_16x16x32_bf16 a[96:99], a[136:139], v[156:159], a[96:99]
    s_waitcnt lgkmcnt(4)
    v_mfma_f32_16x16x32_bf16 a[96:99], a[156:159], v[160:163], a[96:99]
    v_mfma_f32_16x16x32_bf16 a[100:103], a[120:123], v[164:167], a[100:103]
    ds_read_b128 v[156:159], v13 offset:15232
    v_mfma_f32_16x16x32_bf16 a[100:103], a[140:143], v[168:171], a[100:103]
    buffer_load_dwordx4 v255, s[60:63], s35 offen sc1 lds
    v_mfma_f32_16x16x32_bf16 a[104:107], a[124:127], v[164:167], a[104:107]
    ds_read_b128 v[160:163], v12 offset:15232
    v_mfma_f32_16x16x32_bf16 a[104:107], a[144:147], v[168:171], a[104:107]
    v_mfma_f32_16x16x32_bf16 a[108:111], a[128:131], v[164:167], a[108:111]
    v_mfma_f32_16x16x32_bf16 a[108:111], a[148:151], v[168:171], a[108:111]
    v_mfma_f32_16x16x32_bf16 a[112:115], a[132:135], v[164:167], a[112:115]
    buffer_load_dwordx4 v[124:127], v2, s[64:67], s57 offen offset:2048 sc1
    v_mfma_f32_16x16x32_bf16 a[112:115], a[152:155], v[168:171], a[112:115]
    v_mfma_f32_16x16x32_bf16 a[116:119], a[136:139], v[164:167], a[116:119]
    s_waitcnt lgkmcnt(4)
    v_mfma_f32_16x16x32_bf16 a[116:119], a[156:159], v[168:171], a[116:119]
    v_mfma_f32_16x16x32_bf16 v[36:39], a[120:123], v[172:175], v[36:39]
    ds_read_b128 v[164:167], v13 offset:16256
    v_mfma_f32_16x16x32_bf16 v[36:39], a[140:143], v[176:179], v[36:39]
    s_waitcnt vmcnt(25)
    v_mfma_f32_16x16x32_bf16 v[40:43], a[124:127], v[172:175], v[40:43]
    ds_read_b128 v[168:171], v12 offset:16256
    v_mfma_f32_16x16x32_bf16 v[40:43], a[144:147], v[176:179], v[40:43]
    v_mfma_f32_16x16x32_bf16 v[44:47], a[128:131], v[172:175], v[44:47]
    buffer_load_dwordx4 v[128:131], v2, s[64:67], s57 offen offset:3072 sc1
    v_mfma_f32_16x16x32_bf16 v[44:47], a[148:151], v[176:179], v[44:47]
    v_add_f32_dpp v188, v188, v188 quad_perm:[1,0,3,2] row_mask:0xf bank_mask:0xf
    v_add_f32_dpp v189, v189, v189 quad_perm:[1,0,3,2] row_mask:0xf bank_mask:0xf
    v_mfma_f32_16x16x32_bf16 v[48:51], a[132:135], v[172:175], v[48:51]
    v_add_f32_dpp v190, v190, v190 quad_perm:[1,0,3,2] row_mask:0xf bank_mask:0xf
    v_add_f32_dpp v191, v191, v191 quad_perm:[1,0,3,2] row_mask:0xf bank_mask:0xf
    v_mfma_f32_16x16x32_bf16 v[48:51], a[152:155], v[176:179], v[48:51]
    v_add_f32_dpp v192, v192, v192 quad_perm:[1,0,3,2] row_mask:0xf bank_mask:0xf
    v_add_f32_dpp v193, v193, v193 quad_perm:[1,0,3,2] row_mask:0xf bank_mask:0xf
    v_mfma_f32_16x16x32_bf16 v[52:55], a[136:139], v[172:175], v[52:55]
    s_waitcnt lgkmcnt(4)
    v_mfma_f32_16x16x32_bf16 v[52:55], a[156:159], v[176:179], v[52:55]
    buffer_load_dwordx4 v[132:135], v3, s[64:67], s57 offen sc1
    v_mfma_f32_16x16x32_bf16 v[56:59], a[120:123], v[180:183], v[56:59]
    ds_read_b128 v[172:175], v16 offset:15232
    v_mfma_f32_16x16x32_bf16 v[56:59], a[140:143], v[184:187], v[56:59]
    v_add_f32_dpp v194, v194, v194 quad_perm:[1,0,3,2] row_mask:0xf bank_mask:0xf
    v_add_f32_dpp v195, v195, v195 quad_perm:[1,0,3,2] row_mask:0xf bank_mask:0xf
    v_mfma_f32_16x16x32_bf16 v[60:63], a[124:127], v[180:183], v[60:63]
    ds_read_b128 v[176:179], v15 offset:15232
    v_mfma_f32_16x16x32_bf16 v[60:63], a[144:147], v[184:187], v[60:63]
    s_mov_b32 s57, 87040
    v_mfma_f32_16x16x32_bf16 v[64:67], a[128:131], v[180:183], v[64:67]
    buffer_load_dwordx4 v[136:139], v2, s[64:67], s57 offen offset:0 sc1
    v_mfma_f32_16x16x32_bf16 v[64:67], a[148:151], v[184:187], v[64:67]
    v_add_f32_dpp v196, v196, v196 quad_perm:[1,0,3,2] row_mask:0xf bank_mask:0xf
    v_add_f32_dpp v197, v197, v197 quad_perm:[1,0,3,2] row_mask:0xf bank_mask:0xf
    v_mfma_f32_16x16x32_bf16 v[68:71], a[132:135], v[180:183], v[68:71]
    v_add_f32_dpp v198, v198, v198 quad_perm:[1,0,3,2] row_mask:0xf bank_mask:0xf
    v_add_f32_dpp v199, v199, v199 quad_perm:[1,0,3,2] row_mask:0xf bank_mask:0xf
    v_mfma_f32_16x16x32_bf16 v[68:71], a[152:155], v[184:187], v[68:71]
    v_add_f32_dpp v200, v200, v200 quad_perm:[1,0,3,2] row_mask:0xf bank_mask:0xf
    v_add_f32_dpp v201, v201, v201 quad_perm:[1,0,3,2] row_mask:0xf bank_mask:0xf
    v_mfma_f32_16x16x32_bf16 v[72:75], a[136:139], v[180:183], v[72:75]
    s_waitcnt lgkmcnt(4)
    s_waitcnt vmcnt(22)
    v_mfma_f32_16x16x32_bf16 v[72:75], a[156:159], v[184:187], v[72:75]
    buffer_load_dwordx4 v[140:143], v2, s[64:67], s57 offen offset:1024 sc1
    v_mfma_f32_16x16x32_bf16 a[0:3], a[160:163], v[156:159], a[0:3]
    ds_read_b128 v[180:183], v16 offset:16256
    v_mfma_f32_16x16x32_bf16 a[0:3], a[180:183], v[160:163], a[0:3]
    v_add_f32_dpp v202, v202, v202 quad_perm:[1,0,3,2] row_mask:0xf bank_mask:0xf
    v_add_f32_dpp v203, v203, v203 quad_perm:[1,0,3,2] row_mask:0xf bank_mask:0xf
    v_mfma_f32_16x16x32_bf16 a[4:7], a[164:167], v[156:159], a[4:7]
    ds_read_b128 v[184:187], v15 offset:16256
    v_mfma_f32_16x16x32_bf16 a[4:7], a[184:187], v[160:163], a[4:7]
    s_waitcnt vmcnt(19)
    v_mfma_f32_16x16x32_bf16 a[8:11], a[168:171], v[156:159], a[8:11]
    buffer_load_dwordx4 v[144:147], v2, s[64:67], s57 offen offset:2048 sc1
    v_mfma_f32_16x16x32_bf16 a[8:11], a[188:191], v[160:163], a[8:11]
    v_add_f32_dpp v204, v204, v204 quad_perm:[1,0,3,2] row_mask:0xf bank_mask:0xf
    v_add_f32_dpp v205, v205, v205 quad_perm:[1,0,3,2] row_mask:0xf bank_mask:0xf
    v_mfma_f32_16x16x32_bf16 a[12:15], a[172:175], v[156:159], a[12:15]
    v_add_f32_dpp v206, v206, v206 quad_perm:[1,0,3,2] row_mask:0xf bank_mask:0xf
    v_add_f32_dpp v207, v207, v207 quad_perm:[1,0,3,2] row_mask:0xf bank_mask:0xf
    v_mfma_f32_16x16x32_bf16 a[12:15], a[192:195], v[160:163], a[12:15]
    v_add_f32_dpp v188, v188, v188 quad_perm:[2,3,0,1] row_mask:0xf bank_mask:0xf
    v_add_f32_dpp v189, v189, v189 quad_perm:[2,3,0,1] row_mask:0xf bank_mask:0xf
    v_mfma_f32_16x16x32_bf16 a[16:19], a[176:179], v[156:159], a[16:19]
    s_waitcnt lgkmcnt(4)
    s_add_u32 s35, s51, s53
    s_lshr_b32 m0, s35, 1
    s_lshr_b32 s35, s45, 1
    v_mfma_f32_16x16x32_bf16 a[16:19], a[196:199], v[160:163], a[16:19]
    buffer_load_dwordx4 v255, s[60:63], s35 offen sc1 lds
    v_mfma_f32_16x16x32_bf16 a[20:23], a[160:163], v[164:167], a[20:23]
    ds_read_b128 v[156:159], v19 offset:15232
    v_mfma_f32_16x16x32_bf16 a[20:23], a[180:183], v[168:171], a[20:23]
    v_add_f32_dpp v190, v190, v190 quad_perm:[2,3,0,1] row_mask:0xf bank_mask:0xf
    v_add_f32_dpp v191, v191, v191 quad_perm:[2,3,0,1] row_mask:0xf bank_mask:0xf
    v_mfma_f32_16x16x32_bf16 a[24:27], a[164:167], v[164:167], a[24:27]
    ds_read_b128 v[160:163], v18 offset:15232
    v_mfma_f32_16x16x32_bf16 a[24:27], a[184:187], v[168:171], a[24:27]
    v_mfma_f32_16x16x32_bf16 a[28:31], a[168:171], v[164:167], a[28:31]
    buffer_load_dwordx4 v[148:151], v2, s[64:67], s57 offen offset:3072 sc1
    v_mfma_f32_16x16x32_bf16 a[28:31], a[188:191], v[168:171], a[28:31]
    v_add_f32_dpp v192, v192, v192 quad_perm:[2,3,0,1] row_mask:0xf bank_mask:0xf
    v_add_f32_dpp v193, v193, v193 quad_perm:[2,3,0,1] row_mask:0xf bank_mask:0xf
    v_mfma_f32_16x16x32_bf16 a[32:35], a[172:175], v[164:167], a[32:35]
    v_add_f32_dpp v194, v194, v194 quad_perm:[2,3,0,1] row_mask:0xf bank_mask:0xf
    v_add_f32_dpp v195, v195, v195 quad_perm:[2,3,0,1] row_mask:0xf bank_mask:0xf
    v_mfma_f32_16x16x32_bf16 a[32:35], a[192:195], v[168:171], a[32:35]
    v_add_f32_dpp v196, v196, v196 quad_perm:[2,3,0,1] row_mask:0xf bank_mask:0xf
    v_add_f32_dpp v197, v197, v197 quad_perm:[2,3,0,1] row_mask:0xf bank_mask:0xf
    v_mfma_f32_16x16x32_bf16 a[36:39], a[176:179], v[164:167], a[36:39]
    s_waitcnt lgkmcnt(4)
    v_mfma_f32_16x16x32_bf16 a[36:39], a[196:199], v[168:171], a[36:39]
    buffer_load_dwordx4 v[152:155], v3, s[64:67], s57 offen sc1
    v_mfma_f32_16x16x32_bf16 a[40:43], a[160:163], v[172:175], a[40:43]
    ds_read_b128 v[164:167], v19 offset:16256
    v_mfma_f32_16x16x32_bf16 a[40:43], a[180:183], v[176:179], a[40:43]
    v_add_f32_dpp v198, v198, v198 quad_perm:[2,3,0,1] row_mask:0xf bank_mask:0xf
    v_add_f32_dpp v199, v199, v199 quad_perm:[2,3,0,1] row_mask:0xf bank_mask:0xf
    v_mfma_f32_16x16x32_bf16 a[44:47], a[164:167], v[172:175], a[44:47]
    ds_read_b128 v[168:171], v18 offset:16256
    v_mfma_f32_16x16x32_bf16 a[44:47], a[184:187], v[176:179], a[44:47]
    s_mov_b32 s57, 92160
    v_mfma_f32_16x16x32_bf16 a[48:51], a[168:171], v[172:175], a[48:51]
    buffer_load_dwordx4 a[200:203], v2, s[64:67], s57 offen offset:0 sc1
    v_mfma_f32_16x16x32_bf16 a[48:51], a[188:191], v[176:179], a[48:51]
    v_add_f32_dpp v200, v200, v200 quad_perm:[2,3,0,1] row_mask:0xf bank_mask:0xf
    v_add_f32_dpp v201, v201, v201 quad_perm:[2,3,0,1] row_mask:0xf bank_mask:0xf
    v_mfma_f32_16x16x32_bf16 a[52:55], a[172:175], v[172:175], a[52:55]
    v_add_f32_dpp v202, v202, v202 quad_perm:[2,3,0,1] row_mask:0xf bank_mask:0xf
    v_add_f32_dpp v203, v203, v203 quad_perm:[2,3,0,1] row_mask:0xf bank_mask:0xf
    v_mfma_f32_16x16x32_bf16 a[52:55], a[192:195], v[176:179], a[52:55]
    v_add_f32_dpp v204, v204, v204 quad_perm:[2,3,0,1] row_mask:0xf bank_mask:0xf
    v_add_f32_dpp v205, v205, v205 quad_perm:[2,3,0,1] row_mask:0xf bank_mask:0xf
    v_mfma_f32_16x16x32_bf16 a[56:59], a[176:179], v[172:175], a[56:59]
    s_waitcnt lgkmcnt(4)
    v_mfma_f32_16x16x32_bf16 a[56:59], a[196:199], v[176:179], a[56:59]
    buffer_load_dwordx4 a[204:207], v2, s[64:67], s57 offen offset:1024 sc1
    v_mfma_f32_16x16x32_bf16 a[60:63], a[160:163], v[180:183], a[60:63]
    ds_read_b128 v[172:175], v22 offset:15232
    v_mfma_f32_16x16x32_bf16 a[60:63], a[180:183], v[184:187], a[60:63]
    v_add_f32_dpp v206, v206, v206 quad_perm:[2,3,0,1] row_mask:0xf bank_mask:0xf
    v_add_f32_dpp v207, v207, v207 quad_perm:[2,3,0,1] row_mask:0xf bank_mask:0xf
    v_mfma_f32_16x16x32_bf16 a[64:67], a[164:167], v[180:183], a[64:67]
    ds_read_b128 v[176:179], v21 offset:15232
    v_mfma_f32_16x16x32_bf16 a[64:67], a[184:187], v[184:187], a[64:67]
    v_mfma_f32_16x16x32_bf16 a[68:71], a[168:171], v[180:183], a[68:71]
    v_add_f32_dpp v188, v188, v188 row_half_mirror row_mask:0xf bank_mask:0xf
    v_add_f32_dpp v189, v189, v189 row_half_mirror row_mask:0xf bank_mask:0xf
    v_mfma_f32_16x16x32_bf16 a[68:71], a[188:191], v[184:187], a[68:71]
    v_add_f32_dpp v190, v190, v190 row_half_mirror row_mask:0xf bank_mask:0xf
    v_add_f32_dpp v191, v191, v191 row_half_mirror row_mask:0xf bank_mask:0xf
    v_mfma_f32_16x16x32_bf16 a[72:75], a[172:175], v[180:183], a[72:75]
    buffer_load_dwordx4 a[208:211], v2, s[64:67], s57 offen offset:2048 sc1
    v_mfma_f32_16x16x32_bf16 a[72:75], a[192:195], v[184:187], a[72:75]
    v_add_f32_dpp v192, v192, v192 row_half_mirror row_mask:0xf bank_mask:0xf
    v_add_f32_dpp v193, v193, v193 row_half_mirror row_mask:0xf bank_mask:0xf
    v_mfma_f32_16x16x32_bf16 a[76:79], a[176:179], v[180:183], a[76:79]
    s_waitcnt lgkmcnt(4)
    v_mfma_f32_16x16x32_bf16 a[76:79], a[196:199], v[184:187], a[76:79]
    v_add_f32_dpp v194, v194, v194 row_half_mirror row_mask:0xf bank_mask:0xf
    v_add_f32_dpp v195, v195, v195 row_half_mirror row_mask:0xf bank_mask:0xf
    v_mfma_f32_16x16x32_bf16 a[80:83], a[160:163], v[156:159], a[80:83]
    ds_read_b128 v[180:183], v22 offset:16256
    v_mfma_f32_16x16x32_bf16 a[80:83], a[180:183], v[160:163], a[80:83]
    buffer_load_dwordx4 a[212:215], v2, s[64:67], s57 offen offset:3072 sc1
    v_mfma_f32_16x16x32_bf16 a[84:87], a[164:167], v[156:159], a[84:87]
    ds_read_b128 v[184:187], v21 offset:16256
    v_mfma_f32_16x16x32_bf16 a[84:87], a[184:187], v[160:163], a[84:87]
    v_mfma_f32_16x16x32_bf16 a[88:91], a[168:171], v[156:159], a[88:91]
    v_add_f32_dpp v196, v196, v196 row_half_mirror row_mask:0xf bank_mask:0xf
    v_add_f32_dpp v197, v197, v197 row_half_mirror row_mask:0xf bank_mask:0xf
    v_mfma_f32_16x16x32_bf16 a[88:91], a[188:191], v[160:163], a[88:91]
    v_add_f32_dpp v198, v198, v198 row_half_mirror row_mask:0xf bank_mask:0xf
    v_add_f32_dpp v199, v199, v199 row_half_mirror row_mask:0xf bank_mask:0xf
    v_mfma_f32_16x16x32_bf16 a[92:95], a[172:175], v[156:159], a[92:95]
    buffer_load_dwordx4 a[216:219], v3, s[64:67], s57 offen sc1
    v_mfma_f32_16x16x32_bf16 a[92:95], a[192:195], v[160:163], a[92:95]
    v_add_f32_dpp v200, v200, v200 row_half_mirror row_mask:0xf bank_mask:0xf
    v_add_f32_dpp v201, v201, v201 row_half_mirror row_mask:0xf bank_mask:0xf
    v_mfma_f32_16x16x32_bf16 a[96:99], a[176:179], v[156:159], a[96:99]
    s_waitcnt lgkmcnt(4)
    s_add_u32 s35, s52, s53
    s_lshr_b32 m0, s35, 1
    s_lshr_b32 s35, s46, 1
    v_mfma_f32_16x16x32_bf16 a[96:99], a[196:199], v[160:163], a[96:99]
    v_add_f32_dpp v202, v202, v202 row_half_mirror row_mask:0xf bank_mask:0xf
    v_add_f32_dpp v203, v203, v203 row_half_mirror row_mask:0xf bank_mask:0xf
    v_mfma_f32_16x16x32_bf16 a[100:103], a[160:163], v[164:167], a[100:103]
    ds_read_b128 v[156:159], v14 offset:15232
    v_mfma_f32_16x16x32_bf16 a[100:103], a[180:183], v[168:171], a[100:103]
    buffer_load_dwordx4 v255, s[60:63], s35 offen sc1 lds
    v_mfma_f32_16x16x32_bf16 a[104:107], a[164:167], v[164:167], a[104:107]
    ds_read_b128 v[160:163], v13 offset:17408
    v_mfma_f32_16x16x32_bf16 a[104:107], a[184:187], v[168:171], a[104:107]
    s_mov_b32 s57, 97280
    v_mfma_f32_16x16x32_bf16 a[108:111], a[168:171], v[164:167], a[108:111]
    v_add_f32_dpp v204, v204, v204 row_half_mirror row_mask:0xf bank_mask:0xf
    v_add_f32_dpp v205, v205, v205 row_half_mirror row_mask:0xf bank_mask:0xf
    v_mfma_f32_16x16x32_bf16 a[108:111], a[188:191], v[168:171], a[108:111]
    v_add_f32_dpp v206, v206, v206 row_half_mirror row_mask:0xf bank_mask:0xf
    v_add_f32_dpp v207, v207, v207 row_half_mirror row_mask:0xf bank_mask:0xf
    v_mfma_f32_16x16x32_bf16 a[112:115], a[172:175], v[164:167], a[112:115]
    buffer_load_dwordx4 a[220:223], v2, s[64:67], s57 offen offset:0 sc1
    v_mfma_f32_16x16x32_bf16 a[112:115], a[192:195], v[168:171], a[112:115]
    v_add_f32_dpp v188, v188, v188 row_mirror row_mask:0xf bank_mask:0xf
    v_add_f32_dpp v189, v189, v189 row_mirror row_mask:0xf bank_mask:0xf
    v_mfma_f32_16x16x32_bf16 a[116:119], a[176:179], v[164:167], a[116:119]
    s_waitcnt lgkmcnt(4)
    v_mfma_f32_16x16x32_bf16 a[116:119], a[196:199], v[168:171], a[116:119]
    v_add_f32_dpp v190, v190, v190 row_mirror row_mask:0xf bank_mask:0xf
    v_add_f32_dpp v191, v191, v191 row_mirror row_mask:0xf bank_mask:0xf
    v_mfma_f32_16x16x32_bf16 v[36:39], a[160:163], v[172:175], v[36:39]
    ds_read_b128 v[164:167], v14 offset:16256
    v_mfma_f32_16x16x32_bf16 v[36:39], a[180:183], v[176:179], v[36:39]
    buffer_load_dwordx4 a[224:227], v2, s[64:67], s57 offen offset:1024 sc1
    v_mfma_f32_16x16x32_bf16 v[40:43], a[164:167], v[172:175], v[40:43]
    ds_read_b128 v[168:171], v13 offset:18432
    v_mfma_f32_16x16x32_bf16 v[40:43], a[184:187], v[176:179], v[40:43]
    v_mfma_f32_16x16x32_bf16 v[44:47], a[168:171], v[172:175], v[44:47]
    v_add_f32_dpp v192, v192, v192 row_mirror row_mask:0xf bank_mask:0xf
    v_add_f32_dpp v193, v193, v193 row_mirror row_mask:0xf bank_mask:0xf
    v_mfma_f32_16x16x32_bf16 v[44:47], a[188:191], v[176:179], v[44:47]
    v_add_f32_dpp v194, v194, v194 row_mirror row_mask:0xf bank_mask:0xf
    v_add_f32_dpp v195, v195, v195 row_mirror row_mask:0xf bank_mask:0xf
    v_mfma_f32_16x16x32_bf16 v[48:51], a[172:175], v[172:175], v[48:51]
    buffer_load_dwordx4 a[228:231], v2, s[64:67], s57 offen offset:2048 sc1
    v_mfma_f32_16x16x32_bf16 v[48:51], a[192:195], v[176:179], v[48:51]
    v_add_f32_dpp v196, v196, v196 row_mirror row_mask:0xf bank_mask:0xf
    v_add_f32_dpp v197, v197, v197 row_mirror row_mask:0xf bank_mask:0xf
    v_mfma_f32_16x16x32_bf16 v[52:55], a[176:179], v[172:175], v[52:55]
    s_waitcnt lgkmcnt(4)
    v_mfma_f32_16x16x32_bf16 v[52:55], a[196:199], v[176:179], v[52:55]
    v_add_f32_dpp v198, v198, v198 row_mirror row_mask:0xf bank_mask:0xf
    v_add_f32_dpp v199, v199, v199 row_mirror row_mask:0xf bank_mask:0xf
    v_mfma_f32_16x16x32_bf16 v[56:59], a[160:163], v[180:183], v[56:59]
    ds_read_b128 v[172:175], v17 offset:15232
    v_mfma_f32_16x16x32_bf16 v[56:59], a[180:183], v[184:187], v[56:59]
    buffer_load_dwordx4 a[232:235], v2, s[64:67], s57 offen offset:3072 sc1
    v_mfma_f32_16x16x32_bf16 v[60:63], a[164:167], v[180:183], v[60:63]
    ds_read_b128 v[176:179], v16 offset:17408
    v_mfma_f32_16x16x32_bf16 v[60:63], a[184:187], v[184:187], v[60:63]
    v_mfma_f32_16x16x32_bf16 v[64:67], a[168:171], v[180:183], v[64:67]
    v_add_f32_dpp v200, v200, v200 row_mirror row_mask:0xf bank_mask:0xf
    v_add_f32_dpp v201, v201, v201 row_mirror row_mask:0xf bank_mask:0xf
    v_mfma_f32_16x16x32_bf16 v[64:67], a[188:191], v[184:187], v[64:67]
    v_add_f32_dpp v202, v202, v202 row_mirror row_mask:0xf bank_mask:0xf
    v_add_f32_dpp v203, v203, v203 row_mirror row_mask:0xf bank_mask:0xf
    v_mfma_f32_16x16x32_bf16 v[68:71], a[172:175], v[180:183], v[68:71]
    buffer_load_dwordx4 a[236:239], v3, s[64:67], s57 offen sc1
    v_mfma_f32_16x16x32_bf16 v[68:71], a[192:195], v[184:187], v[68:71]
    v_add_f32_dpp v204, v204, v204 row_mirror row_mask:0xf bank_mask:0xf
    v_add_f32_dpp v205, v205, v205 row_mirror row_mask:0xf bank_mask:0xf
    v_mfma_f32_16x16x32_bf16 v[72:75], a[176:179], v[180:183], v[72:75]
    s_waitcnt lgkmcnt(4)
    s_waitcnt vmcnt(26)
    s_mov_b32 s57, 102400
    v_mfma_f32_16x16x32_bf16 v[72:75], a[196:199], v[184:187], v[72:75]
    v_add_f32_dpp v206, v206, v206 row_mirror row_mask:0xf bank_mask:0xf
    v_add_f32_dpp v207, v207, v207 row_mirror row_mask:0xf bank_mask:0xf
    v_mfma_f32_16x16x32_bf16 a[0:3], v[76:79], v[156:159], a[0:3]
    ds_read_b128 v[180:183], v17 offset:16256
    v_mfma_f32_16x16x32_bf16 a[0:3], v[96:99], v[160:163], a[0:3]
    buffer_load_dwordx4 a[120:123], v2, s[64:67], s57 offen offset:0 sc1
    v_mfma_f32_16x16x32_bf16 a[4:7], v[80:83], v[156:159], a[4:7]
    ds_read_b128 v[184:187], v16 offset:18432
    v_mfma_f32_16x16x32_bf16 a[4:7], v[100:103], v[160:163], a[4:7]
    s_waitcnt vmcnt(24)
    v_mfma_f32_16x16x32_bf16 a[8:11], v[84:87], v[156:159], a[8:11]
    v_mfma_f32_16x16x32_bf16 a[8:11], v[104:107], v[160:163], a[8:11]
    v_mfma_f32_16x16x32_bf16 a[12:15], v[88:91], v[156:159], a[12:15]
    v_mfma_f32_16x16x32_bf16 a[12:15], v[108:111], v[160:163], a[12:15]
    v_mfma_f32_16x16x32_bf16 a[16:19], v[92:95], v[156:159], a[16:19]
    s_waitcnt lgkmcnt(4)
    v_mfma_f32_16x16x32_bf16 a[16:19], v[112:115], v[160:163], a[16:19]
    buffer_load_dwordx4 a[124:127], v2, s[64:67], s57 offen offset:1024 sc1
    v_mfma_f32_16x16x32_bf16 a[20:23], v[76:79], v[164:167], a[20:23]
    ds_read_b128 v[156:159], v20 offset:15232
    v_mfma_f32_16x16x32_bf16 a[20:23], v[96:99], v[168:171], a[20:23]
    v_add_f32 v36, v36, v188
    v_add_f32 v37, v37, v189
    v_mfma_f32_16x16x32_bf16 a[24:27], v[80:83], v[164:167], a[24:27]
    ds_read_b128 v[160:163], v19 offset:17408
    v_mfma_f32_16x16x32_bf16 a[24:27], v[100:103], v[168:171], a[24:27]
    v_mfma_f32_16x16x32_bf16 a[28:31], v[84:87], v[164:167], a[28:31]
    buffer_load_dwordx4 a[128:131], v2, s[64:67], s57 offen offset:2048 sc1
    v_mfma_f32_16x16x32_bf16 a[28:31], v[104:107], v[168:171], a[28:31]
    v_add_f32 v38, v38, v190
    v_add_f32 v39, v39, v191
    v_mfma_f32_16x16x32_bf16 a[32:35], v[88:91], v[164:167], a[32:35]
    v_add_f32 v40, v40, v192
    v_add_f32 v41, v41, v193
    v_mfma_f32_16x16x32_bf16 a[32:35], v[108:111], v[168:171], a[32:35]
    v_add_f32 v42, v42, v194
    v_add_f32 v43, v43, v195
    v_mfma_f32_16x16x32_bf16 a[36:39], v[92:95], v[164:167], a[36:39]
    s_waitcnt lgkmcnt(4)
    v_mfma_f32_16x16x32_bf16 a[36:39], v[112:115], v[168:171], a[36:39]
    buffer_load_dwordx4 a[132:135], v2, s[64:67], s57 offen offset:3072 sc1
    v_mfma_f32_16x16x32_bf16 a[40:43], v[76:79], v[172:175], a[40:43]
    ds_read_b128 v[164:167], v20 offset:16256
    v_mfma_f32_16x16x32_bf16 a[40:43], v[96:99], v[176:179], a[40:43]
    v_add_f32 v44, v44, v196
    v_add_f32 v45, v45, v197
    v_mfma_f32_16x16x32_bf16 a[44:47], v[80:83], v[172:175], a[44:47]
    ds_read_b128 v[168:171], v19 offset:18432
    v_mfma_f32_16x16x32_bf16 a[44:47], v[100:103], v[176:179], a[44:47]
    v_mfma_f32_16x16x32_bf16 a[48:51], v[84:87], v[172:175], a[48:51]
    buffer_load_dwordx4 a[136:139], v3, s[64:67], s57 offen sc1
    v_mfma_f32_16x16x32_bf16 a[48:51], v[104:107], v[176:179], a[48:51]
    v_add_f32 v46, v46, v198
    v_add_f32 v47, v47, v199
    v_mfma_f32_16x16x32_bf16 a[52:55], v[88:91], v[172:175], a[52:55]
    v_add_f32 v48, v48, v200
    v_add_f32 v49, v49, v201
    v_mfma_f32_16x16x32_bf16 a[52:55], v[108:111], v[176:179], a[52:55]
    v_add_f32 v50, v50, v202
    v_add_f32 v51, v51, v203
    v_mfma_f32_16x16x32_bf16 a[56:59], v[92:95], v[172:175], a[56:59]
    s_waitcnt lgkmcnt(4)
    s_mov_b32 s57, 107520
    v_mfma_f32_16x16x32_bf16 a[56:59], v[112:115], v[176:179], a[56:59]
    buffer_load_dwordx4 a[140:143], v2, s[64:67], s57 offen offset:0 sc1
    v_mfma_f32_16x16x32_bf16 a[60:63], v[76:79], v[180:183], a[60:63]
    ds_read_b128 v[172:175], v23 offset:15232
    v_mfma_f32_16x16x32_bf16 a[60:63], v[96:99], v[184:187], a[60:63]
    v_add_f32 v52, v52, v204
    v_add_f32 v53, v53, v205
    v_mfma_f32_16x16x32_bf16 a[64:67], v[80:83], v[180:183], a[64:67]
    ds_read_b128 v[176:179], v22 offset:17408
    v_mfma_f32_16x16x32_bf16 a[64:67], v[100:103], v[184:187], a[64:67]
    v_mfma_f32_16x16x32_bf16 a[68:71], v[84:87], v[180:183], a[68:71]
    buffer_load_dwordx4 a[144:147], v2, s[64:67], s57 offen offset:1024 sc1
    v_mfma_f32_16x16x32_bf16 a[68:71], v[104:107], v[184:187], a[68:71]
    v_add_f32 v54, v54, v206
    v_add_f32 v55, v55, v207
    v_mfma_f32_16x16x32_bf16 a[72:75], v[88:91], v[180:183], a[72:75]
    v_add_f32 v56, v56, v188
    v_add_f32 v57, v57, v189
    v_mfma_f32_16x16x32_bf16 a[72:75], v[108:111], v[184:187], a[72:75]
    v_add_f32 v58, v58, v190
    v_add_f32 v59, v59, v191
    v_mfma_f32_16x16x32_bf16 a[76:79], v[92:95], v[180:183], a[76:79]
    s_waitcnt lgkmcnt(4)
    v_mfma_f32_16x16x32_bf16 a[76:79], v[112:115], v[184:187], a[76:79]
    buffer_load_dwordx4 a[148:151], v2, s[64:67], s57 offen offset:2048 sc1
    v_mfma_f32_16x16x32_bf16 a[80:83], v[76:79], v[156:159], a[80:83]
    ds_read_b128 v[180:183], v23 offset:16256
    v_mfma_f32_16x16x32_bf16 a[80:83], v[96:99], v[160:163], a[80:83]
    v_add_f32 v60, v60, v192
    v_add_f32 v61, v61, v193
    v_mfma_f32_16x16x32_bf16 a[84:87], v[80:83], v[156:159], a[84:87]
    ds_read_b128 v[184:187], v22 offset:18432
    v_mfma_f32_16x16x32_bf16 a[84:87], v[100:103], v[160:163], a[84:87]
    v_mfma_f32_16x16x32_bf16 a[88:91], v[84:87], v[156:159], a[88:91]
    buffer_load_dwordx4 a[152:155], v2, s[64:67], s57 offen offset:3072 sc1
    v_mfma_f32_16x16x32_bf16 a[88:91], v[104:107], v[160:163], a[88:91]
    v_add_f32 v62, v62, v194
    v_add_f32 v63, v63, v195
    v_mfma_f32_16x16x32_bf16 a[92:95], v[88:91], v[156:159], a[92:95]
    v_add_f32 v64, v64, v196
    v_add_f32 v65, v65, v197
    v_mfma_f32_16x16x32_bf16 a[92:95], v[108:111], v[160:163], a[92:95]
    v_add_f32 v66, v66, v198
    v_add_f32 v67, v67, v199
    v_mfma_f32_16x16x32_bf16 a[96:99], v[92:95], v[156:159], a[96:99]
    s_waitcnt lgkmcnt(4)
    v_mfma_f32_16x16x32_bf16 a[96:99], v[112:115], v[160:163], a[96:99]
    buffer_load_dwordx4 a[156:159], v3, s[64:67], s57 offen sc1
    v_mfma_f32_16x16x32_bf16 a[100:103], v[76:79], v[164:167], a[100:103]
    ds_read_b128 v[156:159], v12 offset:17408
    v_mfma_f32_16x16x32_bf16 a[100:103], v[96:99], v[168:171], a[100:103]
    v_add_f32 v68, v68, v200
    v_add_f32 v69, v69, v201
    v_mfma_f32_16x16x32_bf16 a[104:107], v[80:83], v[164:167], a[104:107]
    ds_read_b128 v[160:163], v14 offset:17408
    v_mfma_f32_16x16x32_bf16 a[104:107], v[100:103], v[168:171], a[104:107]
    s_mov_b32 s57, 112640
    v_mfma_f32_16x16x32_bf16 a[108:111], v[84:87], v[164:167], a[108:111]
    buffer_load_dwordx4 a[160:163], v2, s[64:67], s57 offen offset:0 sc1
    v_mfma_f32_16x16x32_bf16 a[108:111], v[104:107], v[168:171], a[108:111]
    v_add_f32 v70, v70, v202
    v_add_f32 v71, v71, v203
    v_mfma_f32_16x16x32_bf16 a[112:115], v[88:91], v[164:167], a[112:115]
    v_mfma_f32_16x16x32_bf16 a[112:115], v[108:111], v[168:171], a[112:115]
    v_mfma_f32_16x16x32_bf16 a[116:119], v[92:95], v[164:167], a[116:119]
    s_waitcnt lgkmcnt(4)
    v_mfma_f32_16x16x32_bf16 a[116:119], v[112:115], v[168:171], a[116:119]
    v_mfma_f32_16x16x32_bf16 v[36:39], v[76:79], v[172:175], v[36:39]
    ds_read_b128 v[164:167], v12 offset:18432
    v_mfma_f32_16x16x32_bf16 v[36:39], v[96:99], v[176:179], v[36:39]
    buffer_load_dwordx4 a[164:167], v2, s[64:67], s57 offen offset:1024 sc1
    v_mfma_f32_16x16x32_bf16 v[40:43], v[80:83], v[172:175], v[40:43]
    ds_read_b128 v[168:171], v14 offset:18432
    v_mfma_f32_16x16x32_bf16 v[40:43], v[100:103], v[176:179], v[40:43]
    v_mfma_f32_16x16x32_bf16 v[44:47], v[84:87], v[172:175], v[44:47]
    v_mfma_f32_16x16x32_bf16 v[44:47], v[104:107], v[176:179], v[44:47]
    v_mfma_f32_16x16x32_bf16 v[48:51], v[88:91], v[172:175], v[48:51]
    buffer_load_dwordx4 a[168:171], v2, s[64:67], s57 offen offset:2048 sc1
    v_mfma_f32_16x16x32_bf16 v[48:51], v[108:111], v[176:179], v[48:51]
    v_mfma_f32_16x16x32_bf16 v[52:55], v[92:95], v[172:175], v[52:55]
    s_waitcnt lgkmcnt(4)
    v_mfma_f32_16x16x32_bf16 v[52:55], v[112:115], v[176:179], v[52:55]
    v_mfma_f32_16x16x32_bf16 v[56:59], v[76:79], v[180:183], v[56:59]
    ds_read_b128 v[172:175], v15 offset:17408
    v_mfma_f32_16x16x32_bf16 v[56:59], v[96:99], v[184:187], v[56:59]
    buffer_load_dwordx4 a[172:175], v2, s[64:67], s57 offen offset:3072 sc1
    v_mfma_f32_16x16x32_bf16 v[60:63], v[80:83], v[180:183], v[60:63]
    ds_read_b128 v[176:179], v17 offset:17408
    v_mfma_f32_16x16x32_bf16 v[60:63], v[100:103], v[184:187], v[60:63]
    v_mfma_f32_16x16x32_bf16 v[64:67], v[84:87], v[180:183], v[64:67]
    v_mfma_f32_16x16x32_bf16 v[64:67], v[104:107], v[184:187], v[64:67]
    v_mfma_f32_16x16x32_bf16 v[68:71], v[88:91], v[180:183], v[68:71]
    buffer_load_dwordx4 a[176:179], v3, s[64:67], s57 offen sc1
    v_mfma_f32_16x16x32_bf16 v[68:71], v[108:111], v[184:187], v[68:71]
    v_mfma_f32_16x16x32_bf16 v[72:75], v[92:95], v[180:183], v[72:75]
    s_waitcnt lgkmcnt(4)
    s_waitcnt vmcnt(30)
    v_mfma_f32_16x16x32_bf16 v[72:75], v[112:115], v[184:187], v[72:75]
    v_mfma_f32_16x16x32_bf16 a[0:3], v[116:119], v[156:159], a[0:3]
    ds_read_b128 v[180:183], v15 offset:18432
    v_mfma_f32_16x16x32_bf16 a[0:3], v[136:139], v[160:163], a[0:3]
    v_accvgpr_read_b32 v228, a240
    v_accvgpr_read_b32 v229, a241
    v_accvgpr_read_b32 v230, a242
    s_add_u32 m0, s58, 37248
    s_nop 0
    buffer_load_dwordx4 v228, s[80:83], 0 offen lds
    v_mfma_f32_16x16x32_bf16 a[4:7], v[120:123], v[156:159], a[4:7]
    ds_read_b128 v[184:187], v17 offset:18432
    v_mfma_f32_16x16x32_bf16 a[4:7], v[140:143], v[160:163], a[4:7]
    s_waitcnt vmcnt(27)
    v_mfma_f32_16x16x32_bf16 a[8:11], v[124:127], v[156:159], a[8:11]
    v_mfma_f32_16x16x32_bf16 a[8:11], v[144:147], v[160:163], a[8:11]
    v_mfma_f32_16x16x32_bf16 a[12:15], v[128:131], v[156:159], a[12:15]
    s_add_u32 m0, s58, 38272
    s_nop 0
    buffer_load_dwordx4 v229, s[80:83], 0 offen lds
    v_mfma_f32_16x16x32_bf16 a[12:15], v[148:151], v[160:163], a[12:15]
    v_mfma_f32_16x16x32_bf16 a[16:19], v[132:135], v[156:159], a[16:19]
    s_waitcnt lgkmcnt(4)
    v_mfma_f32_16x16x32_bf16 a[16:19], v[152:155], v[160:163], a[16:19]
    v_add_f32 v72, v72, v204
    v_add_f32 v73, v73, v205
    v_mfma_f32_16x16x32_bf16 a[20:23], v[116:119], v[164:167], a[20:23]
    ds_read_b128 v[156:159], v18 offset:17408
    v_mfma_f32_16x16x32_bf16 a[20:23], v[136:139], v[168:171], a[20:23]
    s_add_u32 m0, s58, 39296
    s_nop 0
    buffer_load_dwordx4 v230, s[80:83], 0 offen lds
    v_mfma_f32_16x16x32_bf16 a[24:27], v[120:123], v[164:167], a[24:27]
    ds_read_b128 v[160:163], v20 offset:17408
    v_mfma_f32_16x16x32_bf16 a[24:27], v[140:143], v[168:171], a[24:27]
    v_mfma_f32_16x16x32_bf16 a[28:31], v[124:127], v[164:167], a[28:31]
    v_add_f32 v74, v74, v206
    v_add_f32 v75, v75, v207
    v_mfma_f32_16x16x32_bf16 a[28:31], v[144:147], v[168:171], a[28:31]
    v_mfma_f32_16x16x32_bf16 a[32:35], v[128:131], v[164:167], a[32:35]
    buffer_load_dwordx4 v[208:211], v5, s[72:75], s38 offen offset:0
    v_mfma_f32_16x16x32_bf16 a[32:35], v[148:151], v[168:171], a[32:35]
    v_mfma_f32_16x16x32_bf16 a[36:39], v[132:135], v[164:167], a[36:39]
    s_waitcnt lgkmcnt(4)
    v_mfma_f32_16x16x32_bf16 a[36:39], v[152:155], v[168:171], a[36:39]
    v_mfma_f32_16x16x32_bf16 a[40:43], v[116:119], v[172:175], a[40:43]
    ds_read_b128 v[164:167], v18 offset:18432
    v_mfma_f32_16x16x32_bf16 a[40:43], v[136:139], v[176:179], a[40:43]
    buffer_load_dwordx4 v[212:215], v5, s[72:75], s38 offen offset:64
    v_mfma_f32_16x16x32_bf16 a[44:47], v[120:123], v[172:175], a[44:47]
    ds_read_b128 v[168:171], v20 offset:18432
    v_mfma_f32_16x16x32_bf16 a[44:47], v[140:143], v[176:179], a[44:47]
    v_mfma_f32_16x16x32_bf16 a[48:51], v[124:127], v[172:175], a[48:51]
    v_mfma_f32_16x16x32_bf16 a[48:51], v[144:147], v[176:179], a[48:51]
    v_mfma_f32_16x16x32_bf16 a[52:55], v[128:131], v[172:175], a[52:55]
    buffer_load_dwordx2 v[216:217], v9, s[72:75], s38 offen offset:128
    v_mfma_f32_16x16x32_bf16 a[52:55], v[148:151], v[176:179], a[52:55]
    v_mfma_f32_16x16x32_bf16 a[56:59], v[132:135], v[172:175], a[56:59]
    s_waitcnt lgkmcnt(4)
    v_mfma_f32_16x16x32_bf16 a[56:59], v[152:155], v[176:179], a[56:59]
    v_mfma_f32_16x16x32_bf16 a[60:63], v[116:119], v[180:183], a[60:63]
    ds_read_b128 v[172:175], v21 offset:17408
    v_mfma_f32_16x16x32_bf16 a[60:63], v[136:139], v[184:187], a[60:63]
    v_mfma_f32_16x16x32_bf16 a[64:67], v[120:123], v[180:183], a[64:67]
    ds_read_b128 v[176:179], v23 offset:17408
    v_mfma_f32_16x16x32_bf16 a[64:67], v[140:143], v[184:187], a[64:67]
    v_mfma_f32_16x16x32_bf16 a[68:71], v[124:127], v[180:183], a[68:71]
    buffer_load_dwordx4 v[218:221], v5, s[76:79], s38 offen offset:0
    v_mfma_f32_16x16x32_bf16 a[68:71], v[144:147], v[184:187], a[68:71]
    v_mfma_f32_16x16x32_bf16 a[72:75], v[128:131], v[180:183], a[72:75]
    v_mfma_f32_16x16x32_bf16 a[72:75], v[148:151], v[184:187], a[72:75]
    v_mfma_f32_16x16x32_bf16 a[76:79], v[132:135], v[180:183], a[76:79]
    s_waitcnt lgkmcnt(4)
    v_mfma_f32_16x16x32_bf16 a[76:79], v[152:155], v[184:187], a[76:79]
    buffer_load_dwordx4 v[222:225], v5, s[76:79], s38 offen offset:64
    v_mfma_f32_16x16x32_bf16 a[80:83], v[116:119], v[156:159], a[80:83]
    ds_read_b128 v[180:183], v21 offset:18432
    v_mfma_f32_16x16x32_bf16 a[80:83], v[136:139], v[160:163], a[80:83]
    v_mfma_f32_16x16x32_bf16 a[84:87], v[120:123], v[156:159], a[84:87]
    ds_read_b128 v[184:187], v23 offset:18432
    v_mfma_f32_16x16x32_bf16 a[84:87], v[140:143], v[160:163], a[84:87]
    v_mfma_f32_16x16x32_bf16 a[88:91], v[124:127], v[156:159], a[88:91]
    buffer_load_dwordx2 v[226:227], v9, s[76:79], s38 offen offset:128
    v_mfma_f32_16x16x32_bf16 a[88:91], v[144:147], v[160:163], a[88:91]
    v_mfma_f32_16x16x32_bf16 a[92:95], v[128:131], v[156:159], a[92:95]
    v_mfma_f32_16x16x32_bf16 a[92:95], v[148:151], v[160:163], a[92:95]
    v_mfma_f32_16x16x32_bf16 a[96:99], v[132:135], v[156:159], a[96:99]
    s_waitcnt lgkmcnt(4)
    v_mfma_f32_16x16x32_bf16 a[96:99], v[152:155], v[160:163], a[96:99]
    v_mfma_f32_16x16x32_bf16 a[100:103], v[116:119], v[164:167], a[100:103]
    s_waitcnt vmcnt(29)
    ds_read_b128 v[156:159], v24 offset:0
    v_mfma_f32_16x16x32_bf16 a[100:103], v[136:139], v[168:171], a[100:103]
    v_mfma_f32_16x16x32_bf16 a[104:107], v[120:123], v[164:167], a[104:107]
    ds_read_b128 v[160:163], v24 offset:1088
    v_mfma_f32_16x16x32_bf16 a[104:107], v[140:143], v[168:171], a[104:107]
    s_barrier
    v_mfma_f32_16x16x32_bf16 a[108:111], v[124:127], v[164:167], a[108:111]
    v_mfma_f32_16x16x32_bf16 a[108:111], v[144:147], v[168:171], a[108:111]
    v_mfma_f32_16x16x32_bf16 a[112:115], v[128:131], v[164:167], a[112:115]
    v_mfma_f32_16x16x32_bf16 a[112:115], v[148:151], v[168:171], a[112:115]
    v_mfma_f32_16x16x32_bf16 a[116:119], v[132:135], v[164:167], a[116:119]
    s_waitcnt lgkmcnt(4)
    v_mfma_f32_16x16x32_bf16 a[116:119], v[152:155], v[168:171], a[116:119]
    v_mfma_f32_16x16x32_bf16 v[36:39], v[116:119], v[172:175], v[36:39]
    ds_read_b128 v[164:167], v24 offset:2176
    v_mfma_f32_16x16x32_bf16 v[36:39], v[136:139], v[176:179], v[36:39]
    v_mfma_f32_16x16x32_bf16 v[40:43], v[120:123], v[172:175], v[40:43]
    ds_read_b128 v[168:171], v25 offset:64
    v_mfma_f32_16x16x32_bf16 v[40:43], v[140:143], v[176:179], v[40:43]
    v_mfma_f32_16x16x32_bf16 v[44:47], v[124:127], v[172:175], v[44:47]
    v_mfma_f32_16x16x32_bf16 v[44:47], v[144:147], v[176:179], v[44:47]
    v_mfma_f32_16x16x32_bf16 v[48:51], v[128:131], v[172:175], v[48:51]
    v_mfma_f32_16x16x32_bf16 v[48:51], v[148:151], v[176:179], v[48:51]
    v_mfma_f32_16x16x32_bf16 v[52:55], v[132:135], v[172:175], v[52:55]
    s_waitcnt lgkmcnt(4)
    v_mfma_f32_16x16x32_bf16 v[52:55], v[152:155], v[176:179], v[52:55]
    v_mfma_f32_16x16x32_bf16 v[56:59], v[116:119], v[180:183], v[56:59]
    ds_read_b128 v[172:175], v24 offset:512
    v_mfma_f32_16x16x32_bf16 v[56:59], v[136:139], v[184:187], v[56:59]
    v_mfma_f32_16x16x32_bf16 v[60:63], v[120:123], v[180:183], v[60:63]
    ds_read_b128 v[176:179], v24 offset:1600
    v_mfma_f32_16x16x32_bf16 v[60:63], v[140:143], v[184:187], v[60:63]
    v_mfma_f32_16x16x32_bf16 v[64:67], v[124:127], v[180:183], v[64:67]
    v_mfma_f32_16x16x32_bf16 v[64:67], v[144:147], v[184:187], v[64:67]
    v_mfma_f32_16x16x32_bf16 v[68:71], v[128:131], v[180:183], v[68:71]
    v_mfma_f32_16x16x32_bf16 v[68:71], v[148:151], v[184:187], v[68:71]
    v_mfma_f32_16x16x32_bf16 v[72:75], v[132:135], v[180:183], v[72:75]
    s_waitcnt lgkmcnt(4)
    s_waitcnt vmcnt(27)
    v_mfma_f32_16x16x32_bf16 v[72:75], v[152:155], v[184:187], v[72:75]
    v_mfma_f32_16x16x32_bf16 a[0:3], a[200:203], v[156:159], a[0:3]
    ds_read_b128 v[180:183], v24 offset:2688
    v_mfma_f32_16x16x32_bf16 a[0:3], a[220:223], v[160:163], a[0:3]
    v_accvgpr_read_b32 v119, a243
    v_accvgpr_read_b32 v120, a244
    v_mfma_f32_16x16x32_bf16 a[4:7], a[204:207], v[156:159], a[4:7]
    ds_read_b128 v[184:187], v25 offset:576
    v_mfma_f32_16x16x32_bf16 a[4:7], a[224:227], v[160:163], a[4:7]
    s_waitcnt vmcnt(24)
    v_accvgpr_read_b32 v121, a245
    v_accvgpr_read_b32 v122, a246
    v_mfma_f32_16x16x32_bf16 a[8:11], a[208:211], v[156:159], a[8:11]
    v_accvgpr_read_b32 v123, a247
    v_accvgpr_read_b32 v124, a248
    v_mfma_f32_16x16x32_bf16 a[8:11], a[228:231], v[160:163], a[8:11]
    s_waitcnt vmcnt(6)
    v_mfma_f32_16x16x32_bf16 a[12:15], a[212:215], v[156:159], a[12:15]
    ds_read_u16 v128, v119 offset:37248
    ds_read_u16_d16_hi v132, v119 offset:37266
    v_mfma_f32_16x16x32_bf16 a[12:15], a[232:235], v[160:163], a[12:15]
    ds_read_u16 v129, v119 offset:37284
    ds_read_u16_d16_hi v133, v119 offset:37302
    v_mfma_f32_16x16x32_bf16 a[16:19], a[216:219], v[156:159], a[16:19]
    s_waitcnt lgkmcnt(8)
    ds_read_u16 v130, v119 offset:37320
    ds_read_u16_d16_hi v134, v119 offset:37338
    v_mfma_f32_16x16x32_bf16 a[16:19], a[236:239], v[160:163], a[16:19]
    ds_read_u16 v131, v119 offset:37356
    ds_read_u16_d16_hi v135, v119 offset:37374
    v_mfma_f32_16x16x32_bf16 a[0:3], a[120:123], v[164:167], a[0:3]
    ds_read_b128 v[156:159], v27 offset:0
    v_mfma_f32_16x16x32_bf16 a[0:3], a[140:143], v[168:171], a[0:3]
    v_mfma_f32_16x16x32_bf16 a[4:7], a[124:127], v[164:167], a[4:7]
    ds_read_b128 v[160:163], v27 offset:1088
    v_mfma_f32_16x16x32_bf16 a[4:7], a[144:147], v[168:171], a[4:7]
    v_mfma_f32_16x16x32_bf16 a[8:11], a[128:131], v[164:167], a[8:11]
    v_mfma_f32_16x16x32_bf16 a[8:11], a[148:151], v[168:171], a[8:11]
    v_mfma_f32_16x16x32_bf16 a[12:15], a[132:135], v[164:167], a[12:15]
    v_mfma_f32_16x16x32_bf16 a[12:15], a[152:155], v[168:171], a[12:15]
    v_mfma_f32_16x16x32_bf16 a[16:19], a[136:139], v[164:167], a[16:19]
    s_waitcnt lgkmcnt(12)
    v_mfma_f32_16x16x32_bf16 a[16:19], a[156:159], v[168:171], a[16:19]
    v_mfma_f32_16x16x32_bf16 a[20:23], a[200:203], v[172:175], a[20:23]
    ds_read_b128 v[164:167], v27 offset:2176
    v_mfma_f32_16x16x32_bf16 a[20:23], a[220:223], v[176:179], a[20:23]
    ds_write_b128 v248, a[0:3] offset:6528
    v_mfma_f32_16x16x32_bf16 a[24:27], a[204:207], v[172:175], a[24:27]
    ds_read_b128 v[168:171], v28 offset:64
    v_mfma_f32_16x16x32_bf16 a[24:27], a[224:227], v[176:179], a[24:27]
    s_waitcnt lgkmcnt(5)
    v_and_or_b32 v128, v132, s40, v128
    v_and_or_b32 v129, v133, s40, v129
    v_mfma_f32_16x16x32_bf16 a[28:31], a[208:211], v[172:175], a[28:31]
    v_and_or_b32 v130, v134, s40, v130
    v_and_or_b32 v131, v135, s40, v131
    v_mfma_f32_16x16x32_bf16 a[28:31], a[228:231], v[176:179], a[28:31]
    buffer_store_dwordx4 v[128:131], v122, s[84:87], 0 offen sc1
    v_mfma_f32_16x16x32_bf16 a[32:35], a[212:215], v[172:175], a[32:35]
    ds_write_b128 v248, a[4:7] offset:7552
    v_mfma_f32_16x16x32_bf16 a[32:35], a[232:235], v[176:179], a[32:35]
    ds_read_u16 v136, v120 offset:37248
    ds_read_u16_d16_hi v140, v120 offset:37266
    v_mfma_f32_16x16x32_bf16 a[36:39], a[216:219], v[172:175], a[36:39]
    ds_read_u16 v137, v120 offset:37284
    ds_read_u16_d16_hi v141, v120 offset:37302
    v_mfma_f32_16x16x32_bf16 a[36:39], a[236:239], v[176:179], a[36:39]
    ds_write_b128 v248, a[8:11] offset:8576
    v_mfma_f32_16x16x32_bf16 a[20:23], a[120:123], v[180:183], a[20:23]
    ds_read_b128 v[172:175], v29 offset:2240
    v_mfma_f32_16x16x32_bf16 a[20:23], a[140:143], v[184:187], a[20:23]
    ds_read_u16 v138, v120 offset:37320
    ds_read_u16_d16_hi v142, v120 offset:37338
    v_mfma_f32_16x16x32_bf16 a[24:27], a[124:127], v[180:183], a[24:27]
    ds_read_b128 v[176:179], v27 offset:512
    v_mfma_f32_16x16x32_bf16 a[24:27], a[144:147], v[184:187], a[24:27]
    ds_write_b128 v248, a[12:15] offset:9600
    v_mfma_f32_16x16x32_bf16 a[28:31], a[128:131], v[180:183], a[28:31]
    ds_read_u16 v139, v120 offset:37356
    ds_read_u16_d16_hi v143, v120 offset:37374
    v_mfma_f32_16x16x32_bf16 a[28:31], a[148:151], v[184:187], a[28:31]
    s_waitcnt lgkmcnt(0)
    v_and_or_b32 v136, v140, s40, v136
    v_and_or_b32 v137, v141, s40, v137
    v_mfma_f32_16x16x32_bf16 a[32:35], a[132:135], v[180:183], a[32:35]
    v_and_or_b32 v138, v142, s40, v138
    v_and_or_b32 v139, v143, s40, v139
    v_mfma_f32_16x16x32_bf16 a[32:35], a[152:155], v[184:187], a[32:35]
    ds_write_b128 v248, a[16:19] offset:10624
    v_mfma_f32_16x16x32_bf16 a[36:39], a[136:139], v[180:183], a[36:39]
    buffer_store_dwordx4 v[136:139], v123, s[84:87], 0 offen sc1
    v_mfma_f32_16x16x32_bf16 a[36:39], a[156:159], v[184:187], a[36:39]
    ds_read_u16 v144, v121 offset:37248
    ds_read_u16_d16_hi v148, v121 offset:37266
    v_mfma_f32_16x16x32_bf16 a[40:43], a[200:203], v[156:159], a[40:43]
    ds_read_b128 v[180:183], v27 offset:1600
    v_mfma_f32_16x16x32_bf16 a[40:43], a[220:223], v[160:163], a[40:43]
    ds_write_b128 v248, a[20:23] offset:11648
    v_mfma_f32_16x16x32_bf16 a[44:47], a[204:207], v[156:159], a[44:47]
    ds_read_b128 v[184:187], v27 offset:2688
    v_mfma_f32_16x16x32_bf16 a[44:47], a[224:227], v[160:163], a[44:47]
    ds_read_u16 v145, v121 offset:37284
    ds_read_u16_d16_hi v149, v121 offset:37302
    v_mfma_f32_16x16x32_bf16 a[48:51], a[208:211], v[156:159], a[48:51]
    ds_read_u16 v146, v121 offset:37320
    ds_read_u16_d16_hi v150, v121 offset:37338
    v_mfma_f32_16x16x32_bf16 a[48:51], a[228:231], v[160:163], a[48:51]
    ds_read_u16 v147, v121 offset:37356
    ds_read_u16_d16_hi v151, v121 offset:37374
    v_mfma_f32_16x16x32_bf16 a[52:55], a[212:215], v[156:159], a[52:55]
    ds_write_b128 v248, a[24:27] offset:12672
    v_mfma_f32_16x16x32_bf16 a[52:55], a[232:235], v[160:163], a[52:55]
    v_mfma_f32_16x16x32_bf16 a[56:59], a[216:219], v[156:159], a[56:59]
    v_mfma_f32_16x16x32_bf16 a[56:59], a[236:239], v[160:163], a[56:59]
    v_mfma_f32_16x16x32_bf16 a[40:43], a[120:123], v[164:167], a[40:43]
    ds_read_b128 v[156:159], v28 offset:576
    v_mfma_f32_16x16x32_bf16 a[40:43], a[140:143], v[168:171], a[40:43]
    ds_write_b128 v248, a[28:31] offset:13696
    v_mfma_f32_16x16x32_bf16 a[40:43], a[160:163], v[172:175], a[40:43]
    ds_read_b128 v[160:163], v29 offset:2752
    v_mfma_f32_16x16x32_bf16 a[44:47], a[124:127], v[164:167], a[44:47]
    s_waitcnt lgkmcnt(4)
    v_and_or_b32 v144, v148, s40, v144
    v_and_or_b32 v145, v149, s40, v145
    v_mfma_f32_16x16x32_bf16 a[44:47], a[144:147], v[168:171], a[44:47]
    v_and_or_b32 v146, v150, s40, v146
    v_and_or_b32 v147, v151, s40, v147
    v_mfma_f32_16x16x32_bf16 a[44:47], a[164:167], v[172:175], a[44:47]
    buffer_store_dwordx4 v[144:147], v124, s[84:87], 0 offen sc1
    v_mfma_f32_16x16x32_bf16 a[48:51], a[128:131], v[164:167], a[48:51]
    ds_write_b128 v248, a[32:35] offset:14720
    v_mfma_f32_16x16x32_bf16 a[48:51], a[148:151], v[168:171], a[48:51]
    v_mfma_f32_16x16x32_bf16 a[48:51], a[168:171], v[172:175], a[48:51]
    v_mfma_f32_16x16x32_bf16 a[52:55], a[132:135], v[164:167], a[52:55]
    v_mfma_f32_16x16x32_bf16 a[52:55], a[152:155], v[168:171], a[52:55]
    v_mfma_f32_16x16x32_bf16 a[52:55], a[172:175], v[172:175], a[52:55]
    ds_write_b128 v248, a[36:39] offset:15744
    v_mfma_f32_16x16x32_bf16 a[56:59], a[136:139], v[164:167], a[56:59]
    ds_read_b128 v[164:167], v30 offset:0
    v_mfma_f32_16x16x32_bf16 a[56:59], a[156:159], v[168:171], a[56:59]
    v_mfma_f32_16x16x32_bf16 a[56:59], a[176:179], v[172:175], a[56:59]
    v_mfma_f32_16x16x32_bf16 a[60:63], a[200:203], v[176:179], a[60:63]
    ds_read_b128 v[168:171], v30 offset:1088
    v_mfma_f32_16x16x32_bf16 a[60:63], a[220:223], v[180:183], a[60:63]
    ds_write_b128 v248, a[40:43] offset:16768
    v_mfma_f32_16x16x32_bf16 a[64:67], a[204:207], v[176:179], a[64:67]
    s_waitcnt lgkmcnt(3)
    s_barrier
    v_mfma_f32_16x16x32_bf16 a[64:67], a[224:227], v[180:183], a[64:67]
    ds_read_b128 v[76:79], v249 offset:6528
    v_mfma_f32_16x16x32_bf16 a[68:71], a[208:211], v[176:179], a[68:71]
    ds_read_b128 v[80:83], v249 offset:7552
    v_mfma_f32_16x16x32_bf16 a[68:71], a[228:231], v[180:183], a[68:71]
    ds_read_b128 v[172:175], v30 offset:2176
    v_mfma_f32_16x16x32_bf16 a[72:75], a[212:215], v[176:179], a[72:75]
    ds_write_b128 v248, a[44:47] offset:17792
    v_mfma_f32_16x16x32_bf16 a[72:75], a[232:235], v[180:183], a[72:75]
    ds_read_b128 v[84:87], v249 offset:8576
    v_mfma_f32_16x16x32_bf16 a[76:79], a[216:219], v[176:179], a[76:79]
    ds_read_b128 v[88:91], v249 offset:9600
    v_mfma_f32_16x16x32_bf16 a[76:79], a[236:239], v[180:183], a[76:79]
    ds_read_b128 v[92:95], v249 offset:10624
    v_mfma_f32_16x16x32_bf16 a[60:63], a[120:123], v[184:187], a[60:63]
    ds_read_b128 v[176:179], v31 offset:64
    v_mfma_f32_16x16x32_bf16 a[60:63], a[140:143], v[156:159], a[60:63]
    ds_write_b128 v248, a[48:51] offset:18816
    v_mfma_f32_16x16x32_bf16 a[60:63], a[160:163], v[160:163], a[60:63]
    ds_read_b128 v[96:99], v249 offset:11648
    v_mfma_f32_16x16x32_bf16 a[64:67], a[124:127], v[184:187], a[64:67]
    ds_read_b128 v[100:103], v249 offset:12672
    v_mfma_f32_16x16x32_bf16 a[64:67], a[144:147], v[156:159], a[64:67]
    ds_read_b128 v[104:107], v249 offset:13696
    v_mfma_f32_16x16x32_bf16 a[64:67], a[164:167], v[160:163], a[64:67]
    ds_read_b128 v[180:183], v30 offset:512
    v_mfma_f32_16x16x32_bf16 a[68:71], a[128:131], v[184:187], a[68:71]
    ds_write_b128 v248, a[52:55] offset:19840
    v_mfma_f32_16x16x32_bf16 a[68:71], a[148:151], v[156:159], a[68:71]
    ds_read_b128 v[108:111], v249 offset:14720
    v_mfma_f32_16x16x32_bf16 a[68:71], a[168:171], v[160:163], a[68:71]
    ds_read_b128 v[112:115], v249 offset:15744
    v_mfma_f32_16x16x32_bf16 a[72:75], a[132:135], v[184:187], a[72:75]
    s_waitcnt lgkmcnt(9)
    v_add_f32 v36, v36, v76
    v_add_f32 v37, v37, v77
    v_mfma_f32_16x16x32_bf16 a[72:75], a[152:155], v[156:159], a[72:75]
    v_add_f32 v38, v38, v78
    v_add_f32 v39, v39, v79
    v_mfma_f32_16x16x32_bf16 a[72:75], a[172:175], v[160:163], a[72:75]
    ds_write_b128 v248, a[56:59] offset:20864
    v_mfma_f32_16x16x32_bf16 a[76:79], a[136:139], v[184:187], a[76:79]
    v_add_f32 v40, v40, v80
    v_add_f32 v41, v41, v81
    v_mfma_f32_16x16x32_bf16 a[76:79], a[156:159], v[156:159], a[76:79]
    v_add_f32 v42, v42, v82
    v_add_f32 v43, v43, v83
    v_mfma_f32_16x16x32_bf16 a[76:79], a[176:179], v[160:163], a[76:79]
    v_add_f32 v44, v44, v84
    v_add_f32 v45, v45, v85
    v_mfma_f32_16x16x32_bf16 a[80:83], a[200:203], v[164:167], a[80:83]
    ds_read_b128 v[184:187], v30 offset:1600
    v_add_f32 v46, v46, v86
    v_add_f32 v47, v47, v87
    v_mfma_f32_16x16x32_bf16 a[80:83], a[220:223], v[168:171], a[80:83]
    ds_write_b128 v248, a[60:63] offset:21888
    v_mfma_f32_16x16x32_bf16 a[84:87], a[204:207], v[164:167], a[84:87]
    v_add_f32 v48, v48, v88
    v_add_f32 v49, v49, v89
    v_mfma_f32_16x16x32_bf16 a[84:87], a[224:227], v[168:171], a[84:87]
    v_add_f32 v50, v50, v90
    v_add_f32 v51, v51, v91
    v_mfma_f32_16x16x32_bf16 a[88:91], a[208:211], v[164:167], a[88:91]
    v_add_f32 v52, v52, v92
    v_add_f32 v53, v53, v93
    v_mfma_f32_16x16x32_bf16 a[88:91], a[228:231], v[168:171], a[88:91]
    ds_read_b128 v[156:159], v30 offset:2688
    v_add_f32 v54, v54, v94
    v_add_f32 v55, v55, v95
    v_mfma_f32_16x16x32_bf16 a[92:95], a[212:215], v[164:167], a[92:95]
    ds_write_b128 v248, a[64:67] offset:22912
    v_mfma_f32_16x16x32_bf16 a[92:95], a[232:235], v[168:171], a[92:95]
    s_waitcnt lgkmcnt(5)
    v_add_f32 v56, v56, v96
    v_add_f32 v57, v57, v97
    v_mfma_f32_16x16x32_bf16 a[96:99], a[216:219], v[164:167], a[96:99]
    v_add_f32 v58, v58, v98
    v_add_f32 v59, v59, v99
    v_mfma_f32_16x16x32_bf16 a[96:99], a[236:239], v[168:171], a[96:99]
    ds_write_b128 v248, a[68:71] offset:23936
    v_mfma_f32_16x16x32_bf16 a[80:83], a[120:123], v[172:175], a[80:83]
    ds_read_b128 v[160:163], v31 offset:576
    v_add_f32 v60, v60, v100
    v_add_f32 v61, v61, v101
    v_mfma_f32_16x16x32_bf16 a[80:83], a[140:143], v[176:179], a[80:83]
    v_add_f32 v62, v62, v102
    v_add_f32 v63, v63, v103
    v_mfma_f32_16x16x32_bf16 a[84:87], a[124:127], v[172:175], a[84:87]
    v_add_f32 v64, v64, v104
    v_add_f32 v65, v65, v105
    v_mfma_f32_16x16x32_bf16 a[84:87], a[144:147], v[176:179], a[84:87]
    ds_write_b128 v248, a[72:75] offset:24960
    v_mfma_f32_16x16x32_bf16 a[88:91], a[128:131], v[172:175], a[88:91]
    v_add_f32 v66, v66, v106
    v_add_f32 v67, v67, v107
    v_mfma_f32_16x16x32_bf16 a[88:91], a[148:151], v[176:179], a[88:91]
    ds_read_b128 v[164:167], v33 offset:0
    v_add_f32 v68, v68, v108
    v_add_f32 v69, v69, v109
    v_mfma_f32_16x16x32_bf16 a[92:95], a[132:135], v[172:175], a[92:95]
    v_add_f32 v70, v70, v110
    v_add_f32 v71, v71, v111
    v_mfma_f32_16x16x32_bf16 a[92:95], a[152:155], v[176:179], a[92:95]
    ds_write_b128 v248, a[76:79] offset:25984
    v_mfma_f32_16x16x32_bf16 a[96:99], a[136:139], v[172:175], a[96:99]
    s_waitcnt lgkmcnt(8)
    v_add_f32 v72, v72, v112
    v_add_f32 v73, v73, v113
    v_mfma_f32_16x16x32_bf16 a[96:99], a[156:159], v[176:179], a[96:99]
    v_add_f32 v74, v74, v114
    v_add_f32 v75, v75, v115
    v_mfma_f32_16x16x32_bf16 a[100:103], a[200:203], v[180:183], a[100:103]
    ds_read_b128 v[168:171], v33 offset:1088
    v_mfma_f32_16x16x32_bf16 a[100:103], a[220:223], v[184:187], a[100:103]
    ds_write_b128 v248, a[80:83] offset:27008
    v_mfma_f32_16x16x32_bf16 a[104:107], a[204:207], v[180:183], a[104:107]
    s_waitcnt lgkmcnt(2)
    s_barrier
    v_mfma_f32_16x16x32_bf16 a[104:107], a[224:227], v[184:187], a[104:107]
    ds_read_b128 v[136:139], v250 offset:21888
    v_mfma_f32_16x16x32_bf16 a[108:111], a[208:211], v[180:183], a[108:111]
    ds_read_b128 v[140:143], v250 offset:22912
    v_mfma_f32_16x16x32_bf16 a[108:111], a[228:231], v[184:187], a[108:111]
    ds_read_b128 v[172:175], v33 offset:2176
    v_mfma_f32_16x16x32_bf16 a[112:115], a[212:215], v[180:183], a[112:115]
    ds_write_b128 v248, a[84:87] offset:28032
    v_mfma_f32_16x16x32_bf16 a[112:115], a[232:235], v[184:187], a[112:115]
    ds_read_b128 v[144:147], v250 offset:23936
    v_mfma_f32_16x16x32_bf16 a[116:119], a[216:219], v[180:183], a[116:119]
    ds_read_b128 v[148:151], v250 offset:24960
    v_mfma_f32_16x16x32_bf16 a[116:119], a[236:239], v[184:187], a[116:119]
    ds_write_b128 v248, a[88:91] offset:29056
    v_mfma_f32_16x16x32_bf16 a[100:103], a[120:123], v[156:159], a[100:103]
    ds_read_b128 v[176:179], v34 offset:64
    v_mfma_f32_16x16x32_bf16 a[100:103], a[140:143], v[160:163], a[100:103]
    ds_read_b128 v[152:155], v250 offset:25984
    v_mfma_f32_16x16x32_bf16 a[104:107], a[124:127], v[156:159], a[104:107]
    ds_read_b128 v[116:119], v250 offset:16768
    v_mfma_f32_16x16x32_bf16 a[104:107], a[144:147], v[160:163], a[104:107]
    ds_write_b128 v248, a[92:95] offset:30080
    v_mfma_f32_16x16x32_bf16 a[108:111], a[128:131], v[156:159], a[108:111]
    ds_read_b128 v[120:123], v250 offset:17792
    v_mfma_f32_16x16x32_bf16 a[108:111], a[148:151], v[160:163], a[108:111]
    ds_read_b128 v[180:183], v35 offset:2240
    v_mfma_f32_16x16x32_bf16 a[112:115], a[132:135], v[156:159], a[112:115]
    ds_read_b128 v[124:127], v250 offset:18816
    v_mfma_f32_16x16x32_bf16 a[112:115], a[152:155], v[160:163], a[112:115]
    ds_write_b128 v248, a[96:99] offset:31104
    v_mfma_f32_16x16x32_bf16 a[116:119], a[136:139], v[156:159], a[116:119]
    s_waitcnt lgkmcnt(15)
    ds_read_b128 v[128:131], v250 offset:19840
    v_mfma_f32_16x16x32_bf16 a[116:119], a[156:159], v[160:163], a[116:119]
    ds_read_b128 v[132:135], v250 offset:20864
    v_mfma_f32_16x16x32_bf16 v[36:39], a[200:203], v[164:167], v[36:39]
    ds_read_b128 v[184:187], v33 offset:512
    v_mfma_f32_16x16x32_bf16 v[36:39], a[220:223], v[168:171], v[36:39]
    ds_write_b128 v248, a[100:103] offset:32128
    v_mfma_f32_16x16x32_bf16 v[40:43], a[204:207], v[164:167], v[40:43]
    s_waitcnt lgkmcnt(10)
    v_add_f32 v56, v56, v136
    v_add_f32 v57, v57, v137
    v_mfma_f32_16x16x32_bf16 v[40:43], a[224:227], v[168:171], v[40:43]
    v_add_f32 v58, v58, v138
    v_add_f32 v59, v59, v139
    v_mfma_f32_16x16x32_bf16 v[44:47], a[208:211], v[164:167], v[44:47]
    v_add_f32 v60, v60, v140
    v_add_f32 v61, v61, v141
    v_mfma_f32_16x16x32_bf16 v[44:47], a[228:231], v[168:171], v[44:47]
    ds_read_b128 v[156:159], v33 offset:1600
    v_mfma_f32_16x16x32_bf16 v[48:51], a[212:215], v[164:167], v[48:51]
    ds_write_b128 v248, a[104:107] offset:33152
    v_mfma_f32_16x16x32_bf16 v[48:51], a[232:235], v[168:171], v[48:51]
    v_add_f32 v62, v62, v142
    v_add_f32 v63, v63, v143
    v_mfma_f32_16x16x32_bf16 v[52:55], a[216:219], v[164:167], v[52:55]
    s_waitcnt lgkmcnt(8)
    v_add_f32 v64, v64, v144
    v_add_f32 v65, v65, v145
    v_mfma_f32_16x16x32_bf16 v[52:55], a[236:239], v[168:171], v[52:55]
    v_add_f32 v66, v66, v146
    v_add_f32 v67, v67, v147
    v_mfma_f32_16x16x32_bf16 v[36:39], a[120:123], v[172:175], v[36:39]
    ds_read_b128 v[160:163], v33 offset:2688
    v_mfma_f32_16x16x32_bf16 v[36:39], a[140:143], v[176:179], v[36:39]
    ds_write_b128 v248, a[108:111] offset:34176
    v_mfma_f32_16x16x32_bf16 v[36:39], a[160:163], v[180:183], v[36:39]
    v_add_f32 v68, v68, v148
    v_add_f32 v69, v69, v149
    v_mfma_f32_16x16x32_bf16 v[40:43], a[124:127], v[172:175], v[40:43]
    v_add_f32 v70, v70, v150
    v_add_f32 v71, v71, v151
    v_mfma_f32_16x16x32_bf16 v[40:43], a[144:147], v[176:179], v[40:43]
    v_add_f32 v72, v72, v152
    v_add_f32 v73, v73, v153
    v_mfma_f32_16x16x32_bf16 v[40:43], a[164:167], v[180:183], v[40:43]
    ds_read_b128 v[164:167], v34 offset:576
    v_add_f32 v74, v74, v154
    v_add_f32 v75, v75, v155
    v_mfma_f32_16x16x32_bf16 v[44:47], a[128:131], v[172:175], v[44:47]
    ds_write_b128 v248, a[112:115] offset:35200
    v_mfma_f32_16x16x32_bf16 v[44:47], a[148:151], v[176:179], v[44:47]
    ds_read_b128 v[168:171], v35 offset:2752
    v_mfma_f32_16x16x32_bf16 v[44:47], a[168:171], v[180:183], v[44:47]
    v_mfma_f32_16x16x32_bf16 v[48:51], a[132:135], v[172:175], v[48:51]
    v_mfma_f32_16x16x32_bf16 v[48:51], a[152:155], v[176:179], v[48:51]
    v_mfma_f32_16x16x32_bf16 v[48:51], a[172:175], v[180:183], v[48:51]
    ds_write_b128 v248, a[116:119] offset:36224
    v_mfma_f32_16x16x32_bf16 v[52:55], a[136:139], v[172:175], v[52:55]
    v_mfma_f32_16x16x32_bf16 v[52:55], a[156:159], v[176:179], v[52:55]
    s_waitcnt lgkmcnt(7)
    v_mfma_f32_16x16x32_bf16 v[52:55], a[176:179], v[180:183], v[52:55]
    v_mfma_f32_16x16x32_bf16 v[56:59], a[200:203], v[184:187], v[56:59]
    v_mfma_f32_16x16x32_bf16 v[56:59], a[220:223], v[156:159], v[56:59]
    v_mfma_f32_16x16x32_bf16 v[60:63], a[204:207], v[184:187], v[60:63]
    s_waitcnt lgkmcnt(0)
    s_barrier
    v_mfma_f32_16x16x32_bf16 v[60:63], a[224:227], v[156:159], v[60:63]
    ds_read_b128 v[76:79], v251 offset:27008
    v_add_f32 v36, v36, v116
    v_add_f32 v37, v37, v117
    v_mfma_f32_16x16x32_bf16 v[64:67], a[208:211], v[184:187], v[64:67]
    ds_read_b128 v[80:83], v251 offset:28032
    v_add_f32 v38, v38, v118
    v_add_f32 v39, v39, v119
    v_mfma_f32_16x16x32_bf16 v[64:67], a[228:231], v[156:159], v[64:67]
    ds_read_b128 v[84:87], v251 offset:29056
    v_add_f32 v40, v40, v120
    v_add_f32 v41, v41, v121
    v_mfma_f32_16x16x32_bf16 v[68:71], a[212:215], v[184:187], v[68:71]
    ds_read_b128 v[88:91], v251 offset:30080
    v_add_f32 v42, v42, v122
    v_add_f32 v43, v43, v123
    v_mfma_f32_16x16x32_bf16 v[68:71], a[232:235], v[156:159], v[68:71]
    ds_read_b128 v[92:95], v251 offset:31104
    v_add_f32 v44, v44, v124
    v_add_f32 v45, v45, v125
    v_mfma_f32_16x16x32_bf16 v[72:75], a[216:219], v[184:187], v[72:75]
    ds_read_b128 v[96:99], v251 offset:32128
    v_add_f32 v46, v46, v126
    v_add_f32 v47, v47, v127
    v_mfma_f32_16x16x32_bf16 v[72:75], a[236:239], v[156:159], v[72:75]
    ds_read_b128 v[100:103], v251 offset:33152
    v_add_f32 v48, v48, v128
    v_add_f32 v49, v49, v129
    v_mfma_f32_16x16x32_bf16 v[56:59], a[120:123], v[160:163], v[56:59]
    ds_read_b128 v[104:107], v251 offset:34176
    v_add_f32 v50, v50, v130
    v_add_f32 v51, v51, v131
    v_mfma_f32_16x16x32_bf16 v[56:59], a[140:143], v[164:167], v[56:59]
    ds_read_b128 v[108:111], v251 offset:35200
    v_add_f32 v52, v52, v132
    v_add_f32 v53, v53, v133
    v_mfma_f32_16x16x32_bf16 v[56:59], a[160:163], v[168:171], v[56:59]
    ds_read_b128 v[112:115], v251 offset:36224
    v_add_f32 v54, v54, v134
    v_add_f32 v55, v55, v135
    v_mfma_f32_16x16x32_bf16 v[60:63], a[124:127], v[160:163], v[60:63]
    s_waitcnt lgkmcnt(8)
    v_add_f32 v36, v36, v76
    v_add_f32 v37, v37, v77
    v_mfma_f32_16x16x32_bf16 v[60:63], a[144:147], v[164:167], v[60:63]
    v_add_f32 v38, v38, v78
    v_add_f32 v39, v39, v79
    v_mfma_f32_16x16x32_bf16 v[60:63], a[164:167], v[168:171], v[60:63]
    v_add_f32 v40, v40, v80
    v_add_f32 v41, v41, v81
    v_mfma_f32_16x16x32_bf16 v[64:67], a[128:131], v[160:163], v[64:67]
    v_add_f32 v42, v42, v82
    v_add_f32 v43, v43, v83
    v_mfma_f32_16x16x32_bf16 v[64:67], a[148:151], v[164:167], v[64:67]
    s_waitcnt lgkmcnt(5)
    v_add_f32 v44, v44, v84
    v_add_f32 v45, v45, v85
    v_mfma_f32_16x16x32_bf16 v[64:67], a[168:171], v[168:171], v[64:67]
    v_add_f32 v46, v46, v86
    v_add_f32 v47, v47, v87
    v_mfma_f32_16x16x32_bf16 v[68:71], a[132:135], v[160:163], v[68:71]
    v_add_f32 v48, v48, v88
    v_add_f32 v49, v49, v89
    v_mfma_f32_16x16x32_bf16 v[68:71], a[152:155], v[164:167], v[68:71]
    v_add_f32 v50, v50, v90
    v_add_f32 v51, v51, v91
    v_mfma_f32_16x16x32_bf16 v[68:71], a[172:175], v[168:171], v[68:71]
    v_add_f32 v52, v52, v92
    v_add_f32 v53, v53, v93
    v_mfma_f32_16x16x32_bf16 v[72:75], a[136:139], v[160:163], v[72:75]
    v_add_f32 v54, v54, v94
    v_add_f32 v55, v55, v95
    v_mfma_f32_16x16x32_bf16 v[72:75], a[156:159], v[164:167], v[72:75]
    v_mfma_f32_16x16x32_bf16 v[72:75], a[176:179], v[168:171], v[72:75]
    s_waitcnt lgkmcnt(4)
    v_pk_add_f32 v[56:57], v[56:57], v[96:97]
    v_pk_add_f32 v[58:59], v[58:59], v[98:99]
    s_waitcnt lgkmcnt(3)
    v_pk_add_f32 v[60:61], v[60:61], v[100:101]
    v_pk_add_f32 v[62:63], v[62:63], v[102:103]
    s_waitcnt lgkmcnt(2)
    v_pk_add_f32 v[64:65], v[64:65], v[104:105]
    v_pk_add_f32 v[66:67], v[66:67], v[106:107]
    s_waitcnt lgkmcnt(1)
    v_pk_add_f32 v[68:69], v[68:69], v[108:109]
    v_pk_add_f32 v[70:71], v[70:71], v[110:111]
    s_waitcnt lgkmcnt(0)
    v_pk_add_f32 v[72:73], v[72:73], v[112:113]
    v_pk_add_f32 v[74:75], v[74:75], v[114:115]
    v_readfirstlane_b32 s98, v36
    s_nop 1
    v_sub_f32 v76, 0, s98
    v_sub_f32 v77, 0, s98
    v_pk_add_f32 v[36:37], v[36:37], v[76:77]
    v_pk_add_f32 v[38:39], v[38:39], v[76:77]
    v_pk_add_f32 v[40:41], v[40:41], v[76:77]
    v_pk_add_f32 v[42:43], v[42:43], v[76:77]
    v_pk_add_f32 v[44:45], v[44:45], v[76:77]
    v_pk_add_f32 v[46:47], v[46:47], v[76:77]
    v_pk_add_f32 v[48:49], v[48:49], v[76:77]
    v_pk_add_f32 v[50:51], v[50:51], v[76:77]
    v_pk_add_f32 v[52:53], v[52:53], v[76:77]
    v_pk_add_f32 v[54:55], v[54:55], v[76:77]
    v_pk_add_f32 v[56:57], v[56:57], v[76:77]
    v_pk_add_f32 v[58:59], v[58:59], v[76:77]
    v_pk_add_f32 v[60:61], v[60:61], v[76:77]
    v_pk_add_f32 v[62:63], v[62:63], v[76:77]
    v_pk_add_f32 v[64:65], v[64:65], v[76:77]
    v_pk_add_f32 v[66:67], v[66:67], v[76:77]
    v_pk_add_f32 v[68:69], v[68:69], v[76:77]
    v_pk_add_f32 v[70:71], v[70:71], v[76:77]
    v_pk_add_f32 v[72:73], v[72:73], v[76:77]
    v_pk_add_f32 v[74:75], v[74:75], v[76:77]
    v_pk_add_f32 v[78:79], v[36:37], v[40:41]
    v_pk_add_f32 v[80:81], v[38:39], v[42:43]
    v_pk_mul_f32 v[82:83], v[36:37], v[36:37]
    v_pk_mul_f32 v[84:85], v[38:39], v[38:39]
    v_pk_fma_f32 v[82:83], v[40:41], v[40:41], v[82:83]
    v_pk_fma_f32 v[84:85], v[42:43], v[42:43], v[84:85]
    v_pk_add_f32 v[78:79], v[78:79], v[44:45]
    v_pk_fma_f32 v[82:83], v[44:45], v[44:45], v[82:83]
    v_pk_add_f32 v[80:81], v[80:81], v[46:47]
    v_pk_fma_f32 v[84:85], v[46:47], v[46:47], v[84:85]
    v_pk_add_f32 v[78:79], v[78:79], v[48:49]
    v_pk_fma_f32 v[82:83], v[48:49], v[48:49], v[82:83]
    v_pk_add_f32 v[80:81], v[80:81], v[50:51]
    v_pk_fma_f32 v[84:85], v[50:51], v[50:51], v[84:85]
    v_pk_add_f32 v[78:79], v[78:79], v[52:53]
    v_pk_fma_f32 v[82:83], v[52:53], v[52:53], v[82:83]
    v_pk_add_f32 v[80:81], v[80:81], v[54:55]
    v_pk_fma_f32 v[84:85], v[54:55], v[54:55], v[84:85]
    v_pk_add_f32 v[78:79], v[78:79], v[56:57]
    v_pk_fma_f32 v[82:83], v[56:57], v[56:57], v[82:83]
    v_pk_add_f32 v[80:81], v[80:81], v[58:59]
    v_pk_fma_f32 v[84:85], v[58:59], v[58:59], v[84:85]
    v_pk_add_f32 v[78:79], v[78:79], v[60:61]
    v_pk_fma_f32 v[82:83], v[60:61], v[60:61], v[82:83]
    v_pk_add_f32 v[80:81], v[80:81], v[62:63]
    v_pk_fma_f32 v[84:85], v[62:63], v[62:63], v[84:85]
    v_pk_add_f32 v[78:79], v[78:79], v[64:65]
    v_pk_fma_f32 v[82:83], v[64:65], v[64:65], v[82:83]
    v_pk_add_f32 v[80:81], v[80:81], v[66:67]
    v_pk_fma_f32 v[84:85], v[66:67], v[66:67], v[84:85]
    v_pk_add_f32 v[78:79], v[78:79], v[68:69]
    v_pk_fma_f32 v[82:83], v[68:69], v[68:69], v[82:83]
    v_pk_add_f32 v[80:81], v[80:81], v[70:71]
    v_pk_fma_f32 v[84:85], v[70:71], v[70:71], v[84:85]
    v_pk_add_f32 v[78:79], v[78:79], v[72:73]
    v_pk_fma_f32 v[82:83], v[72:73], v[72:73], v[82:83]
    v_pk_add_f32 v[80:81], v[80:81], v[74:75]
    v_pk_fma_f32 v[84:85], v[74:75], v[74:75], v[84:85]
    v_pk_add_f32 v[78:79], v[78:79], v[80:81]
    v_pk_add_f32 v[82:83], v[82:83], v[84:85]
    v_add_f32 v78, v78, v79
    v_add_f32 v79, v82, v83
    s_nop 0
    v_add_f32_dpp v78, v78, v78 quad_perm:[1,0,3,2] row_mask:0xf bank_mask:0xf
    v_add_f32_dpp v79, v79, v79 quad_perm:[1,0,3,2] row_mask:0xf bank_mask:0xf
    s_nop 0
    v_add_f32_dpp v78, v78, v78 quad_perm:[2,3,0,1] row_mask:0xf bank_mask:0xf
    v_add_f32_dpp v79, v79, v79 quad_perm:[2,3,0,1] row_mask:0xf bank_mask:0xf
    s_nop 0
    v_add_f32_dpp v78, v78, v78 row_half_mirror row_mask:0xf bank_mask:0xf
    v_add_f32_dpp v79, v79, v79 row_half_mirror row_mask:0xf bank_mask:0xf
    s_nop 0
    v_add_f32_dpp v78, v78, v78 row_mirror row_mask:0xf bank_mask:0xf
    v_add_f32_dpp v79, v79, v79 row_mirror row_mask:0xf bank_mask:0xf
    v_mov_b32 v82, v78
    v_mov_b32 v83, v79
    s_nop 0
    v_permlane16_swap_b32 v78, v82
    v_permlane16_swap_b32 v79, v83
    v_add_f32 v78, v78, v82
    v_add_f32 v79, v79, v83
    v_mov_b32 v82, v78
    v_mov_b32 v83, v79
    s_nop 0
    v_permlane32_swap_b32 v78, v82
    v_permlane32_swap_b32 v79, v83
    v_add_f32 v78, v78, v82
    v_add_f32 v79, v79, v83
    v_mul_f32 v82, 0x39cccccd, v78
    v_fma_f32 v87, -v82, v78, v79
    v_add_f32 v86, s98, v82
    s_lshl_b32 s40, s28, 3
    v_add_u32 v88, s40, v240
    ds_write_b64 v88, v[86:87]
    s_lshl_b32 s34, s59, 10
    s_add_u32 s34, s34, 14262272
    s_add_u32 s84, s26, s34
    s_addc_u32 s85, s27, 0
    s_mov_b32 s86, 1024
    s_mov_b32 s87, 0x00020000
    s_waitcnt vmcnt(0)
    s_waitcnt lgkmcnt(0)
    s_barrier
    s_cmp_lg_u32 s28, 0
    s_cbranch_scc1 L_e1_notw0
    ds_read_b128 v[92:95], v240
    ds_read_b128 v[96:99], v240 offset:16
    s_lshl_b32 s35, s31, 3
    s_lshr_b32 s36, s32, 1
    s_add_u32 s35, s35, s36
    s_memrealtime s[92:93]
    s_waitcnt lgkmcnt(0)
    s_mul_i32 s97, s93, 0x9e3779b1
    s_add_u32 s97, s97, s92
    v_add_f32 v86, v92, v94
    v_add_f32 v87, v96, v98
    v_add_f32 v86, v86, v87
    v_mul_f32 v80, 0x3e800000, v86
    v_add_f32 v87, v93, v95
    v_add_f32 v93, v97, v99
    v_add_f32 v87, v87, v93
    v_sub_f32 v92, v92, v80
    v_sub_f32 v94, v94, v80
    v_sub_f32 v96, v96, v80
    v_sub_f32 v98, v98, v80
    v_mul_f32 v93, v92, v92
    v_fmac_f32 v93, v94, v94
    v_fmac_f32 v93, v96, v96
    v_fmac_f32 v93, v98, v98
    v_fmac_f32 v87, 0x45200000, v93
    v_max_f32 v82, 0, v87
    v_mov_b32 v81, s92
    v_mov_b32 v83, s97
    s_mov_b64 exec, 1
    buffer_store_dwordx4 v[80:83], v241, s[84:87], s35 offen sc1
    s_mov_b64 exec, -1
L_e1_notw0:
L_e1_pub_done:
    v_mov_b32 v90, 0xbfb8aa3b
    v_mov_b32 v91, 0xbfb8aa3b
    v_lshlrev_b32 v100, 16, v208
    v_and_b32 v101, 0xffff0000, v208
    v_lshlrev_b32 v102, 16, v209
    v_and_b32 v103, 0xffff0000, v209
    v_lshlrev_b32 v104, 16, v210
    v_and_b32 v105, 0xffff0000, v210
    v_lshlrev_b32 v106, 16, v211
    v_and_b32 v107, 0xffff0000, v211
    v_lshlrev_b32 v108, 16, v212
    v_and_b32 v109, 0xffff0000, v212
    v_lshlrev_b32 v110, 16, v213
    v_and_b32 v111, 0xffff0000, v213
    v_lshlrev_b32 v112, 16, v214
    v_and_b32 v113, 0xffff0000, v214
    v_lshlrev_b32 v114, 16, v215
    v_and_b32 v115, 0xffff0000, v215
    v_lshlrev_b32 v116, 16, v216
    v_and_b32 v117, 0xffff0000, v216
    v_lshlrev_b32 v118, 16, v217
    v_and_b32 v119, 0xffff0000, v217
    v_lshlrev_b32 v120, 16, v218
    v_and_b32 v121, 0xffff0000, v218
    v_lshlrev_b32 v122, 16, v219
    v_and_b32 v123, 0xffff0000, v219
    v_lshlrev_b32 v124, 16, v220
    v_and_b32 v125, 0xffff0000, v220
    v_lshlrev_b32 v126, 16, v221
    v_and_b32 v127, 0xffff0000, v221
    v_lshlrev_b32 v128, 16, v222
    v_and_b32 v129, 0xffff0000, v222
    v_lshlrev_b32 v130, 16, v223
    v_and_b32 v131, 0xffff0000, v223
    v_lshlrev_b32 v132, 16, v224
    v_and_b32 v133, 0xffff0000, v224
    v_lshlrev_b32 v134, 16, v225
    v_and_b32 v135, 0xffff0000, v225
    v_lshlrev_b32 v136, 16, v226
    v_and_b32 v137, 0xffff0000, v226
    v_lshlrev_b32 v138, 16, v227
    v_and_b32 v139, 0xffff0000, v227
    v_pk_mul_f32 v[100:101], v[100:101], v[90:91]
    v_pk_mul_f32 v[102:103], v[102:103], v[90:91]
    v_pk_mul_f32 v[104:105], v[104:105], v[90:91]
    v_pk_mul_f32 v[106:107], v[106:107], v[90:91]
    v_pk_mul_f32 v[108:109], v[108:109], v[90:91]
    v_pk_mul_f32 v[110:111], v[110:111], v[90:91]
    v_pk_mul_f32 v[112:113], v[112:113], v[90:91]
    v_pk_mul_f32 v[114:115], v[114:115], v[90:91]
    v_pk_mul_f32 v[116:117], v[116:117], v[90:91]
    v_pk_mul_f32 v[118:119], v[118:119], v[90:91]
    v_pk_mul_f32 v[120:121], v[120:121], v[90:91]
    v_pk_mul_f32 v[122:123], v[122:123], v[90:91]
    v_pk_mul_f32 v[124:125], v[124:125], v[90:91]
    v_pk_mul_f32 v[126:127], v[126:127], v[90:91]
    v_pk_mul_f32 v[128:129], v[128:129], v[90:91]
    v_pk_mul_f32 v[130:131], v[130:131], v[90:91]
    v_pk_mul_f32 v[132:133], v[132:133], v[90:91]
    v_pk_mul_f32 v[134:135], v[134:135], v[90:91]
    v_pk_mul_f32 v[136:137], v[136:137], v[90:91]
    v_pk_mul_f32 v[138:139], v[138:139], v[90:91]
    v_pk_mul_f32 v[36:37], v[36:37], v[100:101]
    v_pk_mul_f32 v[38:39], v[38:39], v[102:103]
    v_pk_mul_f32 v[40:41], v[40:41], v[104:105]
    v_pk_mul_f32 v[42:43], v[42:43], v[106:107]
    v_pk_mul_f32 v[44:45], v[44:45], v[108:109]
    v_pk_mul_f32 v[46:47], v[46:47], v[110:111]
    v_pk_mul_f32 v[48:49], v[48:49], v[112:113]
    v_pk_mul_f32 v[50:51], v[50:51], v[114:115]
    v_pk_mul_f32 v[52:53], v[52:53], v[116:117]
    v_pk_mul_f32 v[54:55], v[54:55], v[118:119]
    v_pk_mul_f32 v[56:57], v[56:57], v[100:101]
    v_pk_mul_f32 v[58:59], v[58:59], v[102:103]
    v_pk_mul_f32 v[60:61], v[60:61], v[104:105]
    v_pk_mul_f32 v[62:63], v[62:63], v[106:107]
    v_pk_mul_f32 v[64:65], v[64:65], v[108:109]
    v_pk_mul_f32 v[66:67], v[66:67], v[110:111]
    v_pk_mul_f32 v[68:69], v[68:69], v[112:113]
    v_pk_mul_f32 v[70:71], v[70:71], v[114:115]
    v_pk_mul_f32 v[72:73], v[72:73], v[116:117]
    v_pk_mul_f32 v[74:75], v[74:75], v[118:119]
    s_mul_i32 s33, s59, 655360
    s_add_u32 s33, s33, 5242880
    s_add_u32 s76, s26, s33
    s_addc_u32 s77, s27, 0
    s_mov_b32 s78, 655360
    s_mov_b32 s79, 0x00020000
    s_add_u32 s37, s31, s28
    s_lshl_b32 s37, s37, 6
    s_add_u32 s37, s37, s32
    v_and_b32 v4, 15, v1
    v_add_u32 v4, s37, v4
    v_lshrrev_b32 v5, 4, v1
    v_bfe_u32 v6, v1, 2, 1
    v_lshlrev_b32 v6, 1, v6
    v_xor_b32 v6, v6, v5
    v_lshlrev_b32 v6, 4, v6
    v_lshl_add_u32 v6, v4, 6, v6
    v_lshlrev_b32 v7, 3, v5
    v_lshl_add_u32 v7, v4, 5, v7
    s_mov_b32 s36, 262144
    s_mov_b32 s37, 524288
    s_add_u32 s64, s64, 1884160
    s_addc_u32 s65, s65, 0
    s_add_u32 s60, s60, 5242880
    s_addc_u32 s61, s61, 0
    s_cmp_eq_u32 s28, 0
    s_cbranch_scc1 L_e1_isw0
    s_cmp_lg_u32 s99, 3
    s_cbranch_scc1 L_e1_nw2
    s_memrealtime s[92:93]
    s_waitcnt lgkmcnt(0)
    s_mul_i32 s97, s93, 0x9e3779b1
    s_add_u32 s97, s97, s92
    s_add_u32 s72, s26, 14278656
    s_addc_u32 s73, s27, 0
    s_mov_b32 s74, 4736
    s_mov_b32 s75, 0x00020000
    v_mov_b32 v228, s92
    v_mov_b32 v229, s97
    s_waitcnt vmcnt(0)
    s_mov_b64 exec, 1
    buffer_store_dwordx2 v[228:229], v241, s[72:75], s100 offen sc1
    s_mov_b64 exec, -1
L_e1_nw2:
    s_branch L_e1_wait
L_e1_isw0:
    v_and_b32 v8, 31, v1
    v_lshlrev_b32 v8, 4, v8
    s_sleep 8
    s_mov_b32 s38, 0
    buffer_load_dwordx4 v[140:143], v8, s[84:87], 0 offen sc1
L_e1_poll_loop:
    s_waitcnt vmcnt(0)
    v_cmp_gt_u32 vcc, s96, v141
    v_sub_u32 v143, v143, v141
    v_subrev_u32 v141, s96, v141
    v_cndmask_b32 v9, v252, v253, vcc
    v_cmp_eq_u32 s[94:95], v9, v143
    v_cmp_gt_u32 vcc, 0x10000000, v141
    s_nop 0
    s_and_b64 vcc, vcc, s[94:95]
    s_cmp_eq_u64 vcc, -1
    s_cbranch_scc1 L_e1_poll_ok0
    s_sleep 8
    s_cbranch_scc1 L_e1_poll_ok0
    buffer_load_dwordx4 v[140:143], v8, s[84:87], 0 offen sc1
    s_add_u32 s38, s38, 1
    s_cmp_lt_u32 s38, 2097152
    s_cbranch_scc1 L_e1_poll_loop
    s_waitcnt vmcnt(0)
L_e1_poll_ok0:
    v_mov_b32 v92, v140
    v_mov_b32 v94, v140
    v_mov_b32 v93, v142
L_e1_poll_done:
    s_nop 0
    v_add_f32_dpp v94, v94, v94 quad_perm:[1,0,3,2] row_mask:0xf bank_mask:0xf
    s_nop 1
    v_add_f32_dpp v94, v94, v94 quad_perm:[2,3,0,1] row_mask:0xf bank_mask:0xf
    s_nop 1
    v_add_f32_dpp v94, v94, v94 row_half_mirror row_mask:0xf bank_mask:0xf
    s_nop 1
    v_add_f32_dpp v94, v94, v94 row_mirror row_mask:0xf bank_mask:0xf
    v_mov_b32 v95, v94
    s_nop 1
    v_permlane16_swap_b32 v94, v95
    v_add_f32 v94, v94, v95
    v_mul_f32 v94, 0x3d000000, v94
    v_sub_f32 v92, v92, v94
    v_mul_f32 v92, v92, v92
    v_fmac_f32 v93, 0x46200000, v92
    s_nop 1
    v_add_f32_dpp v93, v93, v93 quad_perm:[1,0,3,2] row_mask:0xf bank_mask:0xf
    s_nop 1
    v_add_f32_dpp v93, v93, v93 quad_perm:[2,3,0,1] row_mask:0xf bank_mask:0xf
    s_nop 1
    v_add_f32_dpp v93, v93, v93 row_half_mirror row_mask:0xf bank_mask:0xf
    s_nop 1
    v_add_f32_dpp v93, v93, v93 row_mirror row_mask:0xf bank_mask:0xf
    v_mov_b32 v95, v93
    s_nop 1
    v_permlane16_swap_b32 v93, v95
    v_add_f32 v93, v93, v95
    v_mov_b32 v95, 0x3727c5ac
    v_fmac_f32 v95, 0x364ccccd, v93
    v_rsq_f32 v95, v95
    v_mov_b32 v96, 2
    ds_write_b96 v240, v[94:96] offset:32
    s_waitcnt lgkmcnt(0)
L_e1_wait:
    s_barrier
    ds_read_b64 v[94:95], v240 offset:32
    s_waitcnt lgkmcnt(0)
    v_sub_f32 v94, s98, v94
    v_mul_f32 v94, v94, v95
    v_pk_fma_f32 v[120:121], v[100:101], v[94:95], v[120:121] op_sel_hi:[1,0,1]
    v_pk_fma_f32 v[122:123], v[102:103], v[94:95], v[122:123] op_sel_hi:[1,0,1]
    v_pk_fma_f32 v[124:125], v[104:105], v[94:95], v[124:125] op_sel_hi:[1,0,1]
    v_pk_fma_f32 v[126:127], v[106:107], v[94:95], v[126:127] op_sel_hi:[1,0,1]
    v_pk_fma_f32 v[128:129], v[108:109], v[94:95], v[128:129] op_sel_hi:[1,0,1]
    v_pk_fma_f32 v[130:131], v[110:111], v[94:95], v[130:131] op_sel_hi:[1,0,1]
    v_pk_fma_f32 v[132:133], v[112:113], v[94:95], v[132:133] op_sel_hi:[1,0,1]
    v_pk_fma_f32 v[134:135], v[114:115], v[94:95], v[134:135] op_sel_hi:[1,0,1]
    v_pk_fma_f32 v[136:137], v[116:117], v[94:95], v[136:137] op_sel_hi:[1,0,1]
    v_pk_fma_f32 v[138:139], v[118:119], v[94:95], v[138:139] op_sel_hi:[1,0,1]
    v_pk_fma_f32 v[36:37], v[36:37], v[94:95], v[120:121] op_sel:[0,1,0] op_sel_hi:[1,1,1]
    v_pk_fma_f32 v[38:39], v[38:39], v[94:95], v[122:123] op_sel:[0,1,0] op_sel_hi:[1,1,1]
    v_pk_fma_f32 v[40:41], v[40:41], v[94:95], v[124:125] op_sel:[0,1,0] op_sel_hi:[1,1,1]
    v_pk_fma_f32 v[42:43], v[42:43], v[94:95], v[126:127] op_sel:[0,1,0] op_sel_hi:[1,1,1]
    v_pk_fma_f32 v[44:45], v[44:45], v[94:95], v[128:129] op_sel:[0,1,0] op_sel_hi:[1,1,1]
    v_pk_fma_f32 v[46:47], v[46:47], v[94:95], v[130:131] op_sel:[0,1,0] op_sel_hi:[1,1,1]
    v_pk_fma_f32 v[48:49], v[48:49], v[94:95], v[132:133] op_sel:[0,1,0] op_sel_hi:[1,1,1]
    v_pk_fma_f32 v[50:51], v[50:51], v[94:95], v[134:135] op_sel:[0,1,0] op_sel_hi:[1,1,1]
    v_pk_fma_f32 v[52:53], v[52:53], v[94:95], v[136:137] op_sel:[0,1,0] op_sel_hi:[1,1,1]
    v_pk_fma_f32 v[54:55], v[54:55], v[94:95], v[138:139] op_sel:[0,1,0] op_sel_hi:[1,1,1]
    v_pk_fma_f32 v[56:57], v[56:57], v[94:95], v[120:121] op_sel:[0,1,0] op_sel_hi:[1,1,1]
    v_pk_fma_f32 v[58:59], v[58:59], v[94:95], v[122:123] op_sel:[0,1,0] op_sel_hi:[1,1,1]
    v_pk_fma_f32 v[60:61], v[60:61], v[94:95], v[124:125] op_sel:[0,1,0] op_sel_hi:[1,1,1]
    v_pk_fma_f32 v[62:63], v[62:63], v[94:95], v[126:127] op_sel:[0,1,0] op_sel_hi:[1,1,1]
    v_pk_fma_f32 v[64:65], v[64:65], v[94:95], v[128:129] op_sel:[0,1,0] op_sel_hi:[1,1,1]
    v_pk_fma_f32 v[66:67], v[66:67], v[94:95], v[130:131] op_sel:[0,1,0] op_sel_hi:[1,1,1]
    v_pk_fma_f32 v[68:69], v[68:69], v[94:95], v[132:133] op_sel:[0,1,0] op_sel_hi:[1,1,1]
    v_pk_fma_f32 v[70:71], v[70:71], v[94:95], v[134:135] op_sel:[0,1,0] op_sel_hi:[1,1,1]
    v_pk_fma_f32 v[72:73], v[72:73], v[94:95], v[136:137] op_sel:[0,1,0] op_sel_hi:[1,1,1]
    v_pk_fma_f32 v[74:75], v[74:75], v[94:95], v[138:139] op_sel:[0,1,0] op_sel_hi:[1,1,1]
    v_exp_f32 v156, v36
    v_exp_f32 v157, v37
    v_exp_f32 v158, v38
    v_exp_f32 v159, v39
    v_exp_f32 v160, v40
    v_exp_f32 v161, v41
    v_exp_f32 v162, v42
    v_exp_f32 v163, v43
    v_pk_fma_f32 v[156:157], v[156:157], v[90:91], v[90:91]
    v_pk_fma_f32 v[158:159], v[158:159], v[90:91], v[90:91]
    v_pk_fma_f32 v[160:161], v[160:161], v[90:91], v[90:91]
    v_pk_fma_f32 v[162:163], v[162:163], v[90:91], v[90:91]
    v_rcp_f32 v156, v156
    v_rcp_f32 v157, v157
    v_rcp_f32 v158, v158
    v_rcp_f32 v159, v159
    v_rcp_f32 v160, v160
    v_rcp_f32 v161, v161
    v_rcp_f32 v162, v162
    v_rcp_f32 v163, v163
    v_pk_mul_f32 v[156:157], v[156:157], v[36:37]
    v_pk_mul_f32 v[158:159], v[158:159], v[38:39]
    v_pk_mul_f32 v[160:161], v[160:161], v[40:41]
    v_pk_mul_f32 v[162:163], v[162:163], v[42:43]
    v_cvt_pk_bf16_f32 v188, v156, v157
    v_cvt_pk_bf16_f32 v189, v158, v159
    v_cvt_pk_bf16_f32 v190, v160, v161
    v_cvt_pk_bf16_f32 v191, v162, v163
    buffer_store_dwordx4 v[188:191], v6, s[76:79], 0 offen offset:0 sc1
    v_exp_f32 v164, v44
    v_exp_f32 v165, v45
    v_exp_f32 v166, v46
    v_exp_f32 v167, v47
    v_exp_f32 v168, v48
    v_exp_f32 v169, v49
    v_exp_f32 v170, v50
    v_exp_f32 v171, v51
    v_exp_f32 v172, v52
    v_exp_f32 v173, v53
    v_exp_f32 v174, v54
    v_exp_f32 v175, v55
    v_pk_fma_f32 v[164:165], v[164:165], v[90:91], v[90:91]
    v_pk_fma_f32 v[166:167], v[166:167], v[90:91], v[90:91]
    v_pk_fma_f32 v[168:169], v[168:169], v[90:91], v[90:91]
    v_pk_fma_f32 v[170:171], v[170:171], v[90:91], v[90:91]
    v_pk_fma_f32 v[172:173], v[172:173], v[90:91], v[90:91]
    v_pk_fma_f32 v[174:175], v[174:175], v[90:91], v[90:91]
    v_rcp_f32 v164, v164
    v_rcp_f32 v165, v165
    v_rcp_f32 v166, v166
    v_rcp_f32 v167, v167
    v_rcp_f32 v168, v168
    v_rcp_f32 v169, v169
    v_rcp_f32 v170, v170
    v_rcp_f32 v171, v171
    v_rcp_f32 v172, v172
    v_rcp_f32 v173, v173
    v_rcp_f32 v174, v174
    v_rcp_f32 v175, v175
    v_pk_mul_f32 v[164:165], v[164:165], v[44:45]
    v_pk_mul_f32 v[166:167], v[166:167], v[46:47]
    v_pk_mul_f32 v[168:169], v[168:169], v[48:49]
    v_pk_mul_f32 v[170:171], v[170:171], v[50:51]
    v_pk_mul_f32 v[172:173], v[172:173], v[52:53]
    v_pk_mul_f32 v[174:175], v[174:175], v[54:55]
    v_cvt_pk_bf16_f32 v192, v164, v165
    v_cvt_pk_bf16_f32 v193, v166, v167
    v_cvt_pk_bf16_f32 v194, v168, v169
    v_cvt_pk_bf16_f32 v195, v170, v171
    v_cvt_pk_bf16_f32 v196, v172, v173
    v_cvt_pk_bf16_f32 v197, v174, v175
    buffer_store_dwordx4 v[192:195], v6, s[76:79], s36 offen offset:0 sc1
    buffer_store_dwordx2 v[196:197], v7, s[76:79], s37 offen offset:0 sc1
    v_exp_f32 v156, v56
    v_exp_f32 v157, v57
    v_exp_f32 v158, v58
    v_exp_f32 v159, v59
    v_exp_f32 v160, v60
    v_exp_f32 v161, v61
    v_exp_f32 v162, v62
    v_exp_f32 v163, v63
    v_pk_fma_f32 v[156:157], v[156:157], v[90:91], v[90:91]
    v_pk_fma_f32 v[158:159], v[158:159], v[90:91], v[90:91]
    v_pk_fma_f32 v[160:161], v[160:161], v[90:91], v[90:91]
    v_pk_fma_f32 v[162:163], v[162:163], v[90:91], v[90:91]
    v_rcp_f32 v156, v156
    v_rcp_f32 v157, v157
    v_rcp_f32 v158, v158
    v_rcp_f32 v159, v159
    v_rcp_f32 v160, v160
    v_rcp_f32 v161, v161
    v_rcp_f32 v162, v162
    v_rcp_f32 v163, v163
    v_pk_mul_f32 v[156:157], v[156:157], v[56:57]
    v_pk_mul_f32 v[158:159], v[158:159], v[58:59]
    v_pk_mul_f32 v[160:161], v[160:161], v[60:61]
    v_pk_mul_f32 v[162:163], v[162:163], v[62:63]
    v_cvt_pk_bf16_f32 v200, v156, v157
    v_cvt_pk_bf16_f32 v201, v158, v159
    v_cvt_pk_bf16_f32 v202, v160, v161
    v_cvt_pk_bf16_f32 v203, v162, v163
    buffer_store_dwordx4 v[200:203], v6, s[76:79], 0 offen offset:1024 sc1
    v_exp_f32 v164, v64
    v_exp_f32 v165, v65
    v_exp_f32 v166, v66
    v_exp_f32 v167, v67
    v_exp_f32 v168, v68
    v_exp_f32 v169, v69
    v_exp_f32 v170, v70
    v_exp_f32 v171, v71
    v_exp_f32 v172, v72
    v_exp_f32 v173, v73
    v_exp_f32 v174, v74
    v_exp_f32 v175, v75
    v_pk_fma_f32 v[164:165], v[164:165], v[90:91], v[90:91]
    v_pk_fma_f32 v[166:167], v[166:167], v[90:91], v[90:91]
    v_pk_fma_f32 v[168:169], v[168:169], v[90:91], v[90:91]
    v_pk_fma_f32 v[170:171], v[170:171], v[90:91], v[90:91]
    v_pk_fma_f32 v[172:173], v[172:173], v[90:91], v[90:91]
    v_pk_fma_f32 v[174:175], v[174:175], v[90:91], v[90:91]
    v_rcp_f32 v164, v164
    v_rcp_f32 v165, v165
    v_rcp_f32 v166, v166
    v_rcp_f32 v167, v167
    v_rcp_f32 v168, v168
    v_rcp_f32 v169, v169
    v_rcp_f32 v170, v170
    v_rcp_f32 v171, v171
    v_rcp_f32 v172, v172
    v_rcp_f32 v173, v173
    v_rcp_f32 v174, v174
    v_rcp_f32 v175, v175
    v_pk_mul_f32 v[164:165], v[164:165], v[64:65]
    v_pk_mul_f32 v[166:167], v[166:167], v[66:67]
    v_pk_mul_f32 v[168:169], v[168:169], v[68:69]
    v_pk_mul_f32 v[170:171], v[170:171], v[70:71]
    v_pk_mul_f32 v[172:173], v[172:173], v[72:73]
    v_pk_mul_f32 v[174:175], v[174:175], v[74:75]
    v_cvt_pk_bf16_f32 v204, v164, v165
    v_cvt_pk_bf16_f32 v205, v166, v167
    v_cvt_pk_bf16_f32 v206, v168, v169
    v_cvt_pk_bf16_f32 v207, v170, v171
    v_cvt_pk_bf16_f32 v208, v172, v173
    v_cvt_pk_bf16_f32 v209, v174, v175
    buffer_store_dwordx4 v[204:207], v6, s[76:79], s36 offen offset:1024 sc1
    buffer_store_dwordx2 v[208:209], v7, s[76:79], s37 offen offset:512 sc1
    s_lshl_b32 s33, s29, 11
    s_add_u32 s33, s33, 14274560
    s_add_u32 s84, s26, s33
    s_addc_u32 s85, s27, 0
    s_mov_b32 s86, 2048
    s_mov_b32 s87, 0x00020000
    s_lshr_b32 s34, s31, 2
    s_lshl_b32 s35, s34, 7
    s_add_u32 s35, s35, s32
    s_lshl_b32 s38, s30, 3
    s_add_u32 s35, s35, s38
    v_lshrrev_b32 v4, 3, v1
    v_add_u32 v4, s34, v4
    v_subrev_u32 v4, 1, v4
    v_cmp_lt_u32 s[90:91], 15, v4
    v_and_b32 v5, 7, v1
    v_lshlrev_b32 v5, 3, v5
    v_lshl_add_u32 v4, v4, 7, v5
    s_or_b32 s90, s90, 0xff000000
    s_lshl_b32 s38, 0x111111, s28
    s_orn2_b32 s90, s90, s38
    s_mov_b32 s91, -1
    v_mov_b32 v5, 0x40000000
    v_cndmask_b32 v4, v4, v5, s[90:91]
    s_cmp_lg_u32 s28, 3
    s_cbranch_scc1 L_e1_nofw
    s_add_u32 s72, s26, 14278656
    s_addc_u32 s73, s27, 0
    s_mov_b32 s74, 4736
    s_mov_b32 s75, 0x00020000
    v_lshlrev_b32 v8, 3, v1
    s_lshl_b32 s39, s30, 9
    s_lshl_b32 s40, s30, 7
    s_add_u32 s40, s40, 4096
    s_mov_b32 s38, 0
    buffer_load_dwordx2 v[140:141], v8, s[72:75], s39 offen offset:2048 sc1
L_e1_fw_loop:
    s_waitcnt vmcnt(0)
    v_cmp_gt_u32 vcc, s96, v140
    v_sub_u32 v141, v141, v140
    v_subrev_u32 v140, s96, v140
    v_cndmask_b32 v9, v252, v253, vcc
    v_cmp_eq_u32 s[94:95], v9, v141
    v_cmp_gt_u32 vcc, 0x10000000, v140
    s_nop 0
    s_and_b64 vcc, vcc, s[94:95]
    s_or_b32 vcc_lo, vcc_lo, 0x80008000
    s_or_b32 vcc_hi, vcc_hi, 0x80008000
    s_cmp_eq_u64 vcc, -1
    s_cbranch_scc1 L_e1_fw_ok0
    s_sleep 4
    s_cbranch_scc1 L_e1_fw_ok0
    buffer_load_dwordx2 v[140:141], v8, s[72:75], s39 offen offset:2048 sc1
    s_add_u32 s38, s38, 1
    s_cmp_lt_u32 s38, 2097152
    s_cbranch_scc1 L_e1_fw_loop
    s_waitcnt vmcnt(0)
L_e1_fw_ok0:
L_e1_fw_done:
L_e1_nofw:
    s_waitcnt vmcnt(0)
    s_barrier
    s_cmp_lg_u32 s28, 1
    s_cbranch_scc1 L_e1_nofl
    s_memrealtime s[92:93]
    s_waitcnt lgkmcnt(0)
    s_mul_i32 s97, s93, 0x9e3779b1
    s_add_u32 s97, s97, s92
    v_mov_b32 v228, s92
    v_mov_b32 v229, s97
    s_mov_b64 exec, 1
    buffer_store_dwordx2 v[228:229], v241, s[84:87], s35 offen sc1
    s_mov_b64 exec, -1
L_e1_nofl:
    s_mov_b32 s57, 0
    buffer_load_dwordx4 a[120:123], v2, s[64:67], s57 offen offset:0 sc1
    buffer_load_dwordx4 a[124:127], v2, s[64:67], s57 offen offset:1024 sc1
    buffer_load_dwordx4 a[128:131], v2, s[64:67], s57 offen offset:2048 sc1
    buffer_load_dwordx4 a[132:135], v2, s[64:67], s57 offen offset:3072 sc1
    buffer_load_dwordx4 a[136:139], v3, s[64:67], s57 offen sc1
    s_mov_b32 s57, 5120
    buffer_load_dwordx4 a[140:143], v2, s[64:67], s57 offen offset:0 sc1
    buffer_load_dwordx4 a[144:147], v2, s[64:67], s57 offen offset:1024 sc1
    buffer_load_dwordx4 a[148:151], v2, s[64:67], s57 offen offset:2048 sc1
    buffer_load_dwordx4 a[152:155], v2, s[64:67], s57 offen offset:3072 sc1
    buffer_load_dwordx4 a[156:159], v3, s[64:67], s57 offen sc1
    s_mov_b32 s57, 10240
    buffer_load_dwordx4 a[160:163], v2, s[64:67], s57 offen offset:0 sc1
    buffer_load_dwordx4 a[164:167], v2, s[64:67], s57 offen offset:1024 sc1
    buffer_load_dwordx4 a[168:171], v2, s[64:67], s57 offen offset:2048 sc1
    buffer_load_dwordx4 a[172:175], v2, s[64:67], s57 offen offset:3072 sc1
    buffer_load_dwordx4 a[176:179], v3, s[64:67], s57 offen sc1
    s_mov_b32 s57, 15360
    buffer_load_dwordx4 a[180:183], v2, s[64:67], s57 offen offset:0 sc1
    buffer_load_dwordx4 a[184:187], v2, s[64:67], s57 offen offset:1024 sc1
    buffer_load_dwordx4 a[188:191], v2, s[64:67], s57 offen offset:2048 sc1
    buffer_load_dwordx4 a[192:195], v2, s[64:67], s57 offen offset:3072 sc1
    buffer_load_dwordx4 a[196:199], v3, s[64:67], s57 offen sc1
L_e1_pre_done:
    s_mov_b32 s38, 0
    buffer_load_dwordx2 v[230:231], v4, s[84:87], 0 offen sc1
L_e1_fa_loop:
    s_waitcnt vmcnt(0)
    v_cmp_gt_u32 vcc, s96, v230
    v_sub_u32 v231, v231, v230
    v_subrev_u32 v230, s96, v230
    v_cndmask_b32 v9, v252, v253, vcc
    v_cmp_eq_u32 s[94:95], v9, v231
    v_cmp_gt_u32 vcc, 0x10000000, v230
    s_nop 0
    s_and_b64 vcc, vcc, s[94:95]
    s_or_b64 vcc, vcc, s[90:91]
    s_cmp_eq_u64 vcc, -1
    s_cbranch_scc1 L_e1_fa_ok0
    s_sleep 2
    s_cbranch_scc1 L_e1_fa_ok0
    buffer_load_dwordx2 v[230:231], v4, s[84:87], 0 offen sc1
    s_add_u32 s38, s38, 1
    s_cmp_lt_u32 s38, 2097152
    s_cbranch_scc1 L_e1_fa_loop
    s_waitcnt vmcnt(0)
L_e1_fa_ok0:
L_e1_fa_done:
L_e1_go2:
    buffer_load_dwordx4 v[188:191], v244, s[60:63], 0 offen sc1
    s_add_u32 m0, s47, 0
    s_add_u32 s35, s41, 0
    buffer_load_dwordx4 v2, s[60:63], s35 offen sc1 lds
    buffer_load_dwordx4 v2, s[60:63], s35 offen offset:1024 sc1 lds
    s_add_u32 m0, s48, 0
    s_add_u32 s35, s42, 0
    buffer_load_dwordx4 v2, s[60:63], s35 offen sc1 lds
    buffer_load_dwordx4 v2, s[60:63], s35 offen offset:1024 sc1 lds
    s_add_u32 m0, s49, 0
    s_add_u32 s35, s43, 0
    buffer_load_dwordx4 v2, s[60:63], s35 offen sc1 lds
    buffer_load_dwordx4 v2, s[60:63], s35 offen offset:1024 sc1 lds
    s_add_u32 m0, s50, 0
    s_add_u32 s35, s44, 0
    buffer_load_dwordx4 v2, s[60:63], s35 offen sc1 lds
    buffer_load_dwordx4 v2, s[60:63], s35 offen offset:1024 sc1 lds
    s_add_u32 m0, s51, 0
    s_add_u32 s35, s45, 0
    buffer_load_dwordx4 v2, s[60:63], s35 offen sc1 lds
    buffer_load_dwordx4 v2, s[60:63], s35 offen offset:1024 sc1 lds
    s_mov_b32 s36, 262144
    buffer_load_dwordx4 v[192:195], v244, s[60:63], s36 offen sc1
    s_waitcnt vmcnt(10)
    ds_read_b128 v[156:159], v13 offset:0
    s_waitcnt lgkmcnt(0)
    v_mfma_f32_16x16x32_bf16 a[0:3], v[156:159], a[120:123], 0
    s_waitcnt vmcnt(9)
    ds_write_b128 v246, v[188:191] offset:6528
    ds_read_b128 v[160:163], v12 offset:0
    s_waitcnt lgkmcnt(0)
    v_mfma_f32_16x16x32_bf16 a[0:3], v[160:163], a[140:143], a[0:3]
    s_mov_b32 s36, 524288
    buffer_load_dwordx4 v[196:199], v245, s[60:63], s36 offen sc1
    v_mfma_f32_16x16x32_bf16 a[4:7], v[156:159], a[124:127], 0
    ds_read_b128 v[164:167], v13 offset:1024
    v_mfma_f32_16x16x32_bf16 a[4:7], v[160:163], a[144:147], a[4:7]
    s_mov_b32 s57, 20480
    v_mfma_f32_16x16x32_bf16 a[8:11], v[156:159], a[128:131], 0
    buffer_load_dwordx4 a[200:203], v2, s[64:67], s57 offen offset:0 sc1
    v_mfma_f32_16x16x32_bf16 a[8:11], v[160:163], a[148:151], a[8:11]
    ds_read_b128 v[168:171], v12 offset:1024
    v_mfma_f32_16x16x32_bf16 a[12:15], v[156:159], a[132:135], 0
    v_mfma_f32_16x16x32_bf16 a[12:15], v[160:163], a[152:155], a[12:15]
    s_waitcnt vmcnt(10)
    ds_read_b128 v[172:175], v16 offset:0
    v_mfma_f32_16x16x32_bf16 a[16:19], v[156:159], a[136:139], 0
    s_waitcnt lgkmcnt(1)
    v_mfma_f32_16x16x32_bf16 a[16:19], v[160:163], a[156:159], a[16:19]
    buffer_load_dwordx4 a[204:207], v2, s[64:67], s57 offen offset:1024 sc1
    v_mfma_f32_16x16x32_bf16 a[20:23], v[164:167], a[120:123], 0
    s_waitcnt vmcnt(10)
    ds_read_b128 v[176:179], v15 offset:0
    v_mfma_f32_16x16x32_bf16 a[20:23], v[168:171], a[140:143], a[20:23]
    v_mfma_f32_16x16x32_bf16 a[24:27], v[164:167], a[124:127], 0
    ds_read_b128 v[180:183], v16 offset:1024
    v_mfma_f32_16x16x32_bf16 a[24:27], v[168:171], a[144:147], a[24:27]
    v_mfma_f32_16x16x32_bf16 a[28:31], v[164:167], a[128:131], 0
    buffer_load_dwordx4 a[208:211], v2, s[64:67], s57 offen offset:2048 sc1
    v_mfma_f32_16x16x32_bf16 a[28:31], v[168:171], a[148:151], a[28:31]
    ds_read_b128 v[184:187], v15 offset:1024
    v_mfma_f32_16x16x32_bf16 a[32:35], v[164:167], a[132:135], 0
    v_mfma_f32_16x16x32_bf16 a[32:35], v[168:171], a[152:155], a[32:35]
    s_waitcnt vmcnt(10)
    ds_read_b128 v[156:159], v19 offset:0
    v_mfma_f32_16x16x32_bf16 a[36:39], v[164:167], a[136:139], 0
    s_waitcnt lgkmcnt(3)
    v_mfma_f32_16x16x32_bf16 a[36:39], v[168:171], a[156:159], a[36:39]
    buffer_load_dwordx4 a[212:215], v2, s[64:67], s57 offen offset:3072 sc1
    v_mfma_f32_16x16x32_bf16 a[40:43], v[172:175], a[120:123], 0
    s_waitcnt vmcnt(10)
    ds_read_b128 v[160:163], v18 offset:0
    v_mfma_f32_16x16x32_bf16 a[40:43], v[176:179], a[140:143], a[40:43]
    v_mfma_f32_16x16x32_bf16 a[44:47], v[172:175], a[124:127], 0
    ds_read_b128 v[164:167], v19 offset:1024
    v_mfma_f32_16x16x32_bf16 a[44:47], v[176:179], a[144:147], a[44:47]
    v_mfma_f32_16x16x32_bf16 a[48:51], v[172:175], a[128:131], 0
    buffer_load_dwordx4 a[216:219], v3, s[64:67], s57 offen sc1
    v_mfma_f32_16x16x32_bf16 a[48:51], v[176:179], a[148:151], a[48:51]
    ds_read_b128 v[168:171], v18 offset:1024
    v_mfma_f32_16x16x32_bf16 a[52:55], v[172:175], a[132:135], 0
    v_mfma_f32_16x16x32_bf16 a[52:55], v[176:179], a[152:155], a[52:55]
    s_mov_b32 s57, 25600
    v_mfma_f32_16x16x32_bf16 a[56:59], v[172:175], a[136:139], 0
    s_waitcnt lgkmcnt(4)
    v_mfma_f32_16x16x32_bf16 a[56:59], v[176:179], a[156:159], a[56:59]
    buffer_load_dwordx4 a[220:223], v2, s[64:67], s57 offen offset:0 sc1
    v_mfma_f32_16x16x32_bf16 a[60:63], v[180:183], a[120:123], 0
    s_waitcnt vmcnt(11)
    ds_read_b128 v[172:175], v22 offset:0
    v_mfma_f32_16x16x32_bf16 a[60:63], v[184:187], a[140:143], a[60:63]
    v_mfma_f32_16x16x32_bf16 a[64:67], v[180:183], a[124:127], 0
    s_waitcnt vmcnt(10)
    ds_read_b128 v[176:179], v21 offset:0
    v_mfma_f32_16x16x32_bf16 a[64:67], v[184:187], a[144:147], a[64:67]
    v_mfma_f32_16x16x32_bf16 a[68:71], v[180:183], a[128:131], 0
    buffer_load_dwordx4 a[224:227], v2, s[64:67], s57 offen offset:1024 sc1
    v_mfma_f32_16x16x32_bf16 a[68:71], v[184:187], a[148:151], a[68:71]
    v_mfma_f32_16x16x32_bf16 a[72:75], v[180:183], a[132:135], 0
    v_mfma_f32_16x16x32_bf16 a[72:75], v[184:187], a[152:155], a[72:75]
    v_mfma_f32_16x16x32_bf16 a[76:79], v[180:183], a[136:139], 0
    s_waitcnt lgkmcnt(4)
    v_mfma_f32_16x16x32_bf16 a[76:79], v[184:187], a[156:159], a[76:79]
    buffer_load_dwordx4 a[228:231], v2, s[64:67], s57 offen offset:2048 sc1
    v_mfma_f32_16x16x32_bf16 a[80:83], v[156:159], a[120:123], 0
    ds_read_b128 v[180:183], v22 offset:1024
    v_mfma_f32_16x16x32_bf16 a[80:83], v[160:163], a[140:143], a[80:83]
    v_mfma_f32_16x16x32_bf16 a[84:87], v[156:159], a[124:127], 0
    ds_read_b128 v[184:187], v21 offset:1024
    v_mfma_f32_16x16x32_bf16 a[84:87], v[160:163], a[144:147], a[84:87]
    v_mfma_f32_16x16x32_bf16 a[88:91], v[156:159], a[128:131], 0
    buffer_load_dwordx4 a[232:235], v2, s[64:67], s57 offen offset:3072 sc1
    v_mfma_f32_16x16x32_bf16 a[88:91], v[160:163], a[148:151], a[88:91]
    v_mfma_f32_16x16x32_bf16 a[92:95], v[156:159], a[132:135], 0
    v_mfma_f32_16x16x32_bf16 a[92:95], v[160:163], a[152:155], a[92:95]
    v_mfma_f32_16x16x32_bf16 a[96:99], v[156:159], a[136:139], 0
    s_waitcnt lgkmcnt(4)
    v_mfma_f32_16x16x32_bf16 a[96:99], v[160:163], a[156:159], a[96:99]
    v_mfma_f32_16x16x32_bf16 a[100:103], v[164:167], a[120:123], 0
    ds_read_b128 v[156:159], v14 offset:0
    v_mfma_f32_16x16x32_bf16 a[100:103], v[168:171], a[140:143], a[100:103]
    v_mfma_f32_16x16x32_bf16 a[104:107], v[164:167], a[124:127], 0
    s_waitcnt vmcnt(12)
    ds_read_b128 v[160:163], v13 offset:2176
    v_mfma_f32_16x16x32_bf16 a[104:107], v[168:171], a[144:147], a[104:107]
    v_mfma_f32_16x16x32_bf16 a[108:111], v[164:167], a[128:131], 0
    buffer_load_dwordx4 a[236:239], v3, s[64:67], s57 offen sc1
    v_mfma_f32_16x16x32_bf16 a[108:111], v[168:171], a[148:151], a[108:111]
    s_add_u32 m0, s52, 0
    s_add_u32 s35, s46, 0
    v_mfma_f32_16x16x32_bf16 a[112:115], v[164:167], a[132:135], 0
    v_mfma_f32_16x16x32_bf16 a[112:115], v[168:171], a[152:155], a[112:115]
    v_mfma_f32_16x16x32_bf16 a[116:119], v[164:167], a[136:139], 0
    s_waitcnt lgkmcnt(4)
    v_mfma_f32_16x16x32_bf16 a[116:119], v[168:171], a[156:159], a[116:119]
    buffer_load_dwordx4 v2, s[60:63], s35 offen sc1 lds
    v_mfma_f32_16x16x32_bf16 v[36:39], v[172:175], a[120:123], 0
    ds_read_b128 v[164:167], v14 offset:1024
    v_mfma_f32_16x16x32_bf16 v[36:39], v[176:179], a[140:143], v[36:39]
    v_mfma_f32_16x16x32_bf16 v[40:43], v[172:175], a[124:127], 0
    s_waitcnt vmcnt(13)
    ds_read_b128 v[168:171], v13 offset:3200
    v_mfma_f32_16x16x32_bf16 v[40:43], v[176:179], a[144:147], v[40:43]
    v_mfma_f32_16x16x32_bf16 v[44:47], v[172:175], a[128:131], 0
    buffer_load_dwordx4 v2, s[60:63], s35 offen offset:1024 sc1 lds
    v_mfma_f32_16x16x32_bf16 v[44:47], v[176:179], a[148:151], v[44:47]
    s_mov_b32 s57, 30720
    v_mfma_f32_16x16x32_bf16 v[48:51], v[172:175], a[132:135], 0
    v_mfma_f32_16x16x32_bf16 v[48:51], v[176:179], a[152:155], v[48:51]
    s_add_u32 m0, s47, 13056
    s_add_u32 s35, s41, 262144
    v_mfma_f32_16x16x32_bf16 v[52:55], v[172:175], a[136:139], 0
    s_waitcnt lgkmcnt(4)
    v_mfma_f32_16x16x32_bf16 v[52:55], v[176:179], a[156:159], v[52:55]
    buffer_load_dwordx4 v2, s[60:63], s35 offen sc1 lds
    v_mfma_f32_16x16x32_bf16 v[56:59], v[180:183], a[120:123], 0
    ds_read_b128 v[172:175], v17 offset:0
    v_mfma_f32_16x16x32_bf16 v[56:59], v[184:187], a[140:143], v[56:59]
    v_mfma_f32_16x16x32_bf16 v[60:63], v[180:183], a[124:127], 0
    ds_read_b128 v[176:179], v16 offset:2176
    v_mfma_f32_16x16x32_bf16 v[60:63], v[184:187], a[144:147], v[60:63]
    v_mfma_f32_16x16x32_bf16 v[64:67], v[180:183], a[128:131], 0
    buffer_load_dwordx4 v[76:79], v2, s[64:67], s57 offen offset:0 sc1
    v_mfma_f32_16x16x32_bf16 v[64:67], v[184:187], a[148:151], v[64:67]
    v_mfma_f32_16x16x32_bf16 v[68:71], v[180:183], a[132:135], 0
    v_mfma_f32_16x16x32_bf16 v[68:71], v[184:187], a[152:155], v[68:71]
    v_mfma_f32_16x16x32_bf16 v[72:75], v[180:183], a[136:139], 0
    s_waitcnt lgkmcnt(4)
    v_mfma_f32_16x16x32_bf16 v[72:75], v[184:187], a[156:159], v[72:75]
    buffer_load_dwordx4 v[80:83], v2, s[64:67], s57 offen offset:1024 sc1
    v_mfma_f32_16x16x32_bf16 a[0:3], v[156:159], a[160:163], a[0:3]
    ds_read_b128 v[180:183], v17 offset:1024
    v_mfma_f32_16x16x32_bf16 a[0:3], v[160:163], a[180:183], a[0:3]
    v_mfma_f32_16x16x32_bf16 a[4:7], v[156:159], a[164:167], a[4:7]
    ds_read_b128 v[184:187], v16 offset:3200
    v_mfma_f32_16x16x32_bf16 a[4:7], v[160:163], a[184:187], a[4:7]
    v_mfma_f32_16x16x32_bf16 a[8:11], v[156:159], a[168:171], a[8:11]
    buffer_load_dwordx4 v[84:87], v2, s[64:67], s57 offen offset:2048 sc1
    v_mfma_f32_16x16x32_bf16 a[8:11], v[160:163], a[188:191], a[8:11]
    v_mfma_f32_16x16x32_bf16 a[12:15], v[156:159], a[172:175], a[12:15]
    v_mfma_f32_16x16x32_bf16 a[12:15], v[160:163], a[192:195], a[12:15]
    v_mfma_f32_16x16x32_bf16 a[16:19], v[156:159], a[176:179], a[16:19]
    s_waitcnt lgkmcnt(4)
    v_mfma_f32_16x16x32_bf16 a[16:19], v[160:163], a[196:199], a[16:19]
    buffer_load_dwordx4 v2, s[60:63], s35 offen offset:1024 sc1 lds
    v_mfma_f32_16x16x32_bf16 a[20:23], v[164:167], a[160:163], a[20:23]
    ds_read_b128 v[156:159], v20 offset:0
    v_mfma_f32_16x16x32_bf16 a[20:23], v[168:171], a[180:183], a[20:23]
    v_mfma_f32_16x16x32_bf16 a[24:27], v[164:167], a[164:167], a[24:27]
    ds_read_b128 v[160:163], v19 offset:2176
    v_mfma_f32_16x16x32_bf16 a[24:27], v[168:171], a[184:187], a[24:27]
    v_mfma_f32_16x16x32_bf16 a[28:31], v[164:167], a[168:171], a[28:31]
    buffer_load_dwordx4 v[88:91], v2, s[64:67], s57 offen offset:3072 sc1
    v_mfma_f32_16x16x32_bf16 a[28:31], v[168:171], a[188:191], a[28:31]
    v_mfma_f32_16x16x32_bf16 a[32:35], v[164:167], a[172:175], a[32:35]
    v_mfma_f32_16x16x32_bf16 a[32:35], v[168:171], a[192:195], a[32:35]
    v_mfma_f32_16x16x32_bf16 a[36:39], v[164:167], a[176:179], a[36:39]
    s_waitcnt lgkmcnt(4)
    v_mfma_f32_16x16x32_bf16 a[36:39], v[168:171], a[196:199], a[36:39]
    buffer_load_dwordx4 v[92:95], v3, s[64:67], s57 offen sc1
    v_mfma_f32_16x16x32_bf16 a[40:43], v[172:175], a[160:163], a[40:43]
    ds_read_b128 v[164:167], v20 offset:1024
    v_mfma_f32_16x16x32_bf16 a[40:43], v[176:179], a[180:183], a[40:43]
    v_mfma_f32_16x16x32_bf16 a[44:47], v[172:175], a[164:167], a[44:47]
    ds_read_b128 v[168:171], v19 offset:3200
    v_mfma_f32_16x16x32_bf16 a[44:47], v[176:179], a[184:187], a[44:47]
    s_add_u32 m0, s48, 13056
    s_add_u32 s35, s42, 262144
    v_mfma_f32_16x16x32_bf16 a[48:51], v[172:175], a[168:171], a[48:51]
    v_mfma_f32_16x16x32_bf16 a[48:51], v[176:179], a[188:191], a[48:51]
    v_mfma_f32_16x16x32_bf16 a[52:55], v[172:175], a[172:175], a[52:55]
    buffer_load_dwordx4 v2, s[60:63], s35 offen sc1 lds
    v_mfma_f32_16x16x32_bf16 a[52:55], v[176:179], a[192:195], a[52:55]
    s_mov_b32 s57, 35840
    v_mfma_f32_16x16x32_bf16 a[56:59], v[172:175], a[176:179], a[56:59]
    s_waitcnt lgkmcnt(4)
    v_mfma_f32_16x16x32_bf16 a[56:59], v[176:179], a[196:199], a[56:59]
    v_mfma_f32_16x16x32_bf16 a[60:63], v[180:183], a[160:163], a[60:63]
    ds_read_b128 v[172:175], v23 offset:0
    v_mfma_f32_16x16x32_bf16 a[60:63], v[184:187], a[180:183], a[60:63]
    buffer_load_dwordx4 v[96:99], v2, s[64:67], s57 offen offset:0 sc1
    v_mfma_f32_16x16x32_bf16 a[64:67], v[180:183], a[164:167], a[64:67]
    ds_read_b128 v[176:179], v22 offset:2176
    v_mfma_f32_16x16x32_bf16 a[64:67], v[184:187], a[184:187], a[64:67]
    v_mfma_f32_16x16x32_bf16 a[68:71], v[180:183], a[168:171], a[68:71]
    v_mfma_f32_16x16x32_bf16 a[68:71], v[184:187], a[188:191], a[68:71]
    v_mfma_f32_16x16x32_bf16 a[72:75], v[180:183], a[172:175], a[72:75]
    buffer_load_dwordx4 v[100:103], v2, s[64:67], s57 offen offset:1024 sc1
    v_mfma_f32_16x16x32_bf16 a[72:75], v[184:187], a[192:195], a[72:75]
    v_mfma_f32_16x16x32_bf16 a[76:79], v[180:183], a[176:179], a[76:79]
    s_waitcnt lgkmcnt(4)
    v_mfma_f32_16x16x32_bf16 a[76:79], v[184:187], a[196:199], a[76:79]
    v_mfma_f32_16x16x32_bf16 a[80:83], v[156:159], a[160:163], a[80:83]
    ds_read_b128 v[180:183], v23 offset:1024
    v_mfma_f32_16x16x32_bf16 a[80:83], v[160:163], a[180:183], a[80:83]
    buffer_load_dwordx4 v[104:107], v2, s[64:67], s57 offen offset:2048 sc1
    v_mfma_f32_16x16x32_bf16 a[84:87], v[156:159], a[164:167], a[84:87]
    ds_read_b128 v[184:187], v22 offset:3200
    v_mfma_f32_16x16x32_bf16 a[84:87], v[160:163], a[184:187], a[84:87]
    v_mfma_f32_16x16x32_bf16 a[88:91], v[156:159], a[168:171], a[88:91]
    v_mfma_f32_16x16x32_bf16 a[88:91], v[160:163], a[188:191], a[88:91]
    v_mfma_f32_16x16x32_bf16 a[92:95], v[156:159], a[172:175], a[92:95]
    buffer_load_dwordx4 v2, s[60:63], s35 offen offset:1024 sc1 lds
    v_mfma_f32_16x16x32_bf16 a[92:95], v[160:163], a[192:195], a[92:95]
    v_mfma_f32_16x16x32_bf16 a[96:99], v[156:159], a[176:179], a[96:99]
    s_waitcnt lgkmcnt(4)
    v_mfma_f32_16x16x32_bf16 a[96:99], v[160:163], a[196:199], a[96:99]
    v_mfma_f32_16x16x32_bf16 a[100:103], v[164:167], a[160:163], a[100:103]
    ds_read_b128 v[156:159], v12 offset:2176
    v_mfma_f32_16x16x32_bf16 a[100:103], v[168:171], a[180:183], a[100:103]
    buffer_load_dwordx4 v[108:111], v2, s[64:67], s57 offen offset:3072 sc1
    v_mfma_f32_16x16x32_bf16 a[104:107], v[164:167], a[164:167], a[104:107]
    ds_read_b128 v[160:163], v14 offset:2176
    v_mfma_f32_16x16x32_bf16 a[104:107], v[168:171], a[184:187], a[104:107]
    v_mfma_f32_16x16x32_bf16 a[108:111], v[164:167], a[168:171], a[108:111]
    v_mfma_f32_16x16x32_bf16 a[108:111], v[168:171], a[188:191], a[108:111]
    v_mfma_f32_16x16x32_bf16 a[112:115], v[164:167], a[172:175], a[112:115]
    buffer_load_dwordx4 v[112:115], v3, s[64:67], s57 offen sc1
    v_mfma_f32_16x16x32_bf16 a[112:115], v[168:171], a[192:195], a[112:115]
    s_mov_b32 s57, 40960
    v_mfma_f32_16x16x32_bf16 a[116:119], v[164:167], a[176:179], a[116:119]
    s_waitcnt lgkmcnt(4)
    v_mfma_f32_16x16x32_bf16 a[116:119], v[168:171], a[196:199], a[116:119]
    v_mfma_f32_16x16x32_bf16 v[36:39], v[172:175], a[160:163], v[36:39]
    ds_read_b128 v[164:167], v12 offset:3200
    v_mfma_f32_16x16x32_bf16 v[36:39], v[176:179], a[180:183], v[36:39]
    s_add_u32 m0, s49, 13056
    s_add_u32 s35, s43, 262144
    buffer_load_dwordx4 v2, s[60:63], s35 offen sc1 lds
    v_mfma_f32_16x16x32_bf16 v[40:43], v[172:175], a[164:167], v[40:43]
    ds_read_b128 v[168:171], v14 offset:3200
    v_mfma_f32_16x16x32_bf16 v[40:43], v[176:179], a[184:187], v[40:43]
    v_mfma_f32_16x16x32_bf16 v[44:47], v[172:175], a[168:171], v[44:47]
    v_mfma_f32_16x16x32_bf16 v[44:47], v[176:179], a[188:191], v[44:47]
    v_mfma_f32_16x16x32_bf16 v[48:51], v[172:175], a[172:175], v[48:51]
    buffer_load_dwordx4 v[116:119], v2, s[64:67], s57 offen offset:0 sc1
    v_mfma_f32_16x16x32_bf16 v[48:51], v[176:179], a[192:195], v[48:51]
    v_mfma_f32_16x16x32_bf16 v[52:55], v[172:175], a[176:179], v[52:55]
    s_waitcnt lgkmcnt(4)
    v_mfma_f32_16x16x32_bf16 v[52:55], v[176:179], a[196:199], v[52:55]
    v_mfma_f32_16x16x32_bf16 v[56:59], v[180:183], a[160:163], v[56:59]
    ds_read_b128 v[172:175], v15 offset:2176
    v_mfma_f32_16x16x32_bf16 v[56:59], v[184:187], a[180:183], v[56:59]
    buffer_load_dwordx4 v[120:123], v2, s[64:67], s57 offen offset:1024 sc1
    v_mfma_f32_16x16x32_bf16 v[60:63], v[180:183], a[164:167], v[60:63]
    ds_read_b128 v[176:179], v17 offset:2176
    v_mfma_f32_16x16x32_bf16 v[60:63], v[184:187], a[184:187], v[60:63]
    v_mfma_f32_16x16x32_bf16 v[64:67], v[180:183], a[168:171], v[64:67]
    v_mfma_f32_16x16x32_bf16 v[64:67], v[184:187], a[188:191], v[64:67]
    v_mfma_f32_16x16x32_bf16 v[68:71], v[180:183], a[172:175], v[68:71]
    v_mfma_f32_16x16x32_bf16 v[68:71], v[184:187], a[192:195], v[68:71]
    v_mfma_f32_16x16x32_bf16 v[72:75], v[180:183], a[176:179], v[72:75]
    s_waitcnt lgkmcnt(4)
    s_waitcnt vmcnt(22)
    v_mfma_f32_16x16x32_bf16 v[72:75], v[184:187], a[196:199], v[72:75]
    buffer_load_dwordx4 v2, s[60:63], s35 offen offset:1024 sc1 lds
    v_mfma_f32_16x16x32_bf16 a[0:3], v[156:159], a[200:203], a[0:3]
    ds_read_b128 v[180:183], v15 offset:3200
    v_mfma_f32_16x16x32_bf16 a[0:3], v[160:163], a[220:223], a[0:3]
    v_mfma_f32_16x16x32_bf16 a[4:7], v[156:159], a[204:207], a[4:7]
    ds_read_b128 v[184:187], v17 offset:3200
    v_mfma_f32_16x16x32_bf16 a[4:7], v[160:163], a[224:227], a[4:7]
    s_waitcnt vmcnt(20)
    v_mfma_f32_16x16x32_bf16 a[8:11], v[156:159], a[208:211], a[8:11]
    buffer_load_dwordx4 v[124:127], v2, s[64:67], s57 offen offset:2048 sc1
    v_mfma_f32_16x16x32_bf16 a[8:11], v[160:163], a[228:231], a[8:11]
    v_mfma_f32_16x16x32_bf16 a[12:15], v[156:159], a[212:215], a[12:15]
    v_mfma_f32_16x16x32_bf16 a[12:15], v[160:163], a[232:235], a[12:15]
    v_mfma_f32_16x16x32_bf16 a[16:19], v[156:159], a[216:219], a[16:19]
    s_waitcnt lgkmcnt(4)
    v_mfma_f32_16x16x32_bf16 a[16:19], v[160:163], a[236:239], a[16:19]
    buffer_load_dwordx4 v[128:131], v2, s[64:67], s57 offen offset:3072 sc1
    v_mfma_f32_16x16x32_bf16 a[20:23], v[164:167], a[200:203], a[20:23]
    ds_read_b128 v[156:159], v18 offset:2176
    v_mfma_f32_16x16x32_bf16 a[20:23], v[168:171], a[220:223], a[20:23]
    v_mfma_f32_16x16x32_bf16 a[24:27], v[164:167], a[204:207], a[24:27]
    ds_read_b128 v[160:163], v20 offset:2176
    v_mfma_f32_16x16x32_bf16 a[24:27], v[168:171], a[224:227], a[24:27]
    v_mfma_f32_16x16x32_bf16 a[28:31], v[164:167], a[208:211], a[28:31]
    buffer_load_dwordx4 v[132:135], v3, s[64:67], s57 offen sc1
    v_mfma_f32_16x16x32_bf16 a[28:31], v[168:171], a[228:231], a[28:31]
    s_add_u32 m0, s50, 13056
    s_add_u32 s35, s44, 262144
    v_mfma_f32_16x16x32_bf16 a[32:35], v[164:167], a[212:215], a[32:35]
    v_mfma_f32_16x16x32_bf16 a[32:35], v[168:171], a[232:235], a[32:35]
    v_mfma_f32_16x16x32_bf16 a[36:39], v[164:167], a[216:219], a[36:39]
    s_waitcnt lgkmcnt(4)
    v_mfma_f32_16x16x32_bf16 a[36:39], v[168:171], a[236:239], a[36:39]
    buffer_load_dwordx4 v2, s[60:63], s35 offen sc1 lds
    v_mfma_f32_16x16x32_bf16 a[40:43], v[172:175], a[200:203], a[40:43]
    ds_read_b128 v[164:167], v18 offset:3200
    v_mfma_f32_16x16x32_bf16 a[40:43], v[176:179], a[220:223], a[40:43]
    v_mfma_f32_16x16x32_bf16 a[44:47], v[172:175], a[204:207], a[44:47]
    ds_read_b128 v[168:171], v20 offset:3200
    v_mfma_f32_16x16x32_bf16 a[44:47], v[176:179], a[224:227], a[44:47]
    s_mov_b32 s57, 46080
    v_mfma_f32_16x16x32_bf16 a[48:51], v[172:175], a[208:211], a[48:51]
    buffer_load_dwordx4 v[136:139], v2, s[64:67], s57 offen offset:0 sc1
    v_mfma_f32_16x16x32_bf16 a[48:51], v[176:179], a[228:231], a[48:51]
    v_mfma_f32_16x16x32_bf16 a[52:55], v[172:175], a[212:215], a[52:55]
    v_mfma_f32_16x16x32_bf16 a[52:55], v[176:179], a[232:235], a[52:55]
    v_mfma_f32_16x16x32_bf16 a[56:59], v[172:175], a[216:219], a[56:59]
    s_waitcnt lgkmcnt(4)
    v_mfma_f32_16x16x32_bf16 a[56:59], v[176:179], a[236:239], a[56:59]
    buffer_load_dwordx4 v[140:143], v2, s[64:67], s57 offen offset:1024 sc1
    v_mfma_f32_16x16x32_bf16 a[60:63], v[180:183], a[200:203], a[60:63]
    ds_read_b128 v[172:175], v21 offset:2176
    v_mfma_f32_16x16x32_bf16 a[60:63], v[184:187], a[220:223], a[60:63]
    v_mfma_f32_16x16x32_bf16 a[64:67], v[180:183], a[204:207], a[64:67]
    ds_read_b128 v[176:179], v23 offset:2176
    v_mfma_f32_16x16x32_bf16 a[64:67], v[184:187], a[224:227], a[64:67]
    v_mfma_f32_16x16x32_bf16 a[68:71], v[180:183], a[208:211], a[68:71]
    buffer_load_dwordx4 v[144:147], v2, s[64:67], s57 offen offset:2048 sc1
    v_mfma_f32_16x16x32_bf16 a[68:71], v[184:187], a[228:231], a[68:71]
    v_mfma_f32_16x16x32_bf16 a[72:75], v[180:183], a[212:215], a[72:75]
    v_mfma_f32_16x16x32_bf16 a[72:75], v[184:187], a[232:235], a[72:75]
    v_mfma_f32_16x16x32_bf16 a[76:79], v[180:183], a[216:219], a[76:79]
    s_waitcnt lgkmcnt(4)
    v_mfma_f32_16x16x32_bf16 a[76:79], v[184:187], a[236:239], a[76:79]
    buffer_load_dwordx4 v2, s[60:63], s35 offen offset:1024 sc1 lds
    v_mfma_f32_16x16x32_bf16 a[80:83], v[156:159], a[200:203], a[80:83]
    ds_read_b128 v[180:183], v21 offset:3200
    v_mfma_f32_16x16x32_bf16 a[80:83], v[160:163], a[220:223], a[80:83]
    v_mfma_f32_16x16x32_bf16 a[84:87], v[156:159], a[204:207], a[84:87]
    ds_read_b128 v[184:187], v23 offset:3200
    v_mfma_f32_16x16x32_bf16 a[84:87], v[160:163], a[224:227], a[84:87]
    v_mfma_f32_16x16x32_bf16 a[88:91], v[156:159], a[208:211], a[88:91]
    buffer_load_dwordx4 v[148:151], v2, s[64:67], s57 offen offset:3072 sc1
    v_mfma_f32_16x16x32_bf16 a[88:91], v[160:163], a[228:231], a[88:91]
    v_mfma_f32_16x16x32_bf16 a[92:95], v[156:159], a[212:215], a[92:95]
    v_mfma_f32_16x16x32_bf16 a[92:95], v[160:163], a[232:235], a[92:95]
    v_mfma_f32_16x16x32_bf16 a[96:99], v[156:159], a[216:219], a[96:99]
    s_waitcnt lgkmcnt(4)
    v_mfma_f32_16x16x32_bf16 a[96:99], v[160:163], a[236:239], a[96:99]
    v_mfma_f32_16x16x32_bf16 a[100:103], v[164:167], a[200:203], a[100:103]
    s_waitcnt vmcnt(28)
    ds_read_b128 v[156:159], v13 offset:4352
    v_mfma_f32_16x16x32_bf16 a[100:103], v[168:171], a[220:223], a[100:103]
    buffer_load_dwordx4 v[152:155], v3, s[64:67], s57 offen sc1
    v_mfma_f32_16x16x32_bf16 a[104:107], v[164:167], a[204:207], a[104:107]
    s_waitcnt vmcnt(28)
    ds_read_b128 v[160:163], v12 offset:4352
    v_mfma_f32_16x16x32_bf16 a[104:107], v[168:171], a[224:227], a[104:107]
    s_add_u32 m0, s51, 13056
    s_add_u32 s35, s45, 262144
    v_mfma_f32_16x16x32_bf16 a[108:111], v[164:167], a[208:211], a[108:111]
    v_mfma_f32_16x16x32_bf16 a[108:111], v[168:171], a[228:231], a[108:111]
    v_mfma_f32_16x16x32_bf16 a[112:115], v[164:167], a[212:215], a[112:115]
    buffer_load_dwordx4 v2, s[60:63], s35 offen sc1 lds
    v_mfma_f32_16x16x32_bf16 a[112:115], v[168:171], a[232:235], a[112:115]
    s_mov_b32 s57, 51200
    v_mfma_f32_16x16x32_bf16 a[116:119], v[164:167], a[216:219], a[116:119]
    s_waitcnt lgkmcnt(4)
    v_mfma_f32_16x16x32_bf16 a[116:119], v[168:171], a[236:239], a[116:119]
    v_mfma_f32_16x16x32_bf16 v[36:39], v[172:175], a[200:203], v[36:39]
    ds_read_b128 v[164:167], v13 offset:5376
    v_mfma_f32_16x16x32_bf16 v[36:39], v[176:179], a[220:223], v[36:39]
    buffer_load_dwordx4 a[120:123], v2, s[64:67], s57 offen offset:0 sc1
    v_mfma_f32_16x16x32_bf16 v[40:43], v[172:175], a[204:207], v[40:43]
    ds_read_b128 v[168:171], v12 offset:5376
    v_mfma_f32_16x16x32_bf16 v[40:43], v[176:179], a[224:227], v[40:43]
    v_mfma_f32_16x16x32_bf16 v[44:47], v[172:175], a[208:211], v[44:47]
    ds_write_b128 v246, v[192:195] offset:19584
    v_mfma_f32_16x16x32_bf16 v[44:47], v[176:179], a[228:231], v[44:47]
    ds_write_b128 v247, v[196:199] offset:0
    v_mfma_f32_16x16x32_bf16 v[48:51], v[172:175], a[212:215], v[48:51]
    buffer_load_dwordx4 a[124:127], v2, s[64:67], s57 offen offset:1024 sc1
    v_mfma_f32_16x16x32_bf16 v[48:51], v[176:179], a[232:235], v[48:51]
    v_mfma_f32_16x16x32_bf16 v[52:55], v[172:175], a[216:219], v[52:55]
    s_waitcnt lgkmcnt(6)
    v_mfma_f32_16x16x32_bf16 v[52:55], v[176:179], a[236:239], v[52:55]
    v_mfma_f32_16x16x32_bf16 v[56:59], v[180:183], a[200:203], v[56:59]
    ds_read_b128 v[172:175], v16 offset:4352
    v_mfma_f32_16x16x32_bf16 v[56:59], v[184:187], a[220:223], v[56:59]
    buffer_load_dwordx4 v2, s[60:63], s35 offen offset:1024 sc1 lds
    v_mfma_f32_16x16x32_bf16 v[60:63], v[180:183], a[204:207], v[60:63]
    ds_read_b128 v[176:179], v15 offset:4352
    v_mfma_f32_16x16x32_bf16 v[60:63], v[184:187], a[224:227], v[60:63]
    v_mfma_f32_16x16x32_bf16 v[64:67], v[180:183], a[208:211], v[64:67]
    v_mfma_f32_16x16x32_bf16 v[64:67], v[184:187], a[228:231], v[64:67]
    v_mfma_f32_16x16x32_bf16 v[68:71], v[180:183], a[212:215], v[68:71]
    buffer_load_dwordx4 a[128:131], v2, s[64:67], s57 offen offset:2048 sc1
    v_mfma_f32_16x16x32_bf16 v[68:71], v[184:187], a[232:235], v[68:71]
    v_mfma_f32_16x16x32_bf16 v[72:75], v[180:183], a[216:219], v[72:75]
    s_waitcnt lgkmcnt(6)
    s_waitcnt vmcnt(23)
    v_mfma_f32_16x16x32_bf16 v[72:75], v[184:187], a[236:239], v[72:75]
    v_mfma_f32_16x16x32_bf16 a[0:3], v[156:159], v[76:79], a[0:3]
    ds_read_b128 v[180:183], v16 offset:5376
    v_mfma_f32_16x16x32_bf16 a[0:3], v[160:163], v[96:99], a[0:3]
    buffer_load_dwordx4 a[132:135], v2, s[64:67], s57 offen offset:3072 sc1
    v_mfma_f32_16x16x32_bf16 a[4:7], v[156:159], v[80:83], a[4:7]
    ds_read_b128 v[184:187], v15 offset:5376
    v_mfma_f32_16x16x32_bf16 a[4:7], v[160:163], v[100:103], a[4:7]
    s_waitcnt vmcnt(20)
    v_mfma_f32_16x16x32_bf16 a[8:11], v[156:159], v[84:87], a[8:11]
    v_and_b32 v4, 15, v1
    v_lshlrev_b32 v4, 13, v4
    v_mfma_f32_16x16x32_bf16 a[8:11], v[160:163], v[104:107], a[8:11]
    v_bfe_u32 v5, v1, 4, 1
    v_lshl_add_u32 v4, v5, 5, v4
    v_mfma_f32_16x16x32_bf16 a[12:15], v[156:159], v[88:91], a[12:15]
    buffer_load_dwordx4 a[136:139], v3, s[64:67], s57 offen sc1
    v_mfma_f32_16x16x32_bf16 a[12:15], v[160:163], v[108:111], a[12:15]
    v_lshrrev_b32 v5, 5, v1
    v_lshl_add_u32 v4, v5, 4, v4
    v_mfma_f32_16x16x32_bf16 a[16:19], v[156:159], v[92:95], a[16:19]
    s_waitcnt lgkmcnt(6)
    s_add_u32 m0, s52, 13056
    s_add_u32 s35, s46, 262144
    v_mfma_f32_16x16x32_bf16 a[16:19], v[160:163], v[112:115], a[16:19]
    s_mul_i32 s37, s59, 655360
    s_add_u32 s38, s31, s28
    v_mfma_f32_16x16x32_bf16 a[20:23], v[164:167], v[76:79], a[20:23]
    ds_read_b128 v[156:159], v19 offset:4352
    v_mfma_f32_16x16x32_bf16 a[20:23], v[168:171], v[96:99], a[20:23]
    buffer_load_dwordx4 v2, s[60:63], s35 offen sc1 lds
    v_mfma_f32_16x16x32_bf16 a[24:27], v[164:167], v[80:83], a[24:27]
    ds_read_b128 v[160:163], v18 offset:4352
    v_mfma_f32_16x16x32_bf16 a[24:27], v[168:171], v[100:103], a[24:27]
    s_mov_b32 s57, 56320
    v_mfma_f32_16x16x32_bf16 a[28:31], v[164:167], v[84:87], a[28:31]
    s_lshl_b32 s38, s38, 6
    s_add_u32 s38, s38, s32
    v_mfma_f32_16x16x32_bf16 a[28:31], v[168:171], v[104:107], a[28:31]
    s_lshl_b32 s38, s38, 1
    s_add_u32 s37, s37, s38
    v_mfma_f32_16x16x32_bf16 a[32:35], v[164:167], v[88:91], a[32:35]
    buffer_load_dwordx4 a[140:143], v2, s[64:67], s57 offen offset:0 sc1
    v_mfma_f32_16x16x32_bf16 a[32:35], v[168:171], v[108:111], a[32:35]
    s_mov_b32 s68, s4
    s_mov_b32 s69, s5
    v_mfma_f32_16x16x32_bf16 a[36:39], v[164:167], v[92:95], a[36:39]
    s_waitcnt lgkmcnt(4)
    v_mfma_f32_16x16x32_bf16 a[36:39], v[168:171], v[112:115], a[36:39]
    s_mov_b32 s70, 5242880
    s_mov_b32 s71, 0x00020000
    v_mfma_f32_16x16x32_bf16 a[40:43], v[172:175], v[76:79], a[40:43]
    ds_read_b128 v[164:167], v19 offset:5376
    v_mfma_f32_16x16x32_bf16 a[40:43], v[176:179], v[96:99], a[40:43]
    s_mov_b32 s72, s22
    s_mov_b32 s73, s23
    v_mfma_f32_16x16x32_bf16 a[44:47], v[172:175], v[80:83], a[44:47]
    ds_read_b128 v[168:171], v18 offset:5376
    v_mfma_f32_16x16x32_bf16 a[44:47], v[176:179], v[100:103], a[44:47]
    v_mfma_f32_16x16x32_bf16 a[48:51], v[172:175], v[84:87], a[48:51]
    buffer_load_dwordx4 a[144:147], v2, s[64:67], s57 offen offset:1024 sc1
    v_mfma_f32_16x16x32_bf16 a[48:51], v[176:179], v[104:107], a[48:51]
    s_mov_b32 s74, 5242880
    s_mov_b32 s75, 0x00020000
    v_mfma_f32_16x16x32_bf16 a[52:55], v[172:175], v[88:91], a[52:55]
    v_mfma_f32_16x16x32_bf16 a[52:55], v[176:179], v[108:111], a[52:55]
    v_mfma_f32_16x16x32_bf16 a[56:59], v[172:175], v[92:95], a[56:59]
    s_waitcnt lgkmcnt(4)
    v_mfma_f32_16x16x32_bf16 a[56:59], v[176:179], v[112:115], a[56:59]
    buffer_load_dwordx4 v2, s[60:63], s35 offen offset:1024 sc1 lds
    v_mfma_f32_16x16x32_bf16 a[60:63], v[180:183], v[76:79], a[60:63]
    ds_read_b128 v[172:175], v22 offset:4352
    v_mfma_f32_16x16x32_bf16 a[60:63], v[184:187], v[96:99], a[60:63]
    v_mfma_f32_16x16x32_bf16 a[64:67], v[180:183], v[80:83], a[64:67]
    ds_read_b128 v[176:179], v21 offset:4352
    v_mfma_f32_16x16x32_bf16 a[64:67], v[184:187], v[100:103], a[64:67]
    v_mfma_f32_16x16x32_bf16 a[68:71], v[180:183], v[84:87], a[68:71]
    buffer_load_dwordx4 a[148:151], v2, s[64:67], s57 offen offset:2048 sc1
    v_mfma_f32_16x16x32_bf16 a[68:71], v[184:187], v[104:107], a[68:71]
    v_mfma_f32_16x16x32_bf16 a[72:75], v[180:183], v[88:91], a[72:75]
    v_mfma_f32_16x16x32_bf16 a[72:75], v[184:187], v[108:111], a[72:75]
    v_mfma_f32_16x16x32_bf16 a[76:79], v[180:183], v[92:95], a[76:79]
    s_waitcnt lgkmcnt(4)
    v_mfma_f32_16x16x32_bf16 a[76:79], v[184:187], v[112:115], a[76:79]
    buffer_load_dwordx4 a[152:155], v2, s[64:67], s57 offen offset:3072 sc1
    v_mfma_f32_16x16x32_bf16 a[80:83], v[156:159], v[76:79], a[80:83]
    ds_read_b128 v[180:183], v22 offset:5376
    v_mfma_f32_16x16x32_bf16 a[80:83], v[160:163], v[96:99], a[80:83]
    v_mfma_f32_16x16x32_bf16 a[84:87], v[156:159], v[80:83], a[84:87]
    ds_read_b128 v[184:187], v21 offset:5376
    v_mfma_f32_16x16x32_bf16 a[84:87], v[160:163], v[100:103], a[84:87]
    v_mfma_f32_16x16x32_bf16 a[88:91], v[156:159], v[84:87], a[88:91]
    buffer_load_dwordx4 a[156:159], v3, s[64:67], s57 offen sc1
    v_mfma_f32_16x16x32_bf16 a[88:91], v[160:163], v[104:107], a[88:91]
    s_mov_b32 s57, 61440
    v_mfma_f32_16x16x32_bf16 a[92:95], v[156:159], v[88:91], a[92:95]
    v_mfma_f32_16x16x32_bf16 a[92:95], v[160:163], v[108:111], a[92:95]
    v_mfma_f32_16x16x32_bf16 a[96:99], v[156:159], v[92:95], a[96:99]
    s_waitcnt lgkmcnt(4)
    v_mfma_f32_16x16x32_bf16 a[96:99], v[160:163], v[112:115], a[96:99]
    buffer_load_dwordx4 a[160:163], v2, s[64:67], s57 offen offset:0 sc1
    v_mfma_f32_16x16x32_bf16 a[100:103], v[164:167], v[76:79], a[100:103]
    ds_read_b128 v[156:159], v14 offset:4352
    v_mfma_f32_16x16x32_bf16 a[100:103], v[168:171], v[96:99], a[100:103]
    v_mfma_f32_16x16x32_bf16 a[104:107], v[164:167], v[80:83], a[104:107]
    ds_read_b128 v[160:163], v13 offset:13056
    v_mfma_f32_16x16x32_bf16 a[104:107], v[168:171], v[100:103], a[104:107]
    v_mfma_f32_16x16x32_bf16 a[108:111], v[164:167], v[84:87], a[108:111]
    buffer_load_dwordx4 a[164:167], v2, s[64:67], s57 offen offset:1024 sc1
    v_mfma_f32_16x16x32_bf16 a[108:111], v[168:171], v[104:107], a[108:111]
    v_mfma_f32_16x16x32_bf16 a[112:115], v[164:167], v[88:91], a[112:115]
    v_mfma_f32_16x16x32_bf16 a[112:115], v[168:171], v[108:111], a[112:115]
    v_mfma_f32_16x16x32_bf16 a[116:119], v[164:167], v[92:95], a[116:119]
    s_waitcnt lgkmcnt(4)
    v_mfma_f32_16x16x32_bf16 a[116:119], v[168:171], v[112:115], a[116:119]
    s_add_u32 s38, s37, 0
    buffer_load_dwordx4 v[188:191], v4, s[68:71], s38 offen
    v_mfma_f32_16x16x32_bf16 v[36:39], v[172:175], v[76:79], v[36:39]
    ds_read_b128 v[164:167], v14 offset:5376
    v_mfma_f32_16x16x32_bf16 v[36:39], v[176:179], v[96:99], v[36:39]
    v_mfma_f32_16x16x32_bf16 v[40:43], v[172:175], v[80:83], v[40:43]
    ds_read_b128 v[168:171], v13 offset:14080
    v_mfma_f32_16x16x32_bf16 v[40:43], v[176:179], v[100:103], v[40:43]
    v_mfma_f32_16x16x32_bf16 v[44:47], v[172:175], v[84:87], v[44:47]
    s_add_u32 s38, s37, 131072
    buffer_load_dwordx4 v[192:195], v4, s[68:71], s38 offen
    v_mfma_f32_16x16x32_bf16 v[44:47], v[176:179], v[104:107], v[44:47]
    v_mfma_f32_16x16x32_bf16 v[48:51], v[172:175], v[88:91], v[48:51]
    v_mfma_f32_16x16x32_bf16 v[48:51], v[176:179], v[108:111], v[48:51]
    v_mfma_f32_16x16x32_bf16 v[52:55], v[172:175], v[92:95], v[52:55]
    s_waitcnt lgkmcnt(4)
    v_mfma_f32_16x16x32_bf16 v[52:55], v[176:179], v[112:115], v[52:55]
    s_add_u32 s38, s37, 262144
    buffer_load_dwordx4 v[196:199], v4, s[68:71], s38 offen
    v_mfma_f32_16x16x32_bf16 v[56:59], v[180:183], v[76:79], v[56:59]
    ds_read_b128 v[172:175], v17 offset:4352
    v_mfma_f32_16x16x32_bf16 v[56:59], v[184:187], v[96:99], v[56:59]
    v_mfma_f32_16x16x32_bf16 v[60:63], v[180:183], v[80:83], v[60:63]
    ds_read_b128 v[176:179], v16 offset:13056
    v_mfma_f32_16x16x32_bf16 v[60:63], v[184:187], v[100:103], v[60:63]
    v_mfma_f32_16x16x32_bf16 v[64:67], v[180:183], v[84:87], v[64:67]
    v_mfma_f32_16x16x32_bf16 v[64:67], v[184:187], v[104:107], v[64:67]
    v_mfma_f32_16x16x32_bf16 v[68:71], v[180:183], v[88:91], v[68:71]
    s_add_u32 s38, s37, 393216
    buffer_load_dwordx4 v[200:203], v4, s[68:71], s38 offen
    v_mfma_f32_16x16x32_bf16 v[68:71], v[184:187], v[108:111], v[68:71]
    v_mfma_f32_16x16x32_bf16 v[72:75], v[180:183], v[92:95], v[72:75]
    s_waitcnt lgkmcnt(4)
    s_waitcnt vmcnt(24)
    v_mfma_f32_16x16x32_bf16 v[72:75], v[184:187], v[112:115], v[72:75]
    v_mfma_f32_16x16x32_bf16 a[0:3], v[156:159], v[116:119], a[0:3]
    ds_read_b128 v[180:183], v17 offset:5376
    v_mfma_f32_16x16x32_bf16 a[0:3], v[160:163], v[136:139], a[0:3]
    s_add_u32 s38, s37, 524288
    buffer_load_dwordx4 v[204:207], v4, s[68:71], s38 offen
    v_mfma_f32_16x16x32_bf16 a[4:7], v[156:159], v[120:123], a[4:7]
    ds_read_b128 v[184:187], v16 offset:14080
    v_mfma_f32_16x16x32_bf16 a[4:7], v[160:163], v[140:143], a[4:7]
    s_waitcnt vmcnt(21)
    v_mfma_f32_16x16x32_bf16 a[8:11], v[156:159], v[124:127], a[8:11]
    v_mfma_f32_16x16x32_bf16 a[8:11], v[160:163], v[144:147], a[8:11]
    v_mfma_f32_16x16x32_bf16 a[12:15], v[156:159], v[128:131], a[12:15]
    buffer_load_dwordx4 a[168:171], v2, s[64:67], s57 offen offset:2048 sc1
    v_mfma_f32_16x16x32_bf16 a[12:15], v[160:163], v[148:151], a[12:15]
    s_add_u32 s35, s47, s53
    s_lshr_b32 m0, s35, 1
    s_lshr_b32 s35, s41, 1
    v_mfma_f32_16x16x32_bf16 a[16:19], v[156:159], v[132:135], a[16:19]
    s_waitcnt lgkmcnt(4)
    v_mfma_f32_16x16x32_bf16 a[16:19], v[160:163], v[152:155], a[16:19]
    v_mfma_f32_16x16x32_bf16 a[20:23], v[164:167], v[116:119], a[20:23]
    ds_read_b128 v[156:159], v20 offset:4352
    v_mfma_f32_16x16x32_bf16 a[20:23], v[168:171], v[136:139], a[20:23]
    buffer_load_dwordx4 v255, s[60:63], s35 offen sc1 lds
    v_mfma_f32_16x16x32_bf16 a[24:27], v[164:167], v[120:123], a[24:27]
    ds_read_b128 v[160:163], v19 offset:13056
    v_mfma_f32_16x16x32_bf16 a[24:27], v[168:171], v[140:143], a[24:27]
    v_mfma_f32_16x16x32_bf16 a[28:31], v[164:167], v[124:127], a[28:31]
    v_mfma_f32_16x16x32_bf16 a[28:31], v[168:171], v[144:147], a[28:31]
    v_mfma_f32_16x16x32_bf16 a[32:35], v[164:167], v[128:131], a[32:35]
    buffer_load_dwordx4 a[172:175], v2, s[64:67], s57 offen offset:3072 sc1
    v_mfma_f32_16x16x32_bf16 a[32:35], v[168:171], v[148:151], a[32:35]
    v_mfma_f32_16x16x32_bf16 a[36:39], v[164:167], v[132:135], a[36:39]
    s_waitcnt lgkmcnt(4)
    v_mfma_f32_16x16x32_bf16 a[36:39], v[168:171], v[152:155], a[36:39]
    v_mfma_f32_16x16x32_bf16 a[40:43], v[172:175], v[116:119], a[40:43]
    ds_read_b128 v[164:167], v20 offset:5376
    v_mfma_f32_16x16x32_bf16 a[40:43], v[176:179], v[136:139], a[40:43]
    buffer_load_dwordx4 a[176:179], v3, s[64:67], s57 offen sc1
    v_mfma_f32_16x16x32_bf16 a[44:47], v[172:175], v[120:123], a[44:47]
    ds_read_b128 v[168:171], v19 offset:14080
    v_mfma_f32_16x16x32_bf16 a[44:47], v[176:179], v[140:143], a[44:47]
    s_mov_b32 s57, 66560
    v_mfma_f32_16x16x32_bf16 a[48:51], v[172:175], v[124:127], a[48:51]
    v_mfma_f32_16x16x32_bf16 a[48:51], v[176:179], v[144:147], a[48:51]
    v_mfma_f32_16x16x32_bf16 a[52:55], v[172:175], v[128:131], a[52:55]
    buffer_load_dwordx4 a[180:183], v2, s[64:67], s57 offen offset:0 sc1
    v_mfma_f32_16x16x32_bf16 a[52:55], v[176:179], v[148:151], a[52:55]
    v_mfma_f32_16x16x32_bf16 a[56:59], v[172:175], v[132:135], a[56:59]
    s_waitcnt lgkmcnt(4)
    v_mfma_f32_16x16x32_bf16 a[56:59], v[176:179], v[152:155], a[56:59]
    v_mfma_f32_16x16x32_bf16 a[60:63], v[180:183], v[116:119], a[60:63]
    ds_read_b128 v[172:175], v23 offset:4352
    v_mfma_f32_16x16x32_bf16 a[60:63], v[184:187], v[136:139], a[60:63]
    v_mfma_f32_16x16x32_bf16 a[64:67], v[180:183], v[120:123], a[64:67]
    ds_read_b128 v[176:179], v22 offset:13056
    v_mfma_f32_16x16x32_bf16 a[64:67], v[184:187], v[140:143], a[64:67]
    v_mfma_f32_16x16x32_bf16 a[68:71], v[180:183], v[124:127], a[68:71]
    v_mfma_f32_16x16x32_bf16 a[68:71], v[184:187], v[144:147], a[68:71]
    v_mfma_f32_16x16x32_bf16 a[72:75], v[180:183], v[128:131], a[72:75]
    v_mfma_f32_16x16x32_bf16 a[72:75], v[184:187], v[148:151], a[72:75]
    v_mfma_f32_16x16x32_bf16 a[76:79], v[180:183], v[132:135], a[76:79]
    s_waitcnt lgkmcnt(4)
    v_mfma_f32_16x16x32_bf16 a[76:79], v[184:187], v[152:155], a[76:79]
    buffer_load_dwordx4 a[184:187], v2, s[64:67], s57 offen offset:1024 sc1
    v_mfma_f32_16x16x32_bf16 a[80:83], v[156:159], v[116:119], a[80:83]
    ds_read_b128 v[180:183], v23 offset:5376
    v_mfma_f32_16x16x32_bf16 a[80:83], v[160:163], v[136:139], a[80:83]
    v_mfma_f32_16x16x32_bf16 a[84:87], v[156:159], v[120:123], a[84:87]
    ds_read_b128 v[184:187], v22 offset:14080
    v_mfma_f32_16x16x32_bf16 a[84:87], v[160:163], v[140:143], a[84:87]
    v_mfma_f32_16x16x32_bf16 a[88:91], v[156:159], v[124:127], a[88:91]
    buffer_load_dwordx4 a[188:191], v2, s[64:67], s57 offen offset:2048 sc1
    v_mfma_f32_16x16x32_bf16 a[88:91], v[160:163], v[144:147], a[88:91]
    v_mfma_f32_16x16x32_bf16 a[92:95], v[156:159], v[128:131], a[92:95]
    v_mfma_f32_16x16x32_bf16 a[92:95], v[160:163], v[148:151], a[92:95]
    s_add_u32 s35, s48, s53
    s_lshr_b32 m0, s35, 1
    s_lshr_b32 s35, s42, 1
    v_mfma_f32_16x16x32_bf16 a[96:99], v[156:159], v[132:135], a[96:99]
    s_waitcnt lgkmcnt(4)
    v_mfma_f32_16x16x32_bf16 a[96:99], v[160:163], v[152:155], a[96:99]
    buffer_load_dwordx4 v255, s[60:63], s35 offen sc1 lds
    v_mfma_f32_16x16x32_bf16 a[100:103], v[164:167], v[116:119], a[100:103]
    ds_read_b128 v[156:159], v12 offset:13056
    v_mfma_f32_16x16x32_bf16 a[100:103], v[168:171], v[136:139], a[100:103]
    v_mfma_f32_16x16x32_bf16 a[104:107], v[164:167], v[120:123], a[104:107]
    ds_read_b128 v[160:163], v14 offset:13056
    v_mfma_f32_16x16x32_bf16 a[104:107], v[168:171], v[140:143], a[104:107]
    v_mfma_f32_16x16x32_bf16 a[108:111], v[164:167], v[124:127], a[108:111]
    buffer_load_dwordx4 a[192:195], v2, s[64:67], s57 offen offset:3072 sc1
    v_mfma_f32_16x16x32_bf16 a[108:111], v[168:171], v[144:147], a[108:111]
    v_mfma_f32_16x16x32_bf16 a[112:115], v[164:167], v[128:131], a[112:115]
    v_mfma_f32_16x16x32_bf16 a[112:115], v[168:171], v[148:151], a[112:115]
    v_mfma_f32_16x16x32_bf16 a[116:119], v[164:167], v[132:135], a[116:119]
    s_waitcnt lgkmcnt(4)
    v_mfma_f32_16x16x32_bf16 a[116:119], v[168:171], v[152:155], a[116:119]
    buffer_load_dwordx4 a[196:199], v3, s[64:67], s57 offen sc1
    v_mfma_f32_16x16x32_bf16 v[36:39], v[172:175], v[116:119], v[36:39]
    ds_read_b128 v[164:167], v12 offset:14080
    v_mfma_f32_16x16x32_bf16 v[36:39], v[176:179], v[136:139], v[36:39]
    v_mfma_f32_16x16x32_bf16 v[40:43], v[172:175], v[120:123], v[40:43]
    ds_read_b128 v[168:171], v14 offset:14080
    v_mfma_f32_16x16x32_bf16 v[40:43], v[176:179], v[140:143], v[40:43]
    s_mov_b32 s57, 71680
    v_mfma_f32_16x16x32_bf16 v[44:47], v[172:175], v[124:127], v[44:47]
    buffer_load_dwordx4 v[76:79], v2, s[64:67], s57 offen offset:0 sc1
    v_mfma_f32_16x16x32_bf16 v[44:47], v[176:179], v[144:147], v[44:47]
    v_mfma_f32_16x16x32_bf16 v[48:51], v[172:175], v[128:131], v[48:51]
    v_mfma_f32_16x16x32_bf16 v[48:51], v[176:179], v[148:151], v[48:51]
    v_mfma_f32_16x16x32_bf16 v[52:55], v[172:175], v[132:135], v[52:55]
    s_waitcnt lgkmcnt(4)
    v_mfma_f32_16x16x32_bf16 v[52:55], v[176:179], v[152:155], v[52:55]
    buffer_load_dwordx4 v[80:83], v2, s[64:67], s57 offen offset:1024 sc1
    v_mfma_f32_16x16x32_bf16 v[56:59], v[180:183], v[116:119], v[56:59]
    ds_read_b128 v[172:175], v15 offset:13056
    v_mfma_f32_16x16x32_bf16 v[56:59], v[184:187], v[136:139], v[56:59]
    v_mfma_f32_16x16x32_bf16 v[60:63], v[180:183], v[120:123], v[60:63]
    ds_read_b128 v[176:179], v17 offset:13056
    v_mfma_f32_16x16x32_bf16 v[60:63], v[184:187], v[140:143], v[60:63]
    v_mfma_f32_16x16x32_bf16 v[64:67], v[180:183], v[124:127], v[64:67]
    buffer_load_dwordx4 v[84:87], v2, s[64:67], s57 offen offset:2048 sc1
    v_mfma_f32_16x16x32_bf16 v[64:67], v[184:187], v[144:147], v[64:67]
    v_mfma_f32_16x16x32_bf16 v[68:71], v[180:183], v[128:131], v[68:71]
    v_mfma_f32_16x16x32_bf16 v[68:71], v[184:187], v[148:151], v[68:71]
    v_mfma_f32_16x16x32_bf16 v[72:75], v[180:183], v[132:135], v[72:75]
    s_waitcnt lgkmcnt(4)
    s_waitcnt vmcnt(24)
    v_mfma_f32_16x16x32_bf16 v[72:75], v[184:187], v[152:155], v[72:75]
    buffer_load_dwordx4 v[88:91], v2, s[64:67], s57 offen offset:3072 sc1
    v_mfma_f32_16x16x32_bf16 a[0:3], v[156:159], a[120:123], a[0:3]
    ds_read_b128 v[180:183], v15 offset:14080
    v_mfma_f32_16x16x32_bf16 a[0:3], v[160:163], a[140:143], a[0:3]
    v_mfma_f32_16x16x32_bf16 a[4:7], v[156:159], a[124:127], a[4:7]
    ds_read_b128 v[184:187], v17 offset:14080
    v_mfma_f32_16x16x32_bf16 a[4:7], v[160:163], a[144:147], a[4:7]
    s_waitcnt vmcnt(21)
    v_mfma_f32_16x16x32_bf16 a[8:11], v[156:159], a[128:131], a[8:11]
    buffer_load_dwordx4 v[92:95], v3, s[64:67], s57 offen sc1
    v_mfma_f32_16x16x32_bf16 a[8:11], v[160:163], a[148:151], a[8:11]
    s_mov_b32 s57, 76800
    v_mfma_f32_16x16x32_bf16 a[12:15], v[156:159], a[132:135], a[12:15]
    v_mfma_f32_16x16x32_bf16 a[12:15], v[160:163], a[152:155], a[12:15]
    s_add_u32 s35, s49, s53
    s_lshr_b32 m0, s35, 1
    s_lshr_b32 s35, s43, 1
    v_mfma_f32_16x16x32_bf16 a[16:19], v[156:159], a[136:139], a[16:19]
    s_waitcnt lgkmcnt(4)
    v_mfma_f32_16x16x32_bf16 a[16:19], v[160:163], a[156:159], a[16:19]
    v_mfma_f32_16x16x32_bf16 a[20:23], v[164:167], a[120:123], a[20:23]
    ds_read_b128 v[156:159], v18 offset:13056
    v_mfma_f32_16x16x32_bf16 a[20:23], v[168:171], a[140:143], a[20:23]
    buffer_load_dwordx4 v255, s[60:63], s35 offen sc1 lds
    v_mfma_f32_16x16x32_bf16 a[24:27], v[164:167], a[124:127], a[24:27]
    ds_read_b128 v[160:163], v20 offset:13056
    v_mfma_f32_16x16x32_bf16 a[24:27], v[168:171], a[144:147], a[24:27]
    v_mfma_f32_16x16x32_bf16 a[28:31], v[164:167], a[128:131], a[28:31]
    v_mfma_f32_16x16x32_bf16 a[28:31], v[168:171], a[148:151], a[28:31]
    v_mfma_f32_16x16x32_bf16 a[32:35], v[164:167], a[132:135], a[32:35]
    buffer_load_dwordx4 v[96:99], v2, s[64:67], s57 offen offset:0 sc1
    v_mfma_f32_16x16x32_bf16 a[32:35], v[168:171], a[152:155], a[32:35]
    v_mfma_f32_16x16x32_bf16 a[36:39], v[164:167], a[136:139], a[36:39]
    s_waitcnt lgkmcnt(4)
    v_mfma_f32_16x16x32_bf16 a[36:39], v[168:171], a[156:159], a[36:39]
    v_mfma_f32_16x16x32_bf16 a[40:43], v[172:175], a[120:123], a[40:43]
    ds_read_b128 v[164:167], v18 offset:14080
    v_mfma_f32_16x16x32_bf16 a[40:43], v[176:179], a[140:143], a[40:43]
    buffer_load_dwordx4 v[100:103], v2, s[64:67], s57 offen offset:1024 sc1
    v_mfma_f32_16x16x32_bf16 a[44:47], v[172:175], a[124:127], a[44:47]
    ds_read_b128 v[168:171], v20 offset:14080
    v_mfma_f32_16x16x32_bf16 a[44:47], v[176:179], a[144:147], a[44:47]
    v_mfma_f32_16x16x32_bf16 a[48:51], v[172:175], a[128:131], a[48:51]
    v_mfma_f32_16x16x32_bf16 a[48:51], v[176:179], a[148:151], a[48:51]
    v_mfma_f32_16x16x32_bf16 a[52:55], v[172:175], a[132:135], a[52:55]
    buffer_load_dwordx4 v[104:107], v2, s[64:67], s57 offen offset:2048 sc1
    v_mfma_f32_16x16x32_bf16 a[52:55], v[176:179], a[152:155], a[52:55]
    v_mfma_f32_16x16x32_bf16 a[56:59], v[172:175], a[136:139], a[56:59]
    s_waitcnt lgkmcnt(4)
    v_mfma_f32_16x16x32_bf16 a[56:59], v[176:179], a[156:159], a[56:59]
    v_mfma_f32_16x16x32_bf16 a[60:63], v[180:183], a[120:123], a[60:63]
    ds_read_b128 v[172:175], v21 offset:13056
    v_mfma_f32_16x16x32_bf16 a[60:63], v[184:187], a[140:143], a[60:63]
    buffer_load_dwordx4 v[108:111], v2, s[64:67], s57 offen offset:3072 sc1
    v_mfma_f32_16x16x32_bf16 a[64:67], v[180:183], a[124:127], a[64:67]
    ds_read_b128 v[176:179], v23 offset:13056
    v_mfma_f32_16x16x32_bf16 a[64:67], v[184:187], a[144:147], a[64:67]
    v_mfma_f32_16x16x32_bf16 a[68:71], v[180:183], a[128:131], a[68:71]
    v_mfma_f32_16x16x32_bf16 a[68:71], v[184:187], a[148:151], a[68:71]
    v_mfma_f32_16x16x32_bf16 a[72:75], v[180:183], a[132:135], a[72:75]
    buffer_load_dwordx4 v[112:115], v3, s[64:67], s57 offen sc1
    v_mfma_f32_16x16x32_bf16 a[72:75], v[184:187], a[152:155], a[72:75]
    s_mov_b32 s57, 81920
    v_mfma_f32_16x16x32_bf16 a[76:79], v[180:183], a[136:139], a[76:79]
    s_waitcnt lgkmcnt(4)
    v_mfma_f32_16x16x32_bf16 a[76:79], v[184:187], a[156:159], a[76:79]
    v_mfma_f32_16x16x32_bf16 a[80:83], v[156:159], a[120:123], a[80:83]
    ds_read_b128 v[180:183], v21 offset:14080
    v_mfma_f32_16x16x32_bf16 a[80:83], v[160:163], a[140:143], a[80:83]
    buffer_load_dwordx4 v[116:119], v2, s[64:67], s57 offen offset:0 sc1
    v_mfma_f32_16x16x32_bf16 a[84:87], v[156:159], a[124:127], a[84:87]
    ds_read_b128 v[184:187], v23 offset:14080
    v_mfma_f32_16x16x32_bf16 a[84:87], v[160:163], a[144:147], a[84:87]
    v_mfma_f32_16x16x32_bf16 a[88:91], v[156:159], a[128:131], a[88:91]
    v_mfma_f32_16x16x32_bf16 a[88:91], v[160:163], a[148:151], a[88:91]
    v_mfma_f32_16x16x32_bf16 a[92:95], v[156:159], a[132:135], a[92:95]
    buffer_load_dwordx4 v[120:123], v2, s[64:67], s57 offen offset:1024 sc1
    v_mfma_f32_16x16x32_bf16 a[92:95], v[160:163], a[152:155], a[92:95]
    s_add_u32 s35, s50, s53
    s_lshr_b32 m0, s35, 1
    s_lshr_b32 s35, s44, 1
    v_mfma_f32_16x16x32_bf16 a[96:99], v[156:159], a[136:139], a[96:99]
    s_waitcnt lgkmcnt(4)
    v_mfma_f32_16x16x32_bf16 a[96:99], v[160:163], a[156:159], a[96:99]
    v_mfma_f32_16x16x32_bf16 a[100:103], v[164:167], a[120:123], a[100:103]
    ds_read_b128 v[156:159], v13 offset:15232
    v_mfma_f32_16x16x32_bf16 a[100:103], v[168:171], a[140:143], a[100:103]
    buffer_load_dwordx4 v255, s[60:63], s35 offen sc1 lds
    v_mfma_f32_16x16x32_bf16 a[104:107], v[164:167], a[124:127], a[104:107]
    ds_read_b128 v[160:163], v12 offset:15232
    v_mfma_f32_16x16x32_bf16 a[104:107], v[168:171], a[144:147], a[104:107]
    v_mfma_f32_16x16x32_bf16 a[108:111], v[164:167], a[128:131], a[108:111]
    v_mfma_f32_16x16x32_bf16 a[108:111], v[168:171], a[148:151], a[108:111]
    v_mfma_f32_16x16x32_bf16 a[112:115], v[164:167], a[132:135], a[112:115]
    buffer_load_dwordx4 v[124:127], v2, s[64:67], s57 offen offset:2048 sc1
    v_mfma_f32_16x16x32_bf16 a[112:115], v[168:171], a[152:155], a[112:115]
    v_mfma_f32_16x16x32_bf16 a[116:119], v[164:167], a[136:139], a[116:119]
    s_waitcnt lgkmcnt(4)
    v_mfma_f32_16x16x32_bf16 a[116:119], v[168:171], a[156:159], a[116:119]
    v_mfma_f32_16x16x32_bf16 v[36:39], v[172:175], a[120:123], v[36:39]
    ds_read_b128 v[164:167], v13 offset:16256
    v_mfma_f32_16x16x32_bf16 v[36:39], v[176:179], a[140:143], v[36:39]
    v_mfma_f32_16x16x32_bf16 v[40:43], v[172:175], a[124:127], v[40:43]
    ds_read_b128 v[168:171], v12 offset:16256
    v_mfma_f32_16x16x32_bf16 v[40:43], v[176:179], a[144:147], v[40:43]
    v_mfma_f32_16x16x32_bf16 v[44:47], v[172:175], a[128:131], v[44:47]
    buffer_load_dwordx4 v[128:131], v2, s[64:67], s57 offen offset:3072 sc1
    v_mfma_f32_16x16x32_bf16 v[44:47], v[176:179], a[148:151], v[44:47]
    v_mfma_f32_16x16x32_bf16 v[48:51], v[172:175], a[132:135], v[48:51]
    v_mfma_f32_16x16x32_bf16 v[48:51], v[176:179], a[152:155], v[48:51]
    v_mfma_f32_16x16x32_bf16 v[52:55], v[172:175], a[136:139], v[52:55]
    s_waitcnt lgkmcnt(4)
    v_mfma_f32_16x16x32_bf16 v[52:55], v[176:179], a[156:159], v[52:55]
    buffer_load_dwordx4 v[132:135], v3, s[64:67], s57 offen sc1
    v_mfma_f32_16x16x32_bf16 v[56:59], v[180:183], a[120:123], v[56:59]
    ds_read_b128 v[172:175], v16 offset:15232
    v_mfma_f32_16x16x32_bf16 v[56:59], v[184:187], a[140:143], v[56:59]
    v_mfma_f32_16x16x32_bf16 v[60:63], v[180:183], a[124:127], v[60:63]
    ds_read_b128 v[176:179], v15 offset:15232
    v_mfma_f32_16x16x32_bf16 v[60:63], v[184:187], a[144:147], v[60:63]
    s_mov_b32 s57, 87040
    v_mfma_f32_16x16x32_bf16 v[64:67], v[180:183], a[128:131], v[64:67]
    buffer_load_dwordx4 v[136:139], v2, s[64:67], s57 offen offset:0 sc1
    v_mfma_f32_16x16x32_bf16 v[64:67], v[184:187], a[148:151], v[64:67]
    v_mfma_f32_16x16x32_bf16 v[68:71], v[180:183], a[132:135], v[68:71]
    v_mfma_f32_16x16x32_bf16 v[68:71], v[184:187], a[152:155], v[68:71]
    v_mfma_f32_16x16x32_bf16 v[72:75], v[180:183], a[136:139], v[72:75]
    s_waitcnt lgkmcnt(4)
    s_waitcnt vmcnt(22)
    v_mfma_f32_16x16x32_bf16 v[72:75], v[184:187], a[156:159], v[72:75]
    buffer_load_dwordx4 v[140:143], v2, s[64:67], s57 offen offset:1024 sc1
    v_mfma_f32_16x16x32_bf16 a[0:3], v[156:159], a[160:163], a[0:3]
    ds_read_b128 v[180:183], v16 offset:16256
    v_mfma_f32_16x16x32_bf16 a[0:3], v[160:163], a[180:183], a[0:3]
    v_mfma_f32_16x16x32_bf16 a[4:7], v[156:159], a[164:167], a[4:7]
    ds_read_b128 v[184:187], v15 offset:16256
    v_mfma_f32_16x16x32_bf16 a[4:7], v[160:163], a[184:187], a[4:7]
    s_waitcnt vmcnt(19)
    v_mfma_f32_16x16x32_bf16 a[8:11], v[156:159], a[168:171], a[8:11]
    buffer_load_dwordx4 v[144:147], v2, s[64:67], s57 offen offset:2048 sc1
    v_mfma_f32_16x16x32_bf16 a[8:11], v[160:163], a[188:191], a[8:11]
    v_mfma_f32_16x16x32_bf16 a[12:15], v[156:159], a[172:175], a[12:15]
    v_mfma_f32_16x16x32_bf16 a[12:15], v[160:163], a[192:195], a[12:15]
    s_add_u32 s35, s51, s53
    s_lshr_b32 m0, s35, 1
    s_lshr_b32 s35, s45, 1
    v_mfma_f32_16x16x32_bf16 a[16:19], v[156:159], a[176:179], a[16:19]
    s_waitcnt lgkmcnt(4)
    v_mfma_f32_16x16x32_bf16 a[16:19], v[160:163], a[196:199], a[16:19]
    buffer_load_dwordx4 v255, s[60:63], s35 offen sc1 lds
    v_mfma_f32_16x16x32_bf16 a[20:23], v[164:167], a[160:163], a[20:23]
    ds_read_b128 v[156:159], v19 offset:15232
    v_mfma_f32_16x16x32_bf16 a[20:23], v[168:171], a[180:183], a[20:23]
    v_mfma_f32_16x16x32_bf16 a[24:27], v[164:167], a[164:167], a[24:27]
    ds_read_b128 v[160:163], v18 offset:15232
    v_mfma_f32_16x16x32_bf16 a[24:27], v[168:171], a[184:187], a[24:27]
    v_mfma_f32_16x16x32_bf16 a[28:31], v[164:167], a[168:171], a[28:31]
    buffer_load_dwordx4 v[148:151], v2, s[64:67], s57 offen offset:3072 sc1
    v_mfma_f32_16x16x32_bf16 a[28:31], v[168:171], a[188:191], a[28:31]
    v_mfma_f32_16x16x32_bf16 a[32:35], v[164:167], a[172:175], a[32:35]
    v_mfma_f32_16x16x32_bf16 a[32:35], v[168:171], a[192:195], a[32:35]
    v_mfma_f32_16x16x32_bf16 a[36:39], v[164:167], a[176:179], a[36:39]
    s_waitcnt lgkmcnt(4)
    v_mfma_f32_16x16x32_bf16 a[36:39], v[168:171], a[196:199], a[36:39]
    buffer_load_dwordx4 v[152:155], v3, s[64:67], s57 offen sc1
    v_mfma_f32_16x16x32_bf16 a[40:43], v[172:175], a[160:163], a[40:43]
    ds_read_b128 v[164:167], v19 offset:16256
    v_mfma_f32_16x16x32_bf16 a[40:43], v[176:179], a[180:183], a[40:43]
    v_mfma_f32_16x16x32_bf16 a[44:47], v[172:175], a[164:167], a[44:47]
    ds_read_b128 v[168:171], v18 offset:16256
    v_mfma_f32_16x16x32_bf16 a[44:47], v[176:179], a[184:187], a[44:47]
    s_mov_b32 s57, 92160
    v_mfma_f32_16x16x32_bf16 a[48:51], v[172:175], a[168:171], a[48:51]
    buffer_load_dwordx4 a[200:203], v2, s[64:67], s57 offen offset:0 sc1
    v_mfma_f32_16x16x32_bf16 a[48:51], v[176:179], a[188:191], a[48:51]
    v_permlane16_swap_b32 v188, v190
    v_permlane16_swap_b32 v189, v191
    v_mfma_f32_16x16x32_bf16 a[52:55], v[172:175], a[172:175], a[52:55]
    v_permlane16_swap_b32 v192, v194
    v_permlane16_swap_b32 v193, v195
    v_mfma_f32_16x16x32_bf16 a[52:55], v[176:179], a[192:195], a[52:55]
    v_permlane16_swap_b32 v196, v198
    v_permlane16_swap_b32 v197, v199
    v_mfma_f32_16x16x32_bf16 a[56:59], v[172:175], a[176:179], a[56:59]
    s_waitcnt lgkmcnt(4)
    v_mfma_f32_16x16x32_bf16 a[56:59], v[176:179], a[196:199], a[56:59]
    buffer_load_dwordx4 a[204:207], v2, s[64:67], s57 offen offset:1024 sc1
    v_mfma_f32_16x16x32_bf16 a[60:63], v[180:183], a[160:163], a[60:63]
    ds_read_b128 v[172:175], v22 offset:15232
    v_mfma_f32_16x16x32_bf16 a[60:63], v[184:187], a[180:183], a[60:63]
    v_permlane16_swap_b32 v200, v202
    v_permlane16_swap_b32 v201, v203
    v_mfma_f32_16x16x32_bf16 a[64:67], v[180:183], a[164:167], a[64:67]
    ds_read_b128 v[176:179], v21 offset:15232
    v_mfma_f32_16x16x32_bf16 a[64:67], v[184:187], a[184:187], a[64:67]
    v_mfma_f32_16x16x32_bf16 a[68:71], v[180:183], a[168:171], a[68:71]
    v_permlane16_swap_b32 v204, v206
    v_permlane16_swap_b32 v205, v207
    v_mfma_f32_16x16x32_bf16 a[68:71], v[184:187], a[188:191], a[68:71]
    v_mfma_f32_16x16x32_bf16 a[72:75], v[180:183], a[172:175], a[72:75]
    buffer_load_dwordx4 a[208:211], v2, s[64:67], s57 offen offset:2048 sc1
    v_mfma_f32_16x16x32_bf16 a[72:75], v[184:187], a[192:195], a[72:75]
    v_mfma_f32_16x16x32_bf16 a[76:79], v[180:183], a[176:179], a[76:79]
    s_waitcnt lgkmcnt(4)
    v_mfma_f32_16x16x32_bf16 a[76:79], v[184:187], a[196:199], a[76:79]
    v_mfma_f32_16x16x32_bf16 a[80:83], v[156:159], a[160:163], a[80:83]
    ds_read_b128 v[180:183], v22 offset:16256
    v_mfma_f32_16x16x32_bf16 a[80:83], v[160:163], a[180:183], a[80:83]
    buffer_load_dwordx4 a[212:215], v2, s[64:67], s57 offen offset:3072 sc1
    v_mfma_f32_16x16x32_bf16 a[84:87], v[156:159], a[164:167], a[84:87]
    ds_read_b128 v[184:187], v21 offset:16256
    v_mfma_f32_16x16x32_bf16 a[84:87], v[160:163], a[184:187], a[84:87]
    v_mfma_f32_16x16x32_bf16 a[88:91], v[156:159], a[168:171], a[88:91]
    v_lshlrev_b32 v234, 16, v188
    v_and_b32 v235, 0xffff0000, v188
    v_mfma_f32_16x16x32_bf16 a[88:91], v[160:163], a[188:191], a[88:91]
    v_add_f32 v36, v36, v234
    v_add_f32 v37, v37, v235
    v_mfma_f32_16x16x32_bf16 a[92:95], v[156:159], a[172:175], a[92:95]
    buffer_load_dwordx4 a[216:219], v3, s[64:67], s57 offen sc1
    v_mfma_f32_16x16x32_bf16 a[92:95], v[160:163], a[192:195], a[92:95]
    v_lshlrev_b32 v236, 16, v189
    v_and_b32 v237, 0xffff0000, v189
    v_mfma_f32_16x16x32_bf16 a[96:99], v[156:159], a[176:179], a[96:99]
    s_waitcnt lgkmcnt(4)
    s_add_u32 s35, s52, s53
    s_lshr_b32 m0, s35, 1
    s_lshr_b32 s35, s46, 1
    v_mfma_f32_16x16x32_bf16 a[96:99], v[160:163], a[196:199], a[96:99]
    v_add_f32 v38, v38, v236
    v_add_f32 v39, v39, v237
    v_mfma_f32_16x16x32_bf16 a[100:103], v[164:167], a[160:163], a[100:103]
    ds_read_b128 v[156:159], v14 offset:15232
    v_mfma_f32_16x16x32_bf16 a[100:103], v[168:171], a[180:183], a[100:103]
    buffer_load_dwordx4 v255, s[60:63], s35 offen sc1 lds
    v_mfma_f32_16x16x32_bf16 a[104:107], v[164:167], a[164:167], a[104:107]
    ds_read_b128 v[160:163], v13 offset:17408
    v_mfma_f32_16x16x32_bf16 a[104:107], v[168:171], a[184:187], a[104:107]
    s_mov_b32 s57, 97280
    v_mfma_f32_16x16x32_bf16 a[108:111], v[164:167], a[168:171], a[108:111]
    v_lshlrev_b32 v234, 16, v192
    v_and_b32 v235, 0xffff0000, v192
    v_mfma_f32_16x16x32_bf16 a[108:111], v[168:171], a[188:191], a[108:111]
    v_add_f32 v40, v40, v234
    v_add_f32 v41, v41, v235
    v_mfma_f32_16x16x32_bf16 a[112:115], v[164:167], a[172:175], a[112:115]
    buffer_load_dwordx4 a[220:223], v2, s[64:67], s57 offen offset:0 sc1
    v_mfma_f32_16x16x32_bf16 a[112:115], v[168:171], a[192:195], a[112:115]
    v_mfma_f32_16x16x32_bf16 a[116:119], v[164:167], a[176:179], a[116:119]
    s_waitcnt lgkmcnt(4)
    v_mfma_f32_16x16x32_bf16 a[116:119], v[168:171], a[196:199], a[116:119]
    v_mfma_f32_16x16x32_bf16 v[36:39], v[172:175], a[160:163], v[36:39]
    ds_read_b128 v[164:167], v14 offset:16256
    v_mfma_f32_16x16x32_bf16 v[36:39], v[176:179], a[180:183], v[36:39]
    buffer_load_dwordx4 a[224:227], v2, s[64:67], s57 offen offset:1024 sc1
    v_mfma_f32_16x16x32_bf16 v[40:43], v[172:175], a[164:167], v[40:43]
    ds_read_b128 v[168:171], v13 offset:18432
    v_mfma_f32_16x16x32_bf16 v[40:43], v[176:179], a[184:187], v[40:43]
    v_mfma_f32_16x16x32_bf16 v[44:47], v[172:175], a[168:171], v[44:47]
    v_mfma_f32_16x16x32_bf16 v[44:47], v[176:179], a[188:191], v[44:47]
    v_mfma_f32_16x16x32_bf16 v[48:51], v[172:175], a[172:175], v[48:51]
    buffer_load_dwordx4 a[228:231], v2, s[64:67], s57 offen offset:2048 sc1
    v_mfma_f32_16x16x32_bf16 v[48:51], v[176:179], a[192:195], v[48:51]
    v_mfma_f32_16x16x32_bf16 v[52:55], v[172:175], a[176:179], v[52:55]
    s_waitcnt lgkmcnt(4)
    v_mfma_f32_16x16x32_bf16 v[52:55], v[176:179], a[196:199], v[52:55]
    v_mfma_f32_16x16x32_bf16 v[56:59], v[180:183], a[160:163], v[56:59]
    ds_read_b128 v[172:175], v17 offset:15232
    v_mfma_f32_16x16x32_bf16 v[56:59], v[184:187], a[180:183], v[56:59]
    buffer_load_dwordx4 a[232:235], v2, s[64:67], s57 offen offset:3072 sc1
    v_mfma_f32_16x16x32_bf16 v[60:63], v[180:183], a[164:167], v[60:63]
    ds_read_b128 v[176:179], v16 offset:17408
    v_mfma_f32_16x16x32_bf16 v[60:63], v[184:187], a[184:187], v[60:63]
    v_mfma_f32_16x16x32_bf16 v[64:67], v[180:183], a[168:171], v[64:67]
    v_mfma_f32_16x16x32_bf16 v[64:67], v[184:187], a[188:191], v[64:67]
    v_mfma_f32_16x16x32_bf16 v[68:71], v[180:183], a[172:175], v[68:71]
    buffer_load_dwordx4 a[236:239], v3, s[64:67], s57 offen sc1
    v_mfma_f32_16x16x32_bf16 v[68:71], v[184:187], a[192:195], v[68:71]
    s_mov_b32 s57, 102400
    v_mfma_f32_16x16x32_bf16 v[72:75], v[180:183], a[176:179], v[72:75]
    s_waitcnt lgkmcnt(4)
    s_waitcnt vmcnt(26)
    v_mfma_f32_16x16x32_bf16 v[72:75], v[184:187], a[196:199], v[72:75]
    v_mfma_f32_16x16x32_bf16 a[0:3], v[156:159], v[76:79], a[0:3]
    ds_read_b128 v[180:183], v17 offset:16256
    v_mfma_f32_16x16x32_bf16 a[0:3], v[160:163], v[96:99], a[0:3]
    buffer_load_dwordx4 a[120:123], v2, s[64:67], s57 offen offset:0 sc1
    v_mfma_f32_16x16x32_bf16 a[4:7], v[156:159], v[80:83], a[4:7]
    ds_read_b128 v[184:187], v16 offset:18432
    v_mfma_f32_16x16x32_bf16 a[4:7], v[160:163], v[100:103], a[4:7]
    s_waitcnt vmcnt(24)
    v_mfma_f32_16x16x32_bf16 a[8:11], v[156:159], v[84:87], a[8:11]
    v_mfma_f32_16x16x32_bf16 a[8:11], v[160:163], v[104:107], a[8:11]
    v_mfma_f32_16x16x32_bf16 a[12:15], v[156:159], v[88:91], a[12:15]
    v_mfma_f32_16x16x32_bf16 a[12:15], v[160:163], v[108:111], a[12:15]
    v_mfma_f32_16x16x32_bf16 a[16:19], v[156:159], v[92:95], a[16:19]
    s_waitcnt lgkmcnt(4)
    v_mfma_f32_16x16x32_bf16 a[16:19], v[160:163], v[112:115], a[16:19]
    buffer_load_dwordx4 a[124:127], v2, s[64:67], s57 offen offset:1024 sc1
    v_mfma_f32_16x16x32_bf16 a[20:23], v[164:167], v[76:79], a[20:23]
    ds_read_b128 v[156:159], v20 offset:15232
    v_mfma_f32_16x16x32_bf16 a[20:23], v[168:171], v[96:99], a[20:23]
    v_lshlrev_b32 v236, 16, v193
    v_and_b32 v237, 0xffff0000, v193
    v_mfma_f32_16x16x32_bf16 a[24:27], v[164:167], v[80:83], a[24:27]
    ds_read_b128 v[160:163], v19 offset:17408
    v_mfma_f32_16x16x32_bf16 a[24:27], v[168:171], v[100:103], a[24:27]
    v_mfma_f32_16x16x32_bf16 a[28:31], v[164:167], v[84:87], a[28:31]
    buffer_load_dwordx4 a[128:131], v2, s[64:67], s57 offen offset:2048 sc1
    v_mfma_f32_16x16x32_bf16 a[28:31], v[168:171], v[104:107], a[28:31]
    v_add_f32 v42, v42, v236
    v_add_f32 v43, v43, v237
    v_mfma_f32_16x16x32_bf16 a[32:35], v[164:167], v[88:91], a[32:35]
    v_lshlrev_b32 v234, 16, v196
    v_and_b32 v235, 0xffff0000, v196
    v_mfma_f32_16x16x32_bf16 a[32:35], v[168:171], v[108:111], a[32:35]
    v_add_f32 v44, v44, v234
    v_add_f32 v45, v45, v235
    v_mfma_f32_16x16x32_bf16 a[36:39], v[164:167], v[92:95], a[36:39]
    s_waitcnt lgkmcnt(4)
    v_mfma_f32_16x16x32_bf16 a[36:39], v[168:171], v[112:115], a[36:39]
    buffer_load_dwordx4 a[132:135], v2, s[64:67], s57 offen offset:3072 sc1
    v_mfma_f32_16x16x32_bf16 a[40:43], v[172:175], v[76:79], a[40:43]
    ds_read_b128 v[164:167], v20 offset:16256
    v_mfma_f32_16x16x32_bf16 a[40:43], v[176:179], v[96:99], a[40:43]
    v_lshlrev_b32 v236, 16, v197
    v_and_b32 v237, 0xffff0000, v197
    v_mfma_f32_16x16x32_bf16 a[44:47], v[172:175], v[80:83], a[44:47]
    ds_read_b128 v[168:171], v19 offset:18432
    v_mfma_f32_16x16x32_bf16 a[44:47], v[176:179], v[100:103], a[44:47]
    v_mfma_f32_16x16x32_bf16 a[48:51], v[172:175], v[84:87], a[48:51]
    buffer_load_dwordx4 a[136:139], v3, s[64:67], s57 offen sc1
    v_mfma_f32_16x16x32_bf16 a[48:51], v[176:179], v[104:107], a[48:51]
    v_add_f32 v46, v46, v236
    v_add_f32 v47, v47, v237
    v_mfma_f32_16x16x32_bf16 a[52:55], v[172:175], v[88:91], a[52:55]
    v_lshlrev_b32 v234, 16, v200
    v_and_b32 v235, 0xffff0000, v200
    v_mfma_f32_16x16x32_bf16 a[52:55], v[176:179], v[108:111], a[52:55]
    v_add_f32 v48, v48, v234
    v_add_f32 v49, v49, v235
    v_mfma_f32_16x16x32_bf16 a[56:59], v[172:175], v[92:95], a[56:59]
    s_waitcnt lgkmcnt(4)
    s_mov_b32 s57, 107520
    v_mfma_f32_16x16x32_bf16 a[56:59], v[176:179], v[112:115], a[56:59]
    buffer_load_dwordx4 a[140:143], v2, s[64:67], s57 offen offset:0 sc1
    v_mfma_f32_16x16x32_bf16 a[60:63], v[180:183], v[76:79], a[60:63]
    ds_read_b128 v[172:175], v23 offset:15232
    v_mfma_f32_16x16x32_bf16 a[60:63], v[184:187], v[96:99], a[60:63]
    v_lshlrev_b32 v236, 16, v201
    v_and_b32 v237, 0xffff0000, v201
    v_mfma_f32_16x16x32_bf16 a[64:67], v[180:183], v[80:83], a[64:67]
    ds_read_b128 v[176:179], v22 offset:17408
    v_mfma_f32_16x16x32_bf16 a[64:67], v[184:187], v[100:103], a[64:67]
    v_mfma_f32_16x16x32_bf16 a[68:71], v[180:183], v[84:87], a[68:71]
    buffer_load_dwordx4 a[144:147], v2, s[64:67], s57 offen offset:1024 sc1
    v_mfma_f32_16x16x32_bf16 a[68:71], v[184:187], v[104:107], a[68:71]
    v_add_f32 v50, v50, v236
    v_add_f32 v51, v51, v237
    v_mfma_f32_16x16x32_bf16 a[72:75], v[180:183], v[88:91], a[72:75]
    v_lshlrev_b32 v234, 16, v204
    v_and_b32 v235, 0xffff0000, v204
    v_mfma_f32_16x16x32_bf16 a[72:75], v[184:187], v[108:111], a[72:75]
    v_add_f32 v52, v52, v234
    v_add_f32 v53, v53, v235
    v_mfma_f32_16x16x32_bf16 a[76:79], v[180:183], v[92:95], a[76:79]
    s_waitcnt lgkmcnt(4)
    v_mfma_f32_16x16x32_bf16 a[76:79], v[184:187], v[112:115], a[76:79]
    buffer_load_dwordx4 a[148:151], v2, s[64:67], s57 offen offset:2048 sc1
    v_mfma_f32_16x16x32_bf16 a[80:83], v[156:159], v[76:79], a[80:83]
    ds_read_b128 v[180:183], v23 offset:16256
    v_mfma_f32_16x16x32_bf16 a[80:83], v[160:163], v[96:99], a[80:83]
    v_lshlrev_b32 v236, 16, v205
    v_and_b32 v237, 0xffff0000, v205
    v_mfma_f32_16x16x32_bf16 a[84:87], v[156:159], v[80:83], a[84:87]
    ds_read_b128 v[184:187], v22 offset:18432
    v_mfma_f32_16x16x32_bf16 a[84:87], v[160:163], v[100:103], a[84:87]
    v_mfma_f32_16x16x32_bf16 a[88:91], v[156:159], v[84:87], a[88:91]
    buffer_load_dwordx4 a[152:155], v2, s[64:67], s57 offen offset:3072 sc1
    v_mfma_f32_16x16x32_bf16 a[88:91], v[160:163], v[104:107], a[88:91]
    v_add_f32 v54, v54, v236
    v_add_f32 v55, v55, v237
    v_mfma_f32_16x16x32_bf16 a[92:95], v[156:159], v[88:91], a[92:95]
    v_lshlrev_b32 v234, 16, v190
    v_and_b32 v235, 0xffff0000, v190
    v_mfma_f32_16x16x32_bf16 a[92:95], v[160:163], v[108:111], a[92:95]
    v_add_f32 v56, v56, v234
    v_add_f32 v57, v57, v235
    v_mfma_f32_16x16x32_bf16 a[96:99], v[156:159], v[92:95], a[96:99]
    s_waitcnt lgkmcnt(4)
    v_mfma_f32_16x16x32_bf16 a[96:99], v[160:163], v[112:115], a[96:99]
    buffer_load_dwordx4 a[156:159], v3, s[64:67], s57 offen sc1
    v_mfma_f32_16x16x32_bf16 a[100:103], v[164:167], v[76:79], a[100:103]
    ds_read_b128 v[156:159], v12 offset:17408
    v_mfma_f32_16x16x32_bf16 a[100:103], v[168:171], v[96:99], a[100:103]
    v_lshlrev_b32 v236, 16, v191
    v_and_b32 v237, 0xffff0000, v191
    v_mfma_f32_16x16x32_bf16 a[104:107], v[164:167], v[80:83], a[104:107]
    ds_read_b128 v[160:163], v14 offset:17408
    v_mfma_f32_16x16x32_bf16 a[104:107], v[168:171], v[100:103], a[104:107]
    s_mov_b32 s57, 112640
    v_mfma_f32_16x16x32_bf16 a[108:111], v[164:167], v[84:87], a[108:111]
    buffer_load_dwordx4 a[160:163], v2, s[64:67], s57 offen offset:0 sc1
    v_mfma_f32_16x16x32_bf16 a[108:111], v[168:171], v[104:107], a[108:111]
    v_add_f32 v58, v58, v236
    v_add_f32 v59, v59, v237
    v_mfma_f32_16x16x32_bf16 a[112:115], v[164:167], v[88:91], a[112:115]
    v_mfma_f32_16x16x32_bf16 a[112:115], v[168:171], v[108:111], a[112:115]
    v_mfma_f32_16x16x32_bf16 a[116:119], v[164:167], v[92:95], a[116:119]
    s_waitcnt lgkmcnt(4)
    v_mfma_f32_16x16x32_bf16 a[116:119], v[168:171], v[112:115], a[116:119]
    v_mfma_f32_16x16x32_bf16 v[36:39], v[172:175], v[76:79], v[36:39]
    ds_read_b128 v[164:167], v12 offset:18432
    v_mfma_f32_16x16x32_bf16 v[36:39], v[176:179], v[96:99], v[36:39]
    buffer_load_dwordx4 a[164:167], v2, s[64:67], s57 offen offset:1024 sc1
    v_mfma_f32_16x16x32_bf16 v[40:43], v[172:175], v[80:83], v[40:43]
    ds_read_b128 v[168:171], v14 offset:18432
    v_mfma_f32_16x16x32_bf16 v[40:43], v[176:179], v[100:103], v[40:43]
    v_mfma_f32_16x16x32_bf16 v[44:47], v[172:175], v[84:87], v[44:47]
    v_mfma_f32_16x16x32_bf16 v[44:47], v[176:179], v[104:107], v[44:47]
    v_mfma_f32_16x16x32_bf16 v[48:51], v[172:175], v[88:91], v[48:51]
    buffer_load_dwordx4 a[168:171], v2, s[64:67], s57 offen offset:2048 sc1
    v_mfma_f32_16x16x32_bf16 v[48:51], v[176:179], v[108:111], v[48:51]
    v_mfma_f32_16x16x32_bf16 v[52:55], v[172:175], v[92:95], v[52:55]
    s_waitcnt lgkmcnt(4)
    v_mfma_f32_16x16x32_bf16 v[52:55], v[176:179], v[112:115], v[52:55]
    v_mfma_f32_16x16x32_bf16 v[56:59], v[180:183], v[76:79], v[56:59]
    ds_read_b128 v[172:175], v15 offset:17408
    v_mfma_f32_16x16x32_bf16 v[56:59], v[184:187], v[96:99], v[56:59]
    buffer_load_dwordx4 a[172:175], v2, s[64:67], s57 offen offset:3072 sc1
    v_mfma_f32_16x16x32_bf16 v[60:63], v[180:183], v[80:83], v[60:63]
    ds_read_b128 v[176:179], v17 offset:17408
    v_mfma_f32_16x16x32_bf16 v[60:63], v[184:187], v[100:103], v[60:63]
    v_mfma_f32_16x16x32_bf16 v[64:67], v[180:183], v[84:87], v[64:67]
    v_mfma_f32_16x16x32_bf16 v[64:67], v[184:187], v[104:107], v[64:67]
    v_mfma_f32_16x16x32_bf16 v[68:71], v[180:183], v[88:91], v[68:71]
    buffer_load_dwordx4 a[176:179], v3, s[64:67], s57 offen sc1
    v_mfma_f32_16x16x32_bf16 v[68:71], v[184:187], v[108:111], v[68:71]
    v_mfma_f32_16x16x32_bf16 v[72:75], v[180:183], v[92:95], v[72:75]
    s_waitcnt lgkmcnt(4)
    s_waitcnt vmcnt(30)
    v_mfma_f32_16x16x32_bf16 v[72:75], v[184:187], v[112:115], v[72:75]
    v_mfma_f32_16x16x32_bf16 a[0:3], v[156:159], v[116:119], a[0:3]
    ds_read_b128 v[180:183], v15 offset:18432
    v_mfma_f32_16x16x32_bf16 a[0:3], v[160:163], v[136:139], a[0:3]
    v_mfma_f32_16x16x32_bf16 a[4:7], v[156:159], v[120:123], a[4:7]
    ds_read_b128 v[184:187], v17 offset:18432
    v_mfma_f32_16x16x32_bf16 a[4:7], v[160:163], v[140:143], a[4:7]
    s_waitcnt vmcnt(26)
    v_mfma_f32_16x16x32_bf16 a[8:11], v[156:159], v[124:127], a[8:11]
    v_mfma_f32_16x16x32_bf16 a[8:11], v[160:163], v[144:147], a[8:11]
    v_mfma_f32_16x16x32_bf16 a[12:15], v[156:159], v[128:131], a[12:15]
    v_mfma_f32_16x16x32_bf16 a[12:15], v[160:163], v[148:151], a[12:15]
    v_mfma_f32_16x16x32_bf16 a[16:19], v[156:159], v[132:135], a[16:19]
    s_waitcnt lgkmcnt(4)
    v_mfma_f32_16x16x32_bf16 a[16:19], v[160:163], v[152:155], a[16:19]
    v_lshlrev_b32 v234, 16, v194
    v_and_b32 v235, 0xffff0000, v194
    v_mfma_f32_16x16x32_bf16 a[20:23], v[164:167], v[116:119], a[20:23]
    ds_read_b128 v[156:159], v18 offset:17408
    v_mfma_f32_16x16x32_bf16 a[20:23], v[168:171], v[136:139], a[20:23]
    v_add_f32 v60, v60, v234
    v_add_f32 v61, v61, v235
    v_mfma_f32_16x16x32_bf16 a[24:27], v[164:167], v[120:123], a[24:27]
    ds_read_b128 v[160:163], v20 offset:17408
    v_mfma_f32_16x16x32_bf16 a[24:27], v[168:171], v[140:143], a[24:27]
    v_mfma_f32_16x16x32_bf16 a[28:31], v[164:167], v[124:127], a[28:31]
    v_lshlrev_b32 v236, 16, v195
    v_and_b32 v237, 0xffff0000, v195
    v_mfma_f32_16x16x32_bf16 a[28:31], v[168:171], v[144:147], a[28:31]
    v_add_f32 v62, v62, v236
    v_add_f32 v63, v63, v237
    v_mfma_f32_16x16x32_bf16 a[32:35], v[164:167], v[128:131], a[32:35]
    v_lshlrev_b32 v234, 16, v198
    v_and_b32 v235, 0xffff0000, v198
    v_mfma_f32_16x16x32_bf16 a[32:35], v[168:171], v[148:151], a[32:35]
    v_add_f32 v64, v64, v234
    v_add_f32 v65, v65, v235
    v_mfma_f32_16x16x32_bf16 a[36:39], v[164:167], v[132:135], a[36:39]
    s_waitcnt lgkmcnt(4)
    v_mfma_f32_16x16x32_bf16 a[36:39], v[168:171], v[152:155], a[36:39]
    v_lshlrev_b32 v236, 16, v199
    v_and_b32 v237, 0xffff0000, v199
    v_mfma_f32_16x16x32_bf16 a[40:43], v[172:175], v[116:119], a[40:43]
    ds_read_b128 v[164:167], v18 offset:18432
    v_mfma_f32_16x16x32_bf16 a[40:43], v[176:179], v[136:139], a[40:43]
    v_add_f32 v66, v66, v236
    v_add_f32 v67, v67, v237
    v_mfma_f32_16x16x32_bf16 a[44:47], v[172:175], v[120:123], a[44:47]
    ds_read_b128 v[168:171], v20 offset:18432
    v_mfma_f32_16x16x32_bf16 a[44:47], v[176:179], v[140:143], a[44:47]
    v_mfma_f32_16x16x32_bf16 a[48:51], v[172:175], v[124:127], a[48:51]
    v_lshlrev_b32 v234, 16, v202
    v_and_b32 v235, 0xffff0000, v202
    v_mfma_f32_16x16x32_bf16 a[48:51], v[176:179], v[144:147], a[48:51]
    v_add_f32 v68, v68, v234
    v_add_f32 v69, v69, v235
    v_mfma_f32_16x16x32_bf16 a[52:55], v[172:175], v[128:131], a[52:55]
    v_lshlrev_b32 v236, 16, v203
    v_and_b32 v237, 0xffff0000, v203
    v_mfma_f32_16x16x32_bf16 a[52:55], v[176:179], v[148:151], a[52:55]
    v_add_f32 v70, v70, v236
    v_add_f32 v71, v71, v237
    v_mfma_f32_16x16x32_bf16 a[56:59], v[172:175], v[132:135], a[56:59]
    s_waitcnt lgkmcnt(4)
    v_mfma_f32_16x16x32_bf16 a[56:59], v[176:179], v[152:155], a[56:59]
    v_lshlrev_b32 v234, 16, v206
    v_and_b32 v235, 0xffff0000, v206
    v_mfma_f32_16x16x32_bf16 a[60:63], v[180:183], v[116:119], a[60:63]
    ds_read_b128 v[172:175], v21 offset:17408
    v_mfma_f32_16x16x32_bf16 a[60:63], v[184:187], v[136:139], a[60:63]
    v_add_f32 v72, v72, v234
    v_add_f32 v73, v73, v235
    v_mfma_f32_16x16x32_bf16 a[64:67], v[180:183], v[120:123], a[64:67]
    ds_read_b128 v[176:179], v23 offset:17408
    v_mfma_f32_16x16x32_bf16 a[64:67], v[184:187], v[140:143], a[64:67]
    v_mfma_f32_16x16x32_bf16 a[68:71], v[180:183], v[124:127], a[68:71]
    v_lshlrev_b32 v236, 16, v207
    v_and_b32 v237, 0xffff0000, v207
    v_mfma_f32_16x16x32_bf16 a[68:71], v[184:187], v[144:147], a[68:71]
    v_add_f32 v74, v74, v236
    v_add_f32 v75, v75, v237
    v_mfma_f32_16x16x32_bf16 a[72:75], v[180:183], v[128:131], a[72:75]
    v_mfma_f32_16x16x32_bf16 a[72:75], v[184:187], v[148:151], a[72:75]
    v_mfma_f32_16x16x32_bf16 a[76:79], v[180:183], v[132:135], a[76:79]
    s_waitcnt lgkmcnt(4)
    v_mfma_f32_16x16x32_bf16 a[76:79], v[184:187], v[152:155], a[76:79]
    v_mfma_f32_16x16x32_bf16 a[80:83], v[156:159], v[116:119], a[80:83]
    ds_read_b128 v[180:183], v21 offset:18432
    v_mfma_f32_16x16x32_bf16 a[80:83], v[160:163], v[136:139], a[80:83]
    v_mfma_f32_16x16x32_bf16 a[84:87], v[156:159], v[120:123], a[84:87]
    ds_read_b128 v[184:187], v23 offset:18432
    v_mfma_f32_16x16x32_bf16 a[84:87], v[160:163], v[140:143], a[84:87]
    v_mfma_f32_16x16x32_bf16 a[88:91], v[156:159], v[124:127], a[88:91]
    v_mfma_f32_16x16x32_bf16 a[88:91], v[160:163], v[144:147], a[88:91]
    v_mfma_f32_16x16x32_bf16 a[92:95], v[156:159], v[128:131], a[92:95]
    v_mfma_f32_16x16x32_bf16 a[92:95], v[160:163], v[148:151], a[92:95]
    v_mfma_f32_16x16x32_bf16 a[96:99], v[156:159], v[132:135], a[96:99]
    s_waitcnt lgkmcnt(4)
    v_mfma_f32_16x16x32_bf16 a[96:99], v[160:163], v[152:155], a[96:99]
    v_mfma_f32_16x16x32_bf16 a[100:103], v[164:167], v[116:119], a[100:103]
    s_waitcnt vmcnt(20)
    ds_read_b128 v[156:159], v24 offset:0
    v_mfma_f32_16x16x32_bf16 a[100:103], v[168:171], v[136:139], a[100:103]
    v_mfma_f32_16x16x32_bf16 a[104:107], v[164:167], v[120:123], a[104:107]
    ds_read_b128 v[160:163], v24 offset:1088
    v_mfma_f32_16x16x32_bf16 a[104:107], v[168:171], v[140:143], a[104:107]
    s_barrier
    v_mfma_f32_16x16x32_bf16 a[108:111], v[164:167], v[124:127], a[108:111]
    v_mfma_f32_16x16x32_bf16 a[108:111], v[168:171], v[144:147], a[108:111]
    v_mfma_f32_16x16x32_bf16 a[112:115], v[164:167], v[128:131], a[112:115]
    v_mfma_f32_16x16x32_bf16 a[112:115], v[168:171], v[148:151], a[112:115]
    v_mfma_f32_16x16x32_bf16 a[116:119], v[164:167], v[132:135], a[116:119]
    s_waitcnt lgkmcnt(4)
    v_mfma_f32_16x16x32_bf16 a[116:119], v[168:171], v[152:155], a[116:119]
    v_mfma_f32_16x16x32_bf16 v[36:39], v[172:175], v[116:119], v[36:39]
    ds_read_b128 v[164:167], v24 offset:2176
    v_mfma_f32_16x16x32_bf16 v[36:39], v[176:179], v[136:139], v[36:39]
    v_mfma_f32_16x16x32_bf16 v[40:43], v[172:175], v[120:123], v[40:43]
    ds_read_b128 v[168:171], v25 offset:64
    v_mfma_f32_16x16x32_bf16 v[40:43], v[176:179], v[140:143], v[40:43]
    v_mfma_f32_16x16x32_bf16 v[44:47], v[172:175], v[124:127], v[44:47]
    v_mfma_f32_16x16x32_bf16 v[44:47], v[176:179], v[144:147], v[44:47]
    v_mfma_f32_16x16x32_bf16 v[48:51], v[172:175], v[128:131], v[48:51]
    v_mfma_f32_16x16x32_bf16 v[48:51], v[176:179], v[148:151], v[48:51]
    v_mfma_f32_16x16x32_bf16 v[52:55], v[172:175], v[132:135], v[52:55]
    s_waitcnt lgkmcnt(4)
    v_mfma_f32_16x16x32_bf16 v[52:55], v[176:179], v[152:155], v[52:55]
    v_mfma_f32_16x16x32_bf16 v[56:59], v[180:183], v[116:119], v[56:59]
    ds_read_b128 v[172:175], v24 offset:512
    v_mfma_f32_16x16x32_bf16 v[56:59], v[184:187], v[136:139], v[56:59]
    v_mfma_f32_16x16x32_bf16 v[60:63], v[180:183], v[120:123], v[60:63]
    ds_read_b128 v[176:179], v24 offset:1600
    v_mfma_f32_16x16x32_bf16 v[60:63], v[184:187], v[140:143], v[60:63]
    v_mfma_f32_16x16x32_bf16 v[64:67], v[180:183], v[124:127], v[64:67]
    v_mfma_f32_16x16x32_bf16 v[64:67], v[184:187], v[144:147], v[64:67]
    v_mfma_f32_16x16x32_bf16 v[68:71], v[180:183], v[128:131], v[68:71]
    v_mfma_f32_16x16x32_bf16 v[68:71], v[184:187], v[148:151], v[68:71]
    v_mfma_f32_16x16x32_bf16 v[72:75], v[180:183], v[132:135], v[72:75]
    s_waitcnt lgkmcnt(4)
    s_waitcnt vmcnt(18)
    v_mfma_f32_16x16x32_bf16 v[72:75], v[184:187], v[152:155], v[72:75]
    v_mfma_f32_16x16x32_bf16 a[0:3], v[156:159], a[200:203], a[0:3]
    ds_read_b128 v[180:183], v24 offset:2688
    v_mfma_f32_16x16x32_bf16 a[0:3], v[160:163], a[220:223], a[0:3]
    v_mfma_f32_16x16x32_bf16 a[4:7], v[156:159], a[204:207], a[4:7]
    ds_read_b128 v[184:187], v25 offset:576
    v_mfma_f32_16x16x32_bf16 a[4:7], v[160:163], a[224:227], a[4:7]
    s_waitcnt vmcnt(15)
    v_mfma_f32_16x16x32_bf16 a[8:11], v[156:159], a[208:211], a[8:11]
    v_mfma_f32_16x16x32_bf16 a[8:11], v[160:163], a[228:231], a[8:11]
    v_mfma_f32_16x16x32_bf16 a[12:15], v[156:159], a[212:215], a[12:15]
    v_mfma_f32_16x16x32_bf16 a[12:15], v[160:163], a[232:235], a[12:15]
    v_mfma_f32_16x16x32_bf16 a[16:19], v[156:159], a[216:219], a[16:19]
    s_waitcnt lgkmcnt(4)
    s_waitcnt vmcnt(8)
    v_mfma_f32_16x16x32_bf16 a[16:19], v[160:163], a[236:239], a[16:19]
    v_mfma_f32_16x16x32_bf16 a[0:3], v[164:167], a[120:123], a[0:3]
    ds_read_b128 v[156:159], v27 offset:0
    v_mfma_f32_16x16x32_bf16 a[0:3], v[168:171], a[140:143], a[0:3]
    v_mfma_f32_16x16x32_bf16 a[4:7], v[164:167], a[124:127], a[4:7]
    ds_read_b128 v[160:163], v27 offset:1088
    v_mfma_f32_16x16x32_bf16 a[4:7], v[168:171], a[144:147], a[4:7]
    s_waitcnt vmcnt(5)
    v_mfma_f32_16x16x32_bf16 a[8:11], v[164:167], a[128:131], a[8:11]
    v_mfma_f32_16x16x32_bf16 a[8:11], v[168:171], a[148:151], a[8:11]
    v_mfma_f32_16x16x32_bf16 a[12:15], v[164:167], a[132:135], a[12:15]
    v_mfma_f32_16x16x32_bf16 a[12:15], v[168:171], a[152:155], a[12:15]
    v_mfma_f32_16x16x32_bf16 a[16:19], v[164:167], a[136:139], a[16:19]
    s_waitcnt lgkmcnt(4)
    v_mfma_f32_16x16x32_bf16 a[16:19], v[168:171], a[156:159], a[16:19]
    v_mfma_f32_16x16x32_bf16 a[20:23], v[172:175], a[200:203], a[20:23]
    ds_read_b128 v[164:167], v27 offset:2176
    v_mfma_f32_16x16x32_bf16 a[20:23], v[176:179], a[220:223], a[20:23]
    ds_write_b128 v248, a[0:3] offset:6528
    v_mfma_f32_16x16x32_bf16 a[24:27], v[172:175], a[204:207], a[24:27]
    ds_read_b128 v[168:171], v28 offset:64
    v_mfma_f32_16x16x32_bf16 a[24:27], v[176:179], a[224:227], a[24:27]
    v_mfma_f32_16x16x32_bf16 a[28:31], v[172:175], a[208:211], a[28:31]
    v_mfma_f32_16x16x32_bf16 a[28:31], v[176:179], a[228:231], a[28:31]
    v_mfma_f32_16x16x32_bf16 a[32:35], v[172:175], a[212:215], a[32:35]
    ds_write_b128 v248, a[4:7] offset:7552
    v_mfma_f32_16x16x32_bf16 a[32:35], v[176:179], a[232:235], a[32:35]
    v_mfma_f32_16x16x32_bf16 a[36:39], v[172:175], a[216:219], a[36:39]
    s_waitcnt lgkmcnt(6)
    v_mfma_f32_16x16x32_bf16 a[36:39], v[176:179], a[236:239], a[36:39]
    ds_write_b128 v248, a[8:11] offset:8576
    v_mfma_f32_16x16x32_bf16 a[20:23], v[180:183], a[120:123], a[20:23]
    ds_read_b128 v[172:175], v29 offset:2240
    v_mfma_f32_16x16x32_bf16 a[20:23], v[184:187], a[140:143], a[20:23]
    v_mfma_f32_16x16x32_bf16 a[24:27], v[180:183], a[124:127], a[24:27]
    ds_read_b128 v[176:179], v27 offset:512
    v_mfma_f32_16x16x32_bf16 a[24:27], v[184:187], a[144:147], a[24:27]
    ds_write_b128 v248, a[12:15] offset:9600
    v_mfma_f32_16x16x32_bf16 a[28:31], v[180:183], a[128:131], a[28:31]
    v_mfma_f32_16x16x32_bf16 a[28:31], v[184:187], a[148:151], a[28:31]
    v_mfma_f32_16x16x32_bf16 a[32:35], v[180:183], a[132:135], a[32:35]
    v_mfma_f32_16x16x32_bf16 a[32:35], v[184:187], a[152:155], a[32:35]
    ds_write_b128 v248, a[16:19] offset:10624
    v_mfma_f32_16x16x32_bf16 a[36:39], v[180:183], a[136:139], a[36:39]
    s_waitcnt lgkmcnt(9)
    v_mfma_f32_16x16x32_bf16 a[36:39], v[184:187], a[156:159], a[36:39]
    v_mfma_f32_16x16x32_bf16 a[40:43], v[156:159], a[200:203], a[40:43]
    ds_read_b128 v[180:183], v27 offset:1600
    v_mfma_f32_16x16x32_bf16 a[40:43], v[160:163], a[220:223], a[40:43]
    ds_write_b128 v248, a[20:23] offset:11648
    v_mfma_f32_16x16x32_bf16 a[44:47], v[156:159], a[204:207], a[44:47]
    ds_read_b128 v[184:187], v27 offset:2688
    v_mfma_f32_16x16x32_bf16 a[44:47], v[160:163], a[224:227], a[44:47]
    v_mfma_f32_16x16x32_bf16 a[48:51], v[156:159], a[208:211], a[48:51]
    v_mfma_f32_16x16x32_bf16 a[48:51], v[160:163], a[228:231], a[48:51]
    v_mfma_f32_16x16x32_bf16 a[52:55], v[156:159], a[212:215], a[52:55]
    ds_write_b128 v248, a[24:27] offset:12672
    v_mfma_f32_16x16x32_bf16 a[52:55], v[160:163], a[232:235], a[52:55]
    v_mfma_f32_16x16x32_bf16 a[56:59], v[156:159], a[216:219], a[56:59]
    s_waitcnt lgkmcnt(7)
    s_waitcnt vmcnt(4)
    v_mfma_f32_16x16x32_bf16 a[56:59], v[160:163], a[236:239], a[56:59]
    v_mfma_f32_16x16x32_bf16 a[40:43], v[164:167], a[120:123], a[40:43]
    ds_read_b128 v[156:159], v28 offset:576
    v_mfma_f32_16x16x32_bf16 a[40:43], v[168:171], a[140:143], a[40:43]
    ds_write_b128 v248, a[28:31] offset:13696
    v_mfma_f32_16x16x32_bf16 a[40:43], v[172:175], a[160:163], a[40:43]
    ds_read_b128 v[160:163], v29 offset:2752
    v_mfma_f32_16x16x32_bf16 a[44:47], v[164:167], a[124:127], a[44:47]
    s_waitcnt vmcnt(2)
    v_mfma_f32_16x16x32_bf16 a[44:47], v[168:171], a[144:147], a[44:47]
    v_mfma_f32_16x16x32_bf16 a[44:47], v[172:175], a[164:167], a[44:47]
    v_mfma_f32_16x16x32_bf16 a[48:51], v[164:167], a[128:131], a[48:51]
    ds_write_b128 v248, a[32:35] offset:14720
    v_mfma_f32_16x16x32_bf16 a[48:51], v[168:171], a[148:151], a[48:51]
    v_mfma_f32_16x16x32_bf16 a[48:51], v[172:175], a[168:171], a[48:51]
    s_waitcnt vmcnt(0)
    v_mfma_f32_16x16x32_bf16 a[52:55], v[164:167], a[132:135], a[52:55]
    v_mfma_f32_16x16x32_bf16 a[52:55], v[168:171], a[152:155], a[52:55]
    v_mfma_f32_16x16x32_bf16 a[52:55], v[172:175], a[172:175], a[52:55]
    ds_write_b128 v248, a[36:39] offset:15744
    v_mfma_f32_16x16x32_bf16 a[56:59], v[164:167], a[136:139], a[56:59]
    ds_read_b128 v[164:167], v30 offset:0
    v_mfma_f32_16x16x32_bf16 a[56:59], v[168:171], a[156:159], a[56:59]
    s_waitcnt lgkmcnt(9)
    v_mfma_f32_16x16x32_bf16 a[56:59], v[172:175], a[176:179], a[56:59]
    v_mfma_f32_16x16x32_bf16 a[60:63], v[176:179], a[200:203], a[60:63]
    ds_read_b128 v[168:171], v30 offset:1088
    v_mfma_f32_16x16x32_bf16 a[60:63], v[180:183], a[220:223], a[60:63]
    ds_write_b128 v248, a[40:43] offset:16768
    v_mfma_f32_16x16x32_bf16 a[64:67], v[176:179], a[204:207], a[64:67]
    s_waitcnt lgkmcnt(3)
    s_barrier
    v_mfma_f32_16x16x32_bf16 a[64:67], v[180:183], a[224:227], a[64:67]
    ds_read_b128 v[76:79], v249 offset:6528
    v_mfma_f32_16x16x32_bf16 a[68:71], v[176:179], a[208:211], a[68:71]
    ds_read_b128 v[80:83], v249 offset:7552
    v_mfma_f32_16x16x32_bf16 a[68:71], v[180:183], a[228:231], a[68:71]
    ds_read_b128 v[172:175], v30 offset:2176
    v_mfma_f32_16x16x32_bf16 a[72:75], v[176:179], a[212:215], a[72:75]
    ds_write_b128 v248, a[44:47] offset:17792
    v_mfma_f32_16x16x32_bf16 a[72:75], v[180:183], a[232:235], a[72:75]
    ds_read_b128 v[84:87], v249 offset:8576
    v_mfma_f32_16x16x32_bf16 a[76:79], v[176:179], a[216:219], a[76:79]
    ds_read_b128 v[88:91], v249 offset:9600
    v_mfma_f32_16x16x32_bf16 a[76:79], v[180:183], a[236:239], a[76:79]
    ds_read_b128 v[92:95], v249 offset:10624
    v_mfma_f32_16x16x32_bf16 a[60:63], v[184:187], a[120:123], a[60:63]
    ds_read_b128 v[176:179], v31 offset:64
    v_mfma_f32_16x16x32_bf16 a[60:63], v[156:159], a[140:143], a[60:63]
    ds_write_b128 v248, a[48:51] offset:18816
    v_mfma_f32_16x16x32_bf16 a[60:63], v[160:163], a[160:163], a[60:63]
    ds_read_b128 v[96:99], v249 offset:11648
    v_mfma_f32_16x16x32_bf16 a[64:67], v[184:187], a[124:127], a[64:67]
    ds_read_b128 v[100:103], v249 offset:12672
    v_mfma_f32_16x16x32_bf16 a[64:67], v[156:159], a[144:147], a[64:67]
    ds_read_b128 v[104:107], v249 offset:13696
    v_mfma_f32_16x16x32_bf16 a[64:67], v[160:163], a[164:167], a[64:67]
    ds_read_b128 v[180:183], v30 offset:512
    v_mfma_f32_16x16x32_bf16 a[68:71], v[184:187], a[128:131], a[68:71]
    ds_write_b128 v248, a[52:55] offset:19840
    v_mfma_f32_16x16x32_bf16 a[68:71], v[156:159], a[148:151], a[68:71]
    ds_read_b128 v[108:111], v249 offset:14720
    v_mfma_f32_16x16x32_bf16 a[68:71], v[160:163], a[168:171], a[68:71]
    ds_read_b128 v[112:115], v249 offset:15744
    v_mfma_f32_16x16x32_bf16 a[72:75], v[184:187], a[132:135], a[72:75]
    s_waitcnt lgkmcnt(9)
    v_add_f32 v36, v36, v76
    v_add_f32 v37, v37, v77
    v_mfma_f32_16x16x32_bf16 a[72:75], v[156:159], a[152:155], a[72:75]
    v_add_f32 v38, v38, v78
    v_add_f32 v39, v39, v79
    v_mfma_f32_16x16x32_bf16 a[72:75], v[160:163], a[172:175], a[72:75]
    ds_write_b128 v248, a[56:59] offset:20864
    v_mfma_f32_16x16x32_bf16 a[76:79], v[184:187], a[136:139], a[76:79]
    v_add_f32 v40, v40, v80
    v_add_f32 v41, v41, v81
    v_mfma_f32_16x16x32_bf16 a[76:79], v[156:159], a[156:159], a[76:79]
    v_add_f32 v42, v42, v82
    v_add_f32 v43, v43, v83
    v_mfma_f32_16x16x32_bf16 a[76:79], v[160:163], a[176:179], a[76:79]
    v_add_f32 v44, v44, v84
    v_add_f32 v45, v45, v85
    v_mfma_f32_16x16x32_bf16 a[80:83], v[164:167], a[200:203], a[80:83]
    ds_read_b128 v[184:187], v30 offset:1600
    v_add_f32 v46, v46, v86
    v_add_f32 v47, v47, v87
    v_mfma_f32_16x16x32_bf16 a[80:83], v[168:171], a[220:223], a[80:83]
    ds_write_b128 v248, a[60:63] offset:21888
    v_mfma_f32_16x16x32_bf16 a[84:87], v[164:167], a[204:207], a[84:87]
    v_add_f32 v48, v48, v88
    v_add_f32 v49, v49, v89
    v_mfma_f32_16x16x32_bf16 a[84:87], v[168:171], a[224:227], a[84:87]
    v_add_f32 v50, v50, v90
    v_add_f32 v51, v51, v91
    v_mfma_f32_16x16x32_bf16 a[88:91], v[164:167], a[208:211], a[88:91]
    v_add_f32 v52, v52, v92
    v_add_f32 v53, v53, v93
    v_mfma_f32_16x16x32_bf16 a[88:91], v[168:171], a[228:231], a[88:91]
    ds_read_b128 v[156:159], v30 offset:2688
    v_add_f32 v54, v54, v94
    v_add_f32 v55, v55, v95
    v_mfma_f32_16x16x32_bf16 a[92:95], v[164:167], a[212:215], a[92:95]
    ds_write_b128 v248, a[64:67] offset:22912
    v_mfma_f32_16x16x32_bf16 a[92:95], v[168:171], a[232:235], a[92:95]
    s_waitcnt lgkmcnt(5)
    v_add_f32 v56, v56, v96
    v_add_f32 v57, v57, v97
    v_mfma_f32_16x16x32_bf16 a[96:99], v[164:167], a[216:219], a[96:99]
    v_add_f32 v58, v58, v98
    v_add_f32 v59, v59, v99
    v_mfma_f32_16x16x32_bf16 a[96:99], v[168:171], a[236:239], a[96:99]
    ds_write_b128 v248, a[68:71] offset:23936
    v_mfma_f32_16x16x32_bf16 a[80:83], v[172:175], a[120:123], a[80:83]
    ds_read_b128 v[160:163], v31 offset:576
    v_add_f32 v60, v60, v100
    v_add_f32 v61, v61, v101
    v_mfma_f32_16x16x32_bf16 a[80:83], v[176:179], a[140:143], a[80:83]
    v_add_f32 v62, v62, v102
    v_add_f32 v63, v63, v103
    v_mfma_f32_16x16x32_bf16 a[84:87], v[172:175], a[124:127], a[84:87]
    v_add_f32 v64, v64, v104
    v_add_f32 v65, v65, v105
    v_mfma_f32_16x16x32_bf16 a[84:87], v[176:179], a[144:147], a[84:87]
    ds_write_b128 v248, a[72:75] offset:24960
    v_mfma_f32_16x16x32_bf16 a[88:91], v[172:175], a[128:131], a[88:91]
    v_add_f32 v66, v66, v106
    v_add_f32 v67, v67, v107
    v_mfma_f32_16x16x32_bf16 a[88:91], v[176:179], a[148:151], a[88:91]
    ds_read_b128 v[164:167], v33 offset:0
    v_add_f32 v68, v68, v108
    v_add_f32 v69, v69, v109
    v_mfma_f32_16x16x32_bf16 a[92:95], v[172:175], a[132:135], a[92:95]
    v_add_f32 v70, v70, v110
    v_add_f32 v71, v71, v111
    v_mfma_f32_16x16x32_bf16 a[92:95], v[176:179], a[152:155], a[92:95]
    ds_write_b128 v248, a[76:79] offset:25984
    v_mfma_f32_16x16x32_bf16 a[96:99], v[172:175], a[136:139], a[96:99]
    s_waitcnt lgkmcnt(8)
    v_add_f32 v72, v72, v112
    v_add_f32 v73, v73, v113
    v_mfma_f32_16x16x32_bf16 a[96:99], v[176:179], a[156:159], a[96:99]
    v_add_f32 v74, v74, v114
    v_add_f32 v75, v75, v115
    v_mfma_f32_16x16x32_bf16 a[100:103], v[180:183], a[200:203], a[100:103]
    ds_read_b128 v[168:171], v33 offset:1088
    v_mfma_f32_16x16x32_bf16 a[100:103], v[184:187], a[220:223], a[100:103]
    ds_write_b128 v248, a[80:83] offset:27008
    v_mfma_f32_16x16x32_bf16 a[104:107], v[180:183], a[204:207], a[104:107]
    s_waitcnt lgkmcnt(2)
    s_barrier
    v_mfma_f32_16x16x32_bf16 a[104:107], v[184:187], a[224:227], a[104:107]
    ds_read_b128 v[136:139], v250 offset:21888
    v_mfma_f32_16x16x32_bf16 a[108:111], v[180:183], a[208:211], a[108:111]
    ds_read_b128 v[140:143], v250 offset:22912
    v_mfma_f32_16x16x32_bf16 a[108:111], v[184:187], a[228:231], a[108:111]
    ds_read_b128 v[172:175], v33 offset:2176
    v_mfma_f32_16x16x32_bf16 a[112:115], v[180:183], a[212:215], a[112:115]
    ds_write_b128 v248, a[84:87] offset:28032
    v_mfma_f32_16x16x32_bf16 a[112:115], v[184:187], a[232:235], a[112:115]
    ds_read_b128 v[144:147], v250 offset:23936
    v_mfma_f32_16x16x32_bf16 a[116:119], v[180:183], a[216:219], a[116:119]
    ds_read_b128 v[148:151], v250 offset:24960
    v_mfma_f32_16x16x32_bf16 a[116:119], v[184:187], a[236:239], a[116:119]
    ds_write_b128 v248, a[88:91] offset:29056
    v_mfma_f32_16x16x32_bf16 a[100:103], v[156:159], a[120:123], a[100:103]
    ds_read_b128 v[176:179], v34 offset:64
    v_mfma_f32_16x16x32_bf16 a[100:103], v[160:163], a[140:143], a[100:103]
    ds_read_b128 v[152:155], v250 offset:25984
    v_mfma_f32_16x16x32_bf16 a[104:107], v[156:159], a[124:127], a[104:107]
    ds_read_b128 v[116:119], v250 offset:16768
    v_mfma_f32_16x16x32_bf16 a[104:107], v[160:163], a[144:147], a[104:107]
    ds_write_b128 v248, a[92:95] offset:30080
    v_mfma_f32_16x16x32_bf16 a[108:111], v[156:159], a[128:131], a[108:111]
    ds_read_b128 v[120:123], v250 offset:17792
    v_mfma_f32_16x16x32_bf16 a[108:111], v[160:163], a[148:151], a[108:111]
    ds_read_b128 v[180:183], v35 offset:2240
    v_mfma_f32_16x16x32_bf16 a[112:115], v[156:159], a[132:135], a[112:115]
    ds_read_b128 v[124:127], v250 offset:18816
    v_mfma_f32_16x16x32_bf16 a[112:115], v[160:163], a[152:155], a[112:115]
    ds_write_b128 v248, a[96:99] offset:31104
    v_mfma_f32_16x16x32_bf16 a[116:119], v[156:159], a[136:139], a[116:119]
    s_waitcnt lgkmcnt(15)
    ds_read_b128 v[128:131], v250 offset:19840
    v_mfma_f32_16x16x32_bf16 a[116:119], v[160:163], a[156:159], a[116:119]
    ds_read_b128 v[132:135], v250 offset:20864
    v_mfma_f32_16x16x32_bf16 v[36:39], v[164:167], a[200:203], v[36:39]
    ds_read_b128 v[184:187], v33 offset:512
    v_mfma_f32_16x16x32_bf16 v[36:39], v[168:171], a[220:223], v[36:39]
    ds_write_b128 v248, a[100:103] offset:32128
    v_mfma_f32_16x16x32_bf16 v[40:43], v[164:167], a[204:207], v[40:43]
    s_waitcnt lgkmcnt(10)
    v_add_f32 v56, v56, v136
    v_add_f32 v57, v57, v137
    v_mfma_f32_16x16x32_bf16 v[40:43], v[168:171], a[224:227], v[40:43]
    v_add_f32 v58, v58, v138
    v_add_f32 v59, v59, v139
    v_mfma_f32_16x16x32_bf16 v[44:47], v[164:167], a[208:211], v[44:47]
    v_add_f32 v60, v60, v140
    v_add_f32 v61, v61, v141
    v_mfma_f32_16x16x32_bf16 v[44:47], v[168:171], a[228:231], v[44:47]
    ds_read_b128 v[156:159], v33 offset:1600
    v_mfma_f32_16x16x32_bf16 v[48:51], v[164:167], a[212:215], v[48:51]
    ds_write_b128 v248, a[104:107] offset:33152
    v_mfma_f32_16x16x32_bf16 v[48:51], v[168:171], a[232:235], v[48:51]
    v_add_f32 v62, v62, v142
    v_add_f32 v63, v63, v143
    v_mfma_f32_16x16x32_bf16 v[52:55], v[164:167], a[216:219], v[52:55]
    s_waitcnt lgkmcnt(8)
    v_add_f32 v64, v64, v144
    v_add_f32 v65, v65, v145
    v_mfma_f32_16x16x32_bf16 v[52:55], v[168:171], a[236:239], v[52:55]
    v_add_f32 v66, v66, v146
    v_add_f32 v67, v67, v147
    v_mfma_f32_16x16x32_bf16 v[36:39], v[172:175], a[120:123], v[36:39]
    ds_read_b128 v[160:163], v33 offset:2688
    v_mfma_f32_16x16x32_bf16 v[36:39], v[176:179], a[140:143], v[36:39]
    ds_write_b128 v248, a[108:111] offset:34176
    v_mfma_f32_16x16x32_bf16 v[36:39], v[180:183], a[160:163], v[36:39]
    v_add_f32 v68, v68, v148
    v_add_f32 v69, v69, v149
    v_mfma_f32_16x16x32_bf16 v[40:43], v[172:175], a[124:127], v[40:43]
    v_add_f32 v70, v70, v150
    v_add_f32 v71, v71, v151
    v_mfma_f32_16x16x32_bf16 v[40:43], v[176:179], a[144:147], v[40:43]
    v_add_f32 v72, v72, v152
    v_add_f32 v73, v73, v153
    v_mfma_f32_16x16x32_bf16 v[40:43], v[180:183], a[164:167], v[40:43]
    ds_read_b128 v[164:167], v34 offset:576
    v_add_f32 v74, v74, v154
    v_add_f32 v75, v75, v155
    v_mfma_f32_16x16x32_bf16 v[44:47], v[172:175], a[128:131], v[44:47]
    ds_write_b128 v248, a[112:115] offset:35200
    v_mfma_f32_16x16x32_bf16 v[44:47], v[176:179], a[148:151], v[44:47]
    ds_read_b128 v[168:171], v35 offset:2752
    v_mfma_f32_16x16x32_bf16 v[44:47], v[180:183], a[168:171], v[44:47]
    v_mfma_f32_16x16x32_bf16 v[48:51], v[172:175], a[132:135], v[48:51]
    v_mfma_f32_16x16x32_bf16 v[48:51], v[176:179], a[152:155], v[48:51]
    v_mfma_f32_16x16x32_bf16 v[48:51], v[180:183], a[172:175], v[48:51]
    ds_write_b128 v248, a[116:119] offset:36224
    v_mfma_f32_16x16x32_bf16 v[52:55], v[172:175], a[136:139], v[52:55]
    v_mfma_f32_16x16x32_bf16 v[52:55], v[176:179], a[156:159], v[52:55]
    s_waitcnt lgkmcnt(7)
    v_mfma_f32_16x16x32_bf16 v[52:55], v[180:183], a[176:179], v[52:55]
    v_mfma_f32_16x16x32_bf16 v[56:59], v[184:187], a[200:203], v[56:59]
    v_mfma_f32_16x16x32_bf16 v[56:59], v[156:159], a[220:223], v[56:59]
    v_mfma_f32_16x16x32_bf16 v[60:63], v[184:187], a[204:207], v[60:63]
    s_waitcnt lgkmcnt(0)
    s_barrier
    v_mfma_f32_16x16x32_bf16 v[60:63], v[156:159], a[224:227], v[60:63]
    ds_read_b128 v[76:79], v251 offset:27008
    v_add_f32 v36, v36, v116
    v_add_f32 v37, v37, v117
    v_mfma_f32_16x16x32_bf16 v[64:67], v[184:187], a[208:211], v[64:67]
    ds_read_b128 v[80:83], v251 offset:28032
    v_add_f32 v38, v38, v118
    v_add_f32 v39, v39, v119
    v_mfma_f32_16x16x32_bf16 v[64:67], v[156:159], a[228:231], v[64:67]
    ds_read_b128 v[84:87], v251 offset:29056
    v_add_f32 v40, v40, v120
    v_add_f32 v41, v41, v121
    v_mfma_f32_16x16x32_bf16 v[68:71], v[184:187], a[212:215], v[68:71]
    ds_read_b128 v[88:91], v251 offset:30080
    v_add_f32 v42, v42, v122
    v_add_f32 v43, v43, v123
    v_mfma_f32_16x16x32_bf16 v[68:71], v[156:159], a[232:235], v[68:71]
    ds_read_b128 v[92:95], v251 offset:31104
    v_add_f32 v44, v44, v124
    v_add_f32 v45, v45, v125
    v_mfma_f32_16x16x32_bf16 v[72:75], v[184:187], a[216:219], v[72:75]
    ds_read_b128 v[96:99], v251 offset:32128
    v_add_f32 v46, v46, v126
    v_add_f32 v47, v47, v127
    v_mfma_f32_16x16x32_bf16 v[72:75], v[156:159], a[236:239], v[72:75]
    ds_read_b128 v[100:103], v251 offset:33152
    v_add_f32 v48, v48, v128
    v_add_f32 v49, v49, v129
    v_mfma_f32_16x16x32_bf16 v[56:59], v[160:163], a[120:123], v[56:59]
    ds_read_b128 v[104:107], v251 offset:34176
    v_add_f32 v50, v50, v130
    v_add_f32 v51, v51, v131
    v_mfma_f32_16x16x32_bf16 v[56:59], v[164:167], a[140:143], v[56:59]
    ds_read_b128 v[108:111], v251 offset:35200
    v_add_f32 v52, v52, v132
    v_add_f32 v53, v53, v133
    v_mfma_f32_16x16x32_bf16 v[56:59], v[168:171], a[160:163], v[56:59]
    ds_read_b128 v[112:115], v251 offset:36224
    v_add_f32 v54, v54, v134
    v_add_f32 v55, v55, v135
    v_mfma_f32_16x16x32_bf16 v[60:63], v[160:163], a[124:127], v[60:63]
    s_waitcnt lgkmcnt(8)
    v_add_f32 v36, v36, v76
    v_add_f32 v37, v37, v77
    v_mfma_f32_16x16x32_bf16 v[60:63], v[164:167], a[144:147], v[60:63]
    v_add_f32 v38, v38, v78
    v_add_f32 v39, v39, v79
    v_mfma_f32_16x16x32_bf16 v[60:63], v[168:171], a[164:167], v[60:63]
    v_add_f32 v40, v40, v80
    v_add_f32 v41, v41, v81
    v_mfma_f32_16x16x32_bf16 v[64:67], v[160:163], a[128:131], v[64:67]
    v_add_f32 v42, v42, v82
    v_add_f32 v43, v43, v83
    v_mfma_f32_16x16x32_bf16 v[64:67], v[164:167], a[148:151], v[64:67]
    s_waitcnt lgkmcnt(5)
    v_add_f32 v44, v44, v84
    v_add_f32 v45, v45, v85
    v_mfma_f32_16x16x32_bf16 v[64:67], v[168:171], a[168:171], v[64:67]
    v_add_f32 v46, v46, v86
    v_add_f32 v47, v47, v87
    v_mfma_f32_16x16x32_bf16 v[68:71], v[160:163], a[132:135], v[68:71]
    v_add_f32 v48, v48, v88
    v_add_f32 v49, v49, v89
    v_mfma_f32_16x16x32_bf16 v[68:71], v[164:167], a[152:155], v[68:71]
    v_add_f32 v50, v50, v90
    v_add_f32 v51, v51, v91
    v_mfma_f32_16x16x32_bf16 v[68:71], v[168:171], a[172:175], v[68:71]
    v_add_f32 v52, v52, v92
    v_add_f32 v53, v53, v93
    v_mfma_f32_16x16x32_bf16 v[72:75], v[160:163], a[136:139], v[72:75]
    v_add_f32 v54, v54, v94
    v_add_f32 v55, v55, v95
    v_mfma_f32_16x16x32_bf16 v[72:75], v[164:167], a[156:159], v[72:75]
    v_mfma_f32_16x16x32_bf16 v[72:75], v[168:171], a[176:179], v[72:75]
    s_waitcnt lgkmcnt(4)
    v_pk_add_f32 v[56:57], v[56:57], v[96:97]
    v_pk_add_f32 v[58:59], v[58:59], v[98:99]
    s_waitcnt lgkmcnt(3)
    v_pk_add_f32 v[60:61], v[60:61], v[100:101]
    v_pk_add_f32 v[62:63], v[62:63], v[102:103]
    s_waitcnt lgkmcnt(2)
    v_pk_add_f32 v[64:65], v[64:65], v[104:105]
    v_pk_add_f32 v[66:67], v[66:67], v[106:107]
    s_waitcnt lgkmcnt(1)
    v_pk_add_f32 v[68:69], v[68:69], v[108:109]
    v_pk_add_f32 v[70:71], v[70:71], v[110:111]
    s_waitcnt lgkmcnt(0)
    v_pk_add_f32 v[72:73], v[72:73], v[112:113]
    v_pk_add_f32 v[74:75], v[74:75], v[114:115]
    v_cvt_pk_bf16_f32 v76, v36, v37
    v_cvt_pk_bf16_f32 v77, v38, v39
    v_cvt_pk_bf16_f32 v78, v56, v57
    v_cvt_pk_bf16_f32 v79, v58, v59
    v_cvt_pk_bf16_f32 v80, v40, v41
    v_cvt_pk_bf16_f32 v81, v42, v43
    v_cvt_pk_bf16_f32 v82, v60, v61
    v_cvt_pk_bf16_f32 v83, v62, v63
    v_cvt_pk_bf16_f32 v84, v44, v45
    v_cvt_pk_bf16_f32 v85, v46, v47
    v_cvt_pk_bf16_f32 v86, v64, v65
    v_cvt_pk_bf16_f32 v87, v66, v67
    v_cvt_pk_bf16_f32 v88, v48, v49
    v_cvt_pk_bf16_f32 v89, v50, v51
    v_cvt_pk_bf16_f32 v90, v68, v69
    v_cvt_pk_bf16_f32 v91, v70, v71
    v_cvt_pk_bf16_f32 v92, v52, v53
    v_cvt_pk_bf16_f32 v93, v54, v55
    v_cvt_pk_bf16_f32 v94, v72, v73
    v_cvt_pk_bf16_f32 v95, v74, v75
    v_permlane16_swap_b32 v76, v78
    v_permlane16_swap_b32 v77, v79
    v_permlane16_swap_b32 v80, v82
    v_permlane16_swap_b32 v81, v83
    v_permlane16_swap_b32 v84, v86
    v_permlane16_swap_b32 v85, v87
    v_permlane16_swap_b32 v88, v90
    v_permlane16_swap_b32 v89, v91
    v_permlane16_swap_b32 v92, v94
    v_permlane16_swap_b32 v93, v95
    s_add_u32 s38, s37, 0
    buffer_store_dwordx4 v[76:79], v4, s[72:75], s38 offen sc1
    s_add_u32 s38, s37, 131072
    buffer_store_dwordx4 v[80:83], v4, s[72:75], s38 offen sc1
    s_add_u32 s38, s37, 262144
    buffer_store_dwordx4 v[84:87], v4, s[72:75], s38 offen sc1
    s_add_u32 s38, s37, 393216
    buffer_store_dwordx4 v[88:91], v4, s[72:75], s38 offen sc1
    s_add_u32 s38, s37, 524288
    buffer_store_dwordx4 v[92:95], v4, s[72:75], s38 offen sc1
L_end:
    s_endpgm
.section .rodata,"a"
.p2align 6
.amdhsa_kernel standalone__adm_resblock__diffusion_kernel
  .amdhsa_next_free_vgpr 508
  .amdhsa_next_free_sgpr 102
  .amdhsa_accum_offset 256
  .amdhsa_group_segment_fixed_size 0
  .amdhsa_kernarg_size 96
  .amdhsa_user_sgpr_count 2
  .amdhsa_user_sgpr_kernarg_segment_ptr 1
  .amdhsa_system_sgpr_workgroup_id_x 1
.end_amdhsa_kernel
.text
```
